```python
import torch

def _softmax(x, axis=-1):
    return torch.softmax(x, dim=axis)
def _gelu(x):
    return torch.nn.functional.gelu(x, approximate="tanh")
def _silu(x):
    return torch.nn.functional.silu(x)
def _sigmoid(x):
    return torch.sigmoid(x)
def _layernorm(x, axis=-1, eps=1e-5):
    m = x.mean(dim=axis, keepdim=True)
    v = x.var(dim=axis, keepdim=True, unbiased=False)
    return (x - m) / torch.sqrt(v + eps)
def _scatter_add(tgt, idx, src, axis=0):
    return tgt.clone().index_add_(axis, idx, src)
def _segment_sum(src, seg, n):
    out = torch.zeros((n,) + src.shape[1:], dtype=src.dtype)
    return out.index_add_(0, seg, src)
def _pad(x, pw):
    flat = tuple(v for pair in reversed(pw) for v in pair)
    return torch.nn.functional.pad(x, flat)

kernel_name = 'concat_heads__mha_block_cached__gqa_block_cached__near_ridge'

def setup_inputs():

    _w = (lambda a: (lambda t: t.to(torch.bfloat16) if t.is_floating_point() else t)(torch.as_tensor(a)))
    def _A_setup():
        B, Sq, D = 8, 224, 512
        H, Sk, Dh = 32, 512, 128
        return {
            "x": _w((lambda *s: torch.randn(*s, dtype=torch.bfloat16) * 0.8)(B, Sq, D)),
            "k_cache": _w((lambda *s: torch.randn(*s, dtype=torch.bfloat16) * 0.8)(B, H, Sk, Dh)),
            "v_cache": _w((lambda *s: torch.randn(*s, dtype=torch.bfloat16) * 0.05)(B, H, Sk, Dh)),
            "wq": _w((lambda *s: torch.randn(*s, dtype=torch.bfloat16) * 0.8)(D, H * Dh) * (D ** -0.5)),
            "wo": _w((lambda *s: torch.randn(*s, dtype=torch.bfloat16) * 0.05)(H * Dh, D) * ((H * Dh) ** -0.5)),
        }
    _A_in = _A_setup()

    def _B_setup():
        B, Sq, D = 8, 224, 512
        Hq, Hkv, Sk, Dh = 32, 32, 512, 128
        assert Hq % Hkv == 0, (Hq, Hkv)
        return {
            "x": _w((lambda *s: torch.randn(*s, dtype=torch.bfloat16) * 0.8)(B, Sq, D)),
            "k_cache": _w((lambda *s: torch.randn(*s, dtype=torch.bfloat16) * 0.8)(B, Hkv, Sk, Dh)),
            "v_cache": _w((lambda *s: torch.randn(*s, dtype=torch.bfloat16) * 0.05)(B, Hkv, Sk, Dh)),
            "wq": _w((lambda *s: torch.randn(*s, dtype=torch.bfloat16) * 0.8)(D, Hq * Dh) * (D ** -0.5)),
            "wo": _w((lambda *s: torch.randn(*s, dtype=torch.bfloat16) * 0.05)(Hq * Dh, D) * ((Hq * Dh) ** -0.5)),
        }
    _B_in = _B_setup()

    return {
        "A_x": _A_in["x"],
        "A_k_cache": _A_in["k_cache"],
        "A_v_cache": _A_in["v_cache"],
        "A_wq": _A_in["wq"],
        "A_wo": _A_in["wo"],
        "B_x": _B_in["x"],
        "B_k_cache": _B_in["k_cache"],
        "B_v_cache": _B_in["v_cache"],
        "B_wq": _B_in["wq"],
        "B_wo": _B_in["wo"],
    }

def reference(A_x, A_k_cache, A_v_cache, A_wq, A_wo, B_x, B_k_cache, B_v_cache, B_wq, B_wo):
    def _A_ref(x, k_cache, v_cache, wq, wo):
        B, Sq, D = x.shape
        H, Dh = 32, 128
        q = (lambda x, *d: x.permute(*d))((x @ wq).reshape(B, Sq, H, Dh), 0, 2, 1, 3)
        scores = torch.einsum("bhqd,bhkd->bhqk", q, k_cache) * (Dh ** -0.5)
        p = _softmax(scores, axis=-1)
        o = torch.einsum("bhqk,bhkd->bhqd", p, v_cache)
        return (lambda x, *d: x.permute(*d))(o, 0, 2, 1, 3).reshape(B, Sq, H * Dh) @ wo

    def _B_ref(x, k_cache, v_cache, wq, wo):
        B, Sq, D = x.shape
        Hq, Dh = 32, 128
        Hkv = k_cache.shape[1]
        rep = Hq // Hkv
        q = (lambda x, *d: x.permute(*d))((x @ wq).reshape(B, Sq, Hq, Dh), 0, 2, 1, 3)
        k = (lambda x, n, axis: torch.repeat_interleave(x, n, dim=axis))(k_cache, rep, axis=1)
        v = (lambda x, n, axis: torch.repeat_interleave(x, n, dim=axis))(v_cache, rep, axis=1)
        scores = torch.einsum("bhqd,bhkd->bhqk", q, k) * (Dh ** -0.5)
        p = _softmax(scores, axis=-1)
        o = torch.einsum("bhqk,bhkd->bhqd", p, v)
        return (lambda x, *d: x.permute(*d))(o, 0, 2, 1, 3).reshape(B, Sq, Hq * Dh) @ wo

    a = _A_ref(A_x, A_k_cache, A_v_cache, A_wq, A_wo)
    b = _B_ref(B_x, B_k_cache, B_v_cache, B_wq, B_wo)
    return torch.concatenate([a, b], axis=-1)
```

```asm
; @launch grid=(256,1,1) block=(256,1,1) lds=163840
.amdgcn_target "amdgcn-amd-amdhsa--gfx950"
.text
.globl concat_heads__mha_block_cached__gqa_block_cached__near_ridge_kernel
.p2align 8
.type concat_heads__mha_block_cached__gqa_block_cached__near_ridge_kernel,@function
concat_heads__mha_block_cached__gqa_block_cached__near_ridge_kernel:
    s_cmp_ge_u32 s2, 256
    s_cbranch_scc1 L_end
    s_load_dwordx16 s[64:79], s[0:1], 0
    s_load_dwordx4 s[80:83], s[0:1], 64
    s_load_dwordx2 s[84:85], s[0:1], 96
    s_load_dwordx4 s[20:23], s[0:1], 80
    s_memrealtime s[24:25]
    s_getpc_b64 s[28:29]
L_pc:
    s_mov_b32 s30, L_s2a-L_pc
    s_mov_b32 s31, 0x20000
    v_lshrrev_b32 v232, 2, v0
    v_lshlrev_b32 v232, 7, v232
    s_bfe_u32 s41, s2, 0x20003
    s_lshl_b32 s41, s41, 13
    buffer_load_dword v233, v232, s[28:31], s41 offen
    s_add_u32 s100, s28, L_s2a-L_pc
    s_addc_u32 s101, s29, 0
    v_lshrrev_b32 v224, 6, v0
    v_and_b32 v231, 63, v0
    v_readfirstlane_b32 s32, v224
    s_bfe_u32 s35, s2, 0x10002
    s_bfe_u32 s36, s2, 0x10003
    s_bfe_u32 s33, s2, 0x20004
    s_and_b32 s52, s2, 1
    s_lshl_b32 s52, s52, 2
    s_or_b32 s33, s33, s52
    s_bfe_u32 s34, s2, 0x20006
    s_and_b32 s52, s2, 2
    s_lshl_b32 s52, s52, 1
    s_or_b32 s34, s34, s52
    s_add_u32 s52, s34, s33
    s_and_b32 s52, s52, 1
    s_and_b32 s55, s34, 2
    s_lshl_b32 s55, s55, 16
    s_lshl_b32 s4, s52, 8
    s_lshl_b32 s60, s4, 12
    s_or_b32 s60, s60, s55
    s_mov_b32 s59, 0x03210654
    s_bitcmp1_b32 s33, 0
    s_cselect_b32 s59, 0x06543210, s59
    v_and_b32 v225, 15, v231
    v_lshrrev_b32 v226, 4, v231
    v_lshlrev_b32 v229, 2, v226
    v_xor_b32 v229, v229, v225
    v_lshlrev_b32 v229, 4, v229
    v_lshl_add_u32 v245, v226, 8, v229
    v_lshl_add_u32 v248, v226, 10, v229
    v_lshlrev_b32 v229, 4, v225
    v_lshl_add_u32 v249, v226, 18, v229
    s_mul_i32 s48, s32, 1040
    s_add_u32 s48, s48, 47360
    s_lshl_b32 s52, s34, 1
    s_add_u32 s52, s52, s36
    s_mul_i32 s52, s52, 114688
    s_lshl_b32 s53, s32, 12
    s_add_u32 s52, s52, s53
    s_lshl_b32 s54, s33, 2
    s_add_u32 s54, s54, s32
    s_lshl_b32 s53, s54, 8
    s_waitcnt lgkmcnt(0)
    s_cmp_eq_u32 s35, 0
    s_cselect_b64 s[64:65], s[64:65], s[74:75]
    s_cselect_b64 s[66:67], s[66:67], s[76:77]
    s_cselect_b64 s[68:69], s[68:69], s[78:79]
    s_cselect_b64 s[70:71], s[70:71], s[80:81]
    s_cselect_b64 s[72:73], s[72:73], s[82:83]
    s_add_u32 s8, s64, s52
    s_addc_u32 s9, s65, 0
    s_mov_b32 s10, 0x19000
    s_mov_b32 s11, 0x20000
    s_add_u32 s12, s70, s53
    s_addc_u32 s13, s71, 0
    s_mov_b32 s14, 0x3fe100
    s_mov_b32 s15, 0x20000
    s_add_u32 m0, s48, 0
    s_bfe_u32 s50, s59, 0x40000
    s_lshl_b32 s50, s50, 14
    s_add_u32 s50, s50, s4
    buffer_load_dwordx4 v248, s[8:11], s50 offen lds
    s_add_u32 m0, s48, 0x1040
    s_bfe_u32 s50, s59, 0x40004
    s_lshl_b32 s50, s50, 14
    s_add_u32 s50, s50, s4
    buffer_load_dwordx4 v248, s[8:11], s50 offen lds
    s_add_u32 m0, s48, 0x2080
    s_bfe_u32 s50, s59, 0x40008
    s_lshl_b32 s50, s50, 14
    s_add_u32 s50, s50, s4
    buffer_load_dwordx4 v248, s[8:11], s50 offen lds
    s_add_u32 m0, s48, 0x30c0
    s_bfe_u32 s50, s59, 0x4000c
    s_lshl_b32 s50, s50, 14
    s_add_u32 s50, s50, s4
    buffer_load_dwordx4 v248, s[8:11], s50 offen lds
    s_add_u32 m0, s48, 0x4100
    s_bfe_u32 s50, s59, 0x40010
    s_lshl_b32 s50, s50, 14
    s_add_u32 s50, s50, s4
    buffer_load_dwordx4 v248, s[8:11], s50 offen lds
    s_add_u32 m0, s48, 0x5140
    s_bfe_u32 s50, s59, 0x40014
    s_lshl_b32 s50, s50, 14
    s_add_u32 s50, s50, s4
    buffer_load_dwordx4 v248, s[8:11], s50 offen lds
    s_add_u32 m0, s48, 0x6180
    s_bfe_u32 s50, s59, 0x40018
    s_lshl_b32 s50, s50, 14
    s_add_u32 s50, s50, s4
    buffer_load_dwordx4 v248, s[8:11], s50 offen lds
    s_add_u32 s40, s60, 0
    buffer_load_dwordx4 v[0:3], v249, s[12:15], s40 offen
    s_add_u32 s41, s60, 0x2000
    buffer_load_dwordx4 v[4:7], v249, s[12:15], s41 offen
    s_add_u32 s40, s60, 0x4000
    buffer_load_dwordx4 v[8:11], v249, s[12:15], s40 offen
    s_add_u32 s41, s60, 0x6000
    buffer_load_dwordx4 v[12:15], v249, s[12:15], s41 offen
    s_add_u32 s40, s60, 0x8000
    buffer_load_dwordx4 v[16:19], v249, s[12:15], s40 offen
    s_add_u32 s41, s60, 0xa000
    buffer_load_dwordx4 v[20:23], v249, s[12:15], s41 offen
    s_add_u32 s40, s60, 0xc000
    buffer_load_dwordx4 v[24:27], v249, s[12:15], s40 offen
    s_add_u32 s41, s60, 0xe000
    buffer_load_dwordx4 v[28:31], v249, s[12:15], s41 offen
    s_xor_b32 s61, s60, 0x20000
    s_xor_b32 s5, s4, 256
    s_lshl_b32 s62, s5, 12
    s_or_b32 s62, s62, s55
    s_xor_b32 s63, s62, 0x20000
    s_xor_b32 s6, s4, 512
    s_lshl_b32 s3, s6, 12
    s_or_b32 s3, s3, s55
    s_xor_b32 s81, s3, 0x20000
    s_xor_b32 s7, s4, 768
    s_lshl_b32 s82, s7, 12
    s_or_b32 s82, s82, s55
    s_xor_b32 s83, s82, 0x20000
    s_mov_b32 s37, 0x05040100
    s_mov_b32 s38, 0x07060302
    s_mov_b32 s49, 0x3e0293ee
    s_mov_b32 s51, 0x5f800000
    s_lshl_b32 s58, s35, 3
    s_or_b32 s58, s58, s34
    s_lshl_b32 s58, s58, 1
    s_or_b32 s58, s58, s36
    s_lshl_b32 s58, s58, 3
    s_or_b32 s58, s58, s33
    s_andn2_b32 s52, s58, 7
    s_add_u32 s76, s22, s52
    s_addc_u32 s77, s23, 0
    s_mov_b32 s78, 8
    s_mov_b32 s79, 0x20000
    s_or_b32 s52, s33, s32
    s_cbranch_scc1 L_noat
    s_or_b32 s43, s24, 1
    v_mov_b32 v236, s43
    v_mov_b32 v237, s25
    buffer_store_dwordx2 v[236:237], off, s[76:79], 0 sc0 sc1
L_noat:
    s_mul_i32 s56, s34, 5
    s_add_u32 s56, s56, s54
    s_lshl_b32 s52, s35, 2
    s_add_u32 s56, s56, s52
    s_and_b32 s56, s56, 7
    s_lshl_b32 s56, s56, 14
    s_lshl_b32 s52, s34, 5
    s_add_u32 s52, s52, s54
    s_lshl_b32 s52, s52, 17
    s_mov_b32 s44, s20
    s_mov_b32 s45, s21
    s_add_u32 s16, s66, s52
    s_addc_u32 s17, s67, 0
    s_mov_b32 s18, 0x20000
    s_mov_b32 s19, 0x20000
    s_add_u32 s20, s68, s52
    s_addc_u32 s21, s69, 0
    s_mov_b32 s22, 0x20000
    s_mov_b32 s23, 0x20000
    s_lshl_b32 s52, s33, 19
    s_lshl_b32 s53, s32, 6
    s_add_u32 s53, s52, s53
    s_add_u32 s24, s72, s53
    s_addc_u32 s25, s73, 0
    s_mov_b32 s26, 0x7ff40
    s_mov_b32 s27, 0x20000
    s_and_b32 s53, s34, 3
    s_lshl_b32 s53, s53, 1
    s_or_b32 s53, s53, s36
    s_lshl_b32 s53, s53, 14
    s_add_u32 s52, s52, s53
    s_lshl_b32 s53, s32, 17
    s_add_u32 s53, s52, s53
    s_add_u32 s68, s72, s53
    s_addc_u32 s69, s73, 0
    s_and_b32 s70, s33, 1
    s_lshr_b32 s52, s58, 3
    s_mul_i32 s52, s52, 917504
    s_mul_i32 s53, s32, 7168
    s_add_u32 s52, s52, s53
    s_mul_i32 s53, s70, 28672
    s_add_u32 s52, s52, s53
    s_add_u32 s28, s84, s52
    s_addc_u32 s29, s85, 0
    s_mov_b32 s30, 0xd3c00
    s_mov_b32 s31, 0x20000
    s_lshr_b32 s52, s33, 1
    s_xor_b32 s53, s52, 2
    s_lshl_b32 s64, s53, 8
    s_xor_b32 s53, s52, 3
    s_lshl_b32 s65, s53, 8
    s_xor_b32 s53, s52, 1
    s_lshl_b32 s66, s53, 8
    s_xor_b32 s53, s52, 0
    s_lshl_b32 s67, s53, 8
    s_mul_i32 s46, s32, 8320
    s_mul_i32 s47, s32, 8448
    s_add_u32 s47, s47, 66560
    v_lshrrev_b32 v227, 2, v225
    v_and_b32 v228, 3, v225
    v_xor_b32 v229, v226, v228
    v_lshlrev_b32 v229, 6, v229
    v_lshl_add_u32 v229, v228, 8, v229
    v_mul_u32_u24 v230, 1040, v227
    v_add_u32 v229, v229, v230
    v_add_u32 v240, s46, v229
    s_lshr_b32 s52, s55, 12
    s_xor_b32 s53, s52, 32
    v_add_u32 v230, 47360, v229
    v_add_u32 v246, s52, v230
    v_add_u32 v254, s53, v230
    v_add_u32 v247, 58240, v246
    v_add_u32 v255, 58240, v254
    v_mul_u32_u24 v229, 1056, v226
    v_lshl_add_u32 v229, v227, 8, v229
    v_lshl_add_u32 v229, v228, 3, v229
    v_add_u32 v229, s47, v229
    v_xor_b32 v230, 0, v227
    v_lshl_add_u32 v241, v230, 6, v229
    v_xor_b32 v230, 1, v227
    v_lshl_add_u32 v242, v230, 6, v229
    v_xor_b32 v230, 2, v227
    v_lshl_add_u32 v243, v230, 6, v229
    v_xor_b32 v230, 3, v227
    v_lshl_add_u32 v244, v230, 6, v229
    v_lshlrev_b32 v251, 4, v231
    v_and_b32 v230, 1, v226
    v_lshlrev_b32 v229, 4, v228
    v_lshlrev_b32 v224, 5, v230
    v_xor_b32 v229, v229, v224
    v_lshrrev_b32 v230, 2, v231
    v_lshl_add_u32 v250, v230, 10, v229
    v_lshl_add_u32 v229, v230, 6, v224
    v_lshl_add_u32 v229, v228, 3, v229
    s_mul_i32 s52, s32, 12288
    s_add_u32 s52, s52, 114688
    v_add_u32 v252, s52, v229
    v_xor_b32 v253, 32, v252
    s_mov_b32 s34, s44
    s_mov_b32 s35, s45
    s_add_u32 s42, s56, 16384
    s_and_b32 s42, s42, 0x1ffff
    s_xor_b32 s43, s42, 4096
    s_mov_b32 s44, s42
    s_mov_b32 s45, s43
    s_mov_b32 s39, 7
    s_waitcnt vmcnt(8)
    s_nop 0
    s_barrier
    ds_read_b128 v[204:207], v246 offset:0
    ds_read_b128 v[208:211], v246 offset:4160
    ds_read_b128 v[212:215], v246 offset:8320
    ds_read_b128 v[216:219], v246 offset:12480
    ds_read_b128 v[220:223], v246 offset:16640
    ds_read_b128 v[224:227], v246 offset:20800
    ds_read_b128 v[228:231], v246 offset:24960
    s_add_u32 s40, s60, 0x10000
    buffer_load_dwordx4 v[32:35], v249, s[12:15], s40 offen
    s_add_u32 s41, s60, 0x12000
    buffer_load_dwordx4 v[36:39], v249, s[12:15], s41 offen
    s_add_u32 s40, s60, 0x14000
    buffer_load_dwordx4 v[40:43], v249, s[12:15], s40 offen
    s_add_u32 s41, s60, 0x16000
    buffer_load_dwordx4 v[44:47], v249, s[12:15], s41 offen
    s_add_u32 s40, s60, 0x18000
    buffer_load_dwordx4 v[48:51], v249, s[12:15], s40 offen
    s_add_u32 s41, s60, 0x1a000
    buffer_load_dwordx4 v[52:55], v249, s[12:15], s41 offen
    s_add_u32 s40, s60, 0x1c000
    buffer_load_dwordx4 v[56:59], v249, s[12:15], s40 offen
    s_add_u32 s41, s60, 0x1e000
    buffer_load_dwordx4 v[60:63], v249, s[12:15], s41 offen
    s_waitcnt vmcnt(14)
    v_perm_b32 v192, v4, v0, s37
    s_waitcnt vmcnt(12)
    v_perm_b32 v193, v12, v8, s37
    s_waitcnt vmcnt(10)
    v_perm_b32 v194, v20, v16, s37
    s_waitcnt vmcnt(8)
    v_perm_b32 v195, v28, v24, s37
    s_waitcnt lgkmcnt(6)
    s_nop 0
    v_mfma_f32_16x16x32_bf16 a[0:3], v[192:195], v[204:207], 0
    s_waitcnt lgkmcnt(5)
    v_perm_b32 v196, v4, v0, s38
    v_perm_b32 v197, v12, v8, s38
    v_mfma_f32_16x16x32_bf16 a[32:35], v[192:195], v[208:211], 0
    s_waitcnt lgkmcnt(4)
    v_perm_b32 v198, v20, v16, s38
    v_perm_b32 v199, v28, v24, s38
    v_mfma_f32_16x16x32_bf16 a[64:67], v[192:195], v[212:215], 0
    s_waitcnt lgkmcnt(3)
    v_mfma_f32_16x16x32_bf16 a[96:99], v[192:195], v[216:219], 0
    s_waitcnt lgkmcnt(2)
    v_mfma_f32_16x16x32_bf16 a[128:131], v[192:195], v[220:223], 0
    s_waitcnt lgkmcnt(1)
    v_mfma_f32_16x16x32_bf16 a[160:163], v[192:195], v[224:227], 0
    s_waitcnt lgkmcnt(0)
    v_mfma_f32_16x16x32_bf16 a[192:195], v[192:195], v[228:231], 0
    s_mov_b32 s4, s68
    v_perm_b32 v200, v5, v1, s37
    v_perm_b32 v201, v13, v9, s37
    v_mfma_f32_16x16x32_bf16 a[4:7], v[196:199], v[204:207], 0
    s_mov_b32 s60, s100
    v_perm_b32 v202, v21, v17, s37
    v_perm_b32 v203, v29, v25, s37
    v_mfma_f32_16x16x32_bf16 a[36:39], v[196:199], v[208:211], 0
    s_bfe_u32 s80, s2, 0x20003
    ds_read_b128 a[224:227], v246 offset:16
    v_mfma_f32_16x16x32_bf16 a[68:71], v[196:199], v[212:215], 0
    s_lshl_b32 s80, s80, 2
    v_mfma_f32_16x16x32_bf16 a[100:103], v[196:199], v[216:219], 0
    s_or_b32 s80, s80, s32
    v_mfma_f32_16x16x32_bf16 a[132:135], v[196:199], v[220:223], 0
    s_add_u32 s40, s61, 0
    ds_read_b128 a[228:231], v246 offset:4176
    v_mfma_f32_16x16x32_bf16 a[164:167], v[196:199], v[224:227], 0
    buffer_load_dwordx4 v[64:67], v249, s[12:15], s40 offen
    v_mfma_f32_16x16x32_bf16 a[196:199], v[196:199], v[228:231], 0
    s_add_u32 s41, s61, 0x2000
    v_perm_b32 v192, v5, v1, s38
    v_perm_b32 v193, v13, v9, s38
    v_mfma_f32_16x16x32_bf16 a[8:11], v[200:203], v[204:207], 0
    buffer_load_dwordx4 v[68:71], v249, s[12:15], s41 offen
    v_mfma_f32_16x16x32_bf16 a[40:43], v[200:203], v[208:211], 0
    s_lshl_b32 s80, s80, 11
    v_perm_b32 v194, v21, v17, s38
    v_perm_b32 v195, v29, v25, s38
    v_mfma_f32_16x16x32_bf16 a[72:75], v[200:203], v[212:215], 0
    s_mul_i32 s52, s32, 28672
    ds_read_b128 a[232:235], v246 offset:8336
    v_mfma_f32_16x16x32_bf16 a[104:107], v[200:203], v[216:219], 0
    s_add_u32 s40, s61, 0x4000
    v_mfma_f32_16x16x32_bf16 a[136:139], v[200:203], v[220:223], 0
    buffer_load_dwordx4 v[72:75], v249, s[12:15], s40 offen
    v_mfma_f32_16x16x32_bf16 a[168:171], v[200:203], v[224:227], 0
    v_mfma_f32_16x16x32_bf16 a[200:203], v[200:203], v[228:231], 0
    v_perm_b32 v196, v6, v2, s37
    v_perm_b32 v197, v14, v10, s37
    v_mfma_f32_16x16x32_bf16 a[12:15], v[192:195], v[204:207], 0
    s_add_u32 s41, s61, 0x6000
    v_perm_b32 v198, v22, v18, s37
    v_perm_b32 v199, v30, v26, s37
    v_mfma_f32_16x16x32_bf16 a[44:47], v[192:195], v[208:211], 0
    buffer_load_dwordx4 v[76:79], v249, s[12:15], s41 offen
    v_mfma_f32_16x16x32_bf16 a[76:79], v[192:195], v[212:215], 0
    ds_read_b128 a[236:239], v246 offset:12496
    v_mfma_f32_16x16x32_bf16 a[108:111], v[192:195], v[216:219], 0
    v_mfma_f32_16x16x32_bf16 a[140:143], v[192:195], v[220:223], 0
    s_add_u32 s40, s61, 0x8000
    v_mfma_f32_16x16x32_bf16 a[172:175], v[192:195], v[224:227], 0
    buffer_load_dwordx4 v[80:83], v249, s[12:15], s40 offen
    v_mfma_f32_16x16x32_bf16 a[204:207], v[192:195], v[228:231], 0
    v_perm_b32 v200, v6, v2, s38
    v_perm_b32 v201, v14, v10, s38
    v_mfma_f32_16x16x32_bf16 a[16:19], v[196:199], v[204:207], 0
    v_perm_b32 v202, v22, v18, s38
    v_perm_b32 v203, v30, v26, s38
    v_mfma_f32_16x16x32_bf16 a[48:51], v[196:199], v[208:211], 0
    s_add_u32 s41, s61, 0xa000
    ds_read_b128 a[240:243], v246 offset:16656
    v_mfma_f32_16x16x32_bf16 a[80:83], v[196:199], v[212:215], 0
    buffer_load_dwordx4 v[84:87], v249, s[12:15], s41 offen
    v_mfma_f32_16x16x32_bf16 a[112:115], v[196:199], v[216:219], 0
    ds_read_b128 a[244:247], v246 offset:20816
    v_mfma_f32_16x16x32_bf16 a[144:147], v[196:199], v[220:223], 0
    v_mfma_f32_16x16x32_bf16 a[176:179], v[196:199], v[224:227], 0
    s_add_u32 s40, s61, 0xc000
    v_mfma_f32_16x16x32_bf16 a[208:211], v[196:199], v[228:231], 0
    buffer_load_dwordx4 v[88:91], v249, s[12:15], s40 offen
    v_mfma_f32_16x16x32_bf16 a[20:23], v[200:203], v[204:207], 0
    v_perm_b32 v192, v7, v3, s37
    v_perm_b32 v193, v15, v11, s37
    v_mfma_f32_16x16x32_bf16 a[52:55], v[200:203], v[208:211], 0
    v_perm_b32 v194, v23, v19, s37
    v_perm_b32 v195, v31, v27, s37
    v_mfma_f32_16x16x32_bf16 a[84:87], v[200:203], v[212:215], 0
    s_add_u32 s41, s61, 0xe000
    ds_read_b128 a[248:251], v246 offset:24976
    v_mfma_f32_16x16x32_bf16 a[116:119], v[200:203], v[216:219], 0
    buffer_load_dwordx4 v[92:95], v249, s[12:15], s41 offen
    v_mfma_f32_16x16x32_bf16 a[148:151], v[200:203], v[220:223], 0
    v_mfma_f32_16x16x32_bf16 a[180:183], v[200:203], v[224:227], 0
    v_mfma_f32_16x16x32_bf16 a[212:215], v[200:203], v[228:231], 0
    v_perm_b32 v196, v7, v3, s38
    v_perm_b32 v197, v15, v11, s38
    v_mfma_f32_16x16x32_bf16 a[24:27], v[192:195], v[204:207], 0
    s_add_u32 m0, s48, 0x71c0
    v_perm_b32 v198, v23, v19, s38
    v_perm_b32 v199, v31, v27, s38
    v_mfma_f32_16x16x32_bf16 a[56:59], v[192:195], v[208:211], 0
    s_bfe_u32 s50, s59, 0x40000
    v_mfma_f32_16x16x32_bf16 a[88:91], v[192:195], v[212:215], 0
    s_lshl_b32 s50, s50, 14
    v_mfma_f32_16x16x32_bf16 a[120:123], v[192:195], v[216:219], 0
    s_add_u32 s50, s50, s5
    v_mfma_f32_16x16x32_bf16 a[152:155], v[192:195], v[220:223], 0
    buffer_load_dwordx4 v248, s[8:11], s50 offen lds
    v_mfma_f32_16x16x32_bf16 a[184:187], v[192:195], v[224:227], 0
    s_add_u32 m0, s48, 0x8200
    v_mfma_f32_16x16x32_bf16 a[216:219], v[192:195], v[228:231], 0
    s_waitcnt vmcnt(13)
    v_perm_b32 v200, v36, v32, s37
    v_perm_b32 v201, v44, v40, s37
    v_mfma_f32_16x16x32_bf16 a[28:31], v[196:199], v[204:207], 0
    s_bfe_u32 s50, s59, 0x40004
    s_lshl_b32 s50, s50, 14
    s_add_u32 s50, s50, s5
    v_mfma_f32_16x16x32_bf16 a[60:63], v[196:199], v[208:211], 0
    buffer_load_dwordx4 v248, s[8:11], s50 offen lds
    v_mfma_f32_16x16x32_bf16 a[92:95], v[196:199], v[212:215], 0
    s_waitcnt vmcnt(10)
    v_perm_b32 v202, v52, v48, s37
    v_perm_b32 v203, v60, v56, s37
    v_mfma_f32_16x16x32_bf16 a[124:127], v[196:199], v[216:219], 0
    s_add_u32 m0, s48, 0x9240
    v_mfma_f32_16x16x32_bf16 a[156:159], v[196:199], v[220:223], 0
    s_bfe_u32 s50, s59, 0x40008
    s_lshl_b32 s50, s50, 14
    s_add_u32 s50, s50, s5
    v_mfma_f32_16x16x32_bf16 a[188:191], v[196:199], v[224:227], 0
    buffer_load_dwordx4 v248, s[8:11], s50 offen lds
    v_mfma_f32_16x16x32_bf16 a[220:223], v[196:199], v[228:231], 0
    s_waitcnt lgkmcnt(0)
    v_perm_b32 v192, v36, v32, s38
    v_perm_b32 v193, v44, v40, s38
    v_mfma_f32_16x16x32_bf16 a[0:3], v[200:203], a[224:227], a[0:3]
    s_add_u32 m0, s48, 0xa280
    v_perm_b32 v194, v52, v48, s38
    v_perm_b32 v195, v60, v56, s38
    v_mfma_f32_16x16x32_bf16 a[32:35], v[200:203], a[228:231], a[32:35]
    s_bfe_u32 s50, s59, 0x4000c
    s_lshl_b32 s50, s50, 14
    s_add_u32 s50, s50, s5
    v_mfma_f32_16x16x32_bf16 a[64:67], v[200:203], a[232:235], a[64:67]
    buffer_load_dwordx4 v248, s[8:11], s50 offen lds
    v_mfma_f32_16x16x32_bf16 a[96:99], v[200:203], a[236:239], a[96:99]
    s_add_u32 m0, s48, 0xb2c0
    v_mfma_f32_16x16x32_bf16 a[128:131], v[200:203], a[240:243], a[128:131]
    s_bfe_u32 s50, s59, 0x40010
    v_mfma_f32_16x16x32_bf16 a[160:163], v[200:203], a[244:247], a[160:163]
    s_lshl_b32 s50, s50, 14
    v_mfma_f32_16x16x32_bf16 a[192:195], v[200:203], a[248:251], a[192:195]
    s_add_u32 s50, s50, s5
    v_perm_b32 v196, v37, v33, s37
    v_perm_b32 v197, v45, v41, s37
    v_mfma_f32_16x16x32_bf16 a[4:7], v[192:195], a[224:227], a[4:7]
    buffer_load_dwordx4 v248, s[8:11], s50 offen lds
    v_mfma_f32_16x16x32_bf16 a[36:39], v[192:195], a[228:231], a[36:39]
    s_add_u32 m0, s48, 0xc300
    v_perm_b32 v198, v53, v49, s37
    v_perm_b32 v199, v61, v57, s37
    v_mfma_f32_16x16x32_bf16 a[68:71], v[192:195], a[232:235], a[68:71]
    s_bfe_u32 s50, s59, 0x40014
    ds_read_b128 v[204:207], v254 offset:0
    v_mfma_f32_16x16x32_bf16 a[100:103], v[192:195], a[236:239], a[100:103]
    s_lshl_b32 s50, s50, 14
    s_add_u32 s50, s50, s5
    v_mfma_f32_16x16x32_bf16 a[132:135], v[192:195], a[240:243], a[132:135]
    buffer_load_dwordx4 v248, s[8:11], s50 offen lds
    v_mfma_f32_16x16x32_bf16 a[164:167], v[192:195], a[244:247], a[164:167]
    s_add_u32 m0, s48, 0xd340
    ds_read_b128 v[208:211], v254 offset:4160
    v_mfma_f32_16x16x32_bf16 a[196:199], v[192:195], a[248:251], a[196:199]
    s_bfe_u32 s50, s59, 0x40018
    v_perm_b32 v200, v37, v33, s38
    v_perm_b32 v201, v45, v41, s38
    v_mfma_f32_16x16x32_bf16 a[8:11], v[196:199], a[224:227], a[8:11]
    s_lshl_b32 s50, s50, 14
    s_add_u32 s50, s50, s5
    v_perm_b32 v202, v53, v49, s38
    v_mfma_f32_16x16x32_bf16 a[40:43], v[196:199], a[228:231], a[40:43]
    buffer_load_dwordx4 v248, s[8:11], s50 offen lds
    v_mfma_f32_16x16x32_bf16 a[72:75], v[196:199], a[232:235], a[72:75]
    s_add_u32 s40, s61, 0x10000
    ds_read_b128 v[212:215], v254 offset:8320
    v_perm_b32 v203, v61, v57, s38
    v_mfma_f32_16x16x32_bf16 a[104:107], v[196:199], a[236:239], a[104:107]
    buffer_load_dwordx4 v[96:99], v249, s[12:15], s40 offen
    v_mfma_f32_16x16x32_bf16 a[136:139], v[196:199], a[240:243], a[136:139]
    s_add_u32 s41, s61, 0x12000
    v_mfma_f32_16x16x32_bf16 a[168:171], v[196:199], a[244:247], a[168:171]
    buffer_load_dwordx4 v[100:103], v249, s[12:15], s41 offen
    v_mfma_f32_16x16x32_bf16 a[200:203], v[196:199], a[248:251], a[200:203]
    s_mov_b32 s5, s69
    v_perm_b32 v192, v38, v34, s37
    v_perm_b32 v193, v46, v42, s37
    v_mfma_f32_16x16x32_bf16 a[12:15], v[200:203], a[224:227], a[12:15]
    v_perm_b32 v194, v54, v50, s37
    v_perm_b32 v195, v62, v58, s37
    v_mfma_f32_16x16x32_bf16 a[44:47], v[200:203], a[228:231], a[44:47]
    s_add_u32 s40, s61, 0x14000
    ds_read_b128 v[216:219], v254 offset:12480
    v_mfma_f32_16x16x32_bf16 a[76:79], v[200:203], a[232:235], a[76:79]
    buffer_load_dwordx4 v[104:107], v249, s[12:15], s40 offen
    v_mfma_f32_16x16x32_bf16 a[108:111], v[200:203], a[236:239], a[108:111]
    v_mfma_f32_16x16x32_bf16 a[140:143], v[200:203], a[240:243], a[140:143]
    v_mfma_f32_16x16x32_bf16 a[172:175], v[200:203], a[244:247], a[172:175]
    s_add_u32 s41, s61, 0x16000
    ds_read_b128 v[220:223], v254 offset:16640
    v_mfma_f32_16x16x32_bf16 a[204:207], v[200:203], a[248:251], a[204:207]
    buffer_load_dwordx4 v[108:111], v249, s[12:15], s41 offen
    v_mfma_f32_16x16x32_bf16 a[16:19], v[192:195], a[224:227], a[16:19]
    v_perm_b32 v196, v38, v34, s38
    v_perm_b32 v197, v46, v42, s38
    v_mfma_f32_16x16x32_bf16 a[48:51], v[192:195], a[228:231], a[48:51]
    v_perm_b32 v198, v54, v50, s38
    v_perm_b32 v199, v62, v58, s38
    v_mfma_f32_16x16x32_bf16 a[80:83], v[192:195], a[232:235], a[80:83]
    s_add_u32 s40, s61, 0x18000
    v_mfma_f32_16x16x32_bf16 a[112:115], v[192:195], a[236:239], a[112:115]
    buffer_load_dwordx4 v[112:115], v249, s[12:15], s40 offen
    v_mfma_f32_16x16x32_bf16 a[144:147], v[192:195], a[240:243], a[144:147]
    ds_read_b128 v[224:227], v254 offset:20800
    v_mfma_f32_16x16x32_bf16 a[176:179], v[192:195], a[244:247], a[176:179]
    v_mfma_f32_16x16x32_bf16 a[208:211], v[192:195], a[248:251], a[208:211]
    s_add_u32 s41, s61, 0x1a000
    v_perm_b32 v200, v39, v35, s37
    v_perm_b32 v201, v47, v43, s37
    v_mfma_f32_16x16x32_bf16 a[20:23], v[196:199], a[224:227], a[20:23]
    buffer_load_dwordx4 v[116:119], v249, s[12:15], s41 offen
    v_mfma_f32_16x16x32_bf16 a[52:55], v[196:199], a[228:231], a[52:55]
    v_perm_b32 v202, v55, v51, s37
    v_perm_b32 v203, v63, v59, s37
    v_mfma_f32_16x16x32_bf16 a[84:87], v[196:199], a[232:235], a[84:87]
    ds_read_b128 v[228:231], v254 offset:24960
    v_mfma_f32_16x16x32_bf16 a[116:119], v[196:199], a[236:239], a[116:119]
    s_add_u32 s40, s61, 0x1c000
    v_mfma_f32_16x16x32_bf16 a[148:151], v[196:199], a[240:243], a[148:151]
    buffer_load_dwordx4 v[120:123], v249, s[12:15], s40 offen
    v_mfma_f32_16x16x32_bf16 a[180:183], v[196:199], a[244:247], a[180:183]
    v_mfma_f32_16x16x32_bf16 a[212:215], v[196:199], a[248:251], a[212:215]
    v_perm_b32 v192, v39, v35, s38
    v_perm_b32 v193, v47, v43, s38
    v_mfma_f32_16x16x32_bf16 a[24:27], v[200:203], a[224:227], a[24:27]
    s_add_u32 s41, s61, 0x1e000
    v_perm_b32 v194, v55, v51, s38
    v_perm_b32 v195, v63, v59, s38
    v_mfma_f32_16x16x32_bf16 a[56:59], v[200:203], a[228:231], a[56:59]
    buffer_load_dwordx4 v[124:127], v249, s[12:15], s41 offen
    v_mfma_f32_16x16x32_bf16 a[88:91], v[200:203], a[232:235], a[88:91]
    s_mov_b32 s61, s101
    v_mfma_f32_16x16x32_bf16 a[120:123], v[200:203], a[236:239], a[120:123]
    v_mfma_f32_16x16x32_bf16 a[152:155], v[200:203], a[240:243], a[152:155]
    v_mfma_f32_16x16x32_bf16 a[184:187], v[200:203], a[244:247], a[184:187]
    s_add_u32 s40, s62, 0
    v_mfma_f32_16x16x32_bf16 a[216:219], v[200:203], a[248:251], a[216:219]
    buffer_load_dwordx4 v[128:131], v249, s[12:15], s40 offen
    v_mfma_f32_16x16x32_bf16 a[28:31], v[192:195], a[224:227], a[28:31]
    s_waitcnt vmcnt(20)
    v_perm_b32 v196, v68, v64, s37
    v_perm_b32 v197, v76, v72, s37
    v_mfma_f32_16x16x32_bf16 a[60:63], v[192:195], a[228:231], a[60:63]
    s_waitcnt vmcnt(16)
    v_perm_b32 v198, v84, v80, s37
    v_perm_b32 v199, v92, v88, s37
    v_mfma_f32_16x16x32_bf16 a[92:95], v[192:195], a[232:235], a[92:95]
    v_mfma_f32_16x16x32_bf16 a[124:127], v[192:195], a[236:239], a[124:127]
    s_add_u32 s41, s62, 0x2000
    v_mfma_f32_16x16x32_bf16 a[156:159], v[192:195], a[240:243], a[156:159]
    buffer_load_dwordx4 v[132:135], v249, s[12:15], s41 offen
    v_mfma_f32_16x16x32_bf16 a[188:191], v[192:195], a[244:247], a[188:191]
    s_add_u32 s40, s62, 0x4000
    v_mfma_f32_16x16x32_bf16 a[220:223], v[192:195], a[248:251], a[220:223]
    s_waitcnt lgkmcnt(0)
    buffer_load_dwordx4 v[136:139], v249, s[12:15], s40 offen
    v_mfma_f32_16x16x32_bf16 a[0:3], v[196:199], v[204:207], a[0:3]
    v_perm_b32 v200, v68, v64, s38
    v_perm_b32 v201, v76, v72, s38
    v_mfma_f32_16x16x32_bf16 a[32:35], v[196:199], v[208:211], a[32:35]
    s_add_u32 s41, s62, 0x6000
    v_perm_b32 v202, v84, v80, s38
    v_perm_b32 v203, v92, v88, s38
    v_mfma_f32_16x16x32_bf16 a[64:67], v[196:199], v[212:215], a[64:67]
    buffer_load_dwordx4 v[140:143], v249, s[12:15], s41 offen
    v_mfma_f32_16x16x32_bf16 a[96:99], v[196:199], v[216:219], a[96:99]
    v_mfma_f32_16x16x32_bf16 a[128:131], v[196:199], v[220:223], a[128:131]
    v_mfma_f32_16x16x32_bf16 a[160:163], v[196:199], v[224:227], a[160:163]
    s_add_u32 s40, s62, 0x8000
    v_mfma_f32_16x16x32_bf16 a[192:195], v[196:199], v[228:231], a[192:195]
    buffer_load_dwordx4 v[144:147], v249, s[12:15], s40 offen
    v_mfma_f32_16x16x32_bf16 a[4:7], v[200:203], v[204:207], a[4:7]
    v_perm_b32 v192, v69, v65, s37
    v_perm_b32 v193, v77, v73, s37
    v_mfma_f32_16x16x32_bf16 a[36:39], v[200:203], v[208:211], a[36:39]
    v_perm_b32 v194, v85, v81, s37
    v_perm_b32 v195, v93, v89, s37
    v_mfma_f32_16x16x32_bf16 a[68:71], v[200:203], v[212:215], a[68:71]
    s_add_u32 s41, s62, 0xa000
    ds_read_b128 a[224:227], v254 offset:16
    v_mfma_f32_16x16x32_bf16 a[100:103], v[200:203], v[216:219], a[100:103]
    buffer_load_dwordx4 v[148:151], v249, s[12:15], s41 offen
    v_mfma_f32_16x16x32_bf16 a[132:135], v[200:203], v[220:223], a[132:135]
    ds_read_b128 a[228:231], v254 offset:4176
    v_mfma_f32_16x16x32_bf16 a[164:167], v[200:203], v[224:227], a[164:167]
    v_mfma_f32_16x16x32_bf16 a[196:199], v[200:203], v[228:231], a[196:199]
    s_add_u32 s40, s62, 0xc000
    v_perm_b32 v196, v69, v65, s38
    v_perm_b32 v197, v77, v73, s38
    v_mfma_f32_16x16x32_bf16 a[8:11], v[192:195], v[204:207], a[8:11]
    buffer_load_dwordx4 v[152:155], v249, s[12:15], s40 offen
    v_mfma_f32_16x16x32_bf16 a[40:43], v[192:195], v[208:211], a[40:43]
    v_perm_b32 v198, v85, v81, s38
    v_perm_b32 v199, v93, v89, s38
    v_mfma_f32_16x16x32_bf16 a[72:75], v[192:195], v[212:215], a[72:75]
    ds_read_b128 a[232:235], v254 offset:8336
    v_mfma_f32_16x16x32_bf16 a[104:107], v[192:195], v[216:219], a[104:107]
    s_add_u32 s41, s62, 0xe000
    v_mfma_f32_16x16x32_bf16 a[136:139], v[192:195], v[220:223], a[136:139]
    buffer_load_dwordx4 v[156:159], v249, s[12:15], s41 offen
    v_mfma_f32_16x16x32_bf16 a[168:171], v[192:195], v[224:227], a[168:171]
    v_mfma_f32_16x16x32_bf16 a[200:203], v[192:195], v[228:231], a[200:203]
    v_perm_b32 v200, v70, v66, s37
    v_perm_b32 v201, v78, v74, s37
    v_mfma_f32_16x16x32_bf16 a[12:15], v[196:199], v[204:207], a[12:15]
    v_perm_b32 v202, v86, v82, s37
    v_perm_b32 v203, v94, v90, s37
    v_mfma_f32_16x16x32_bf16 a[44:47], v[196:199], v[208:211], a[44:47]
    s_add_u32 s40, s62, 0x10000
    ds_read_b128 a[236:239], v254 offset:12496
    v_mfma_f32_16x16x32_bf16 a[76:79], v[196:199], v[212:215], a[76:79]
    buffer_load_dwordx4 v[160:163], v249, s[12:15], s40 offen
    v_mfma_f32_16x16x32_bf16 a[108:111], v[196:199], v[216:219], a[108:111]
    s_add_u32 s41, s62, 0x12000
    v_mfma_f32_16x16x32_bf16 a[140:143], v[196:199], v[220:223], a[140:143]
    buffer_load_dwordx4 v[164:167], v249, s[12:15], s41 offen
    v_mfma_f32_16x16x32_bf16 a[172:175], v[196:199], v[224:227], a[172:175]
    ds_read_b128 a[240:243], v254 offset:16656
    v_mfma_f32_16x16x32_bf16 a[204:207], v[196:199], v[228:231], a[204:207]
    v_perm_b32 v192, v70, v66, s38
    v_perm_b32 v193, v78, v74, s38
    v_mfma_f32_16x16x32_bf16 a[16:19], v[200:203], v[204:207], a[16:19]
    s_add_u32 s40, s62, 0x14000
    v_perm_b32 v194, v86, v82, s38
    v_perm_b32 v195, v94, v90, s38
    v_mfma_f32_16x16x32_bf16 a[48:51], v[200:203], v[208:211], a[48:51]
    buffer_load_dwordx4 v[168:171], v249, s[12:15], s40 offen
    v_mfma_f32_16x16x32_bf16 a[80:83], v[200:203], v[212:215], a[80:83]
    v_mfma_f32_16x16x32_bf16 a[112:115], v[200:203], v[216:219], a[112:115]
    ds_read_b128 a[244:247], v254 offset:20816
    v_mfma_f32_16x16x32_bf16 a[144:147], v[200:203], v[220:223], a[144:147]
    s_add_u32 s41, s62, 0x16000
    v_mfma_f32_16x16x32_bf16 a[176:179], v[200:203], v[224:227], a[176:179]
    buffer_load_dwordx4 v[172:175], v249, s[12:15], s41 offen
    v_mfma_f32_16x16x32_bf16 a[208:211], v[200:203], v[228:231], a[208:211]
    v_perm_b32 v196, v71, v67, s37
    v_perm_b32 v197, v79, v75, s37
    v_mfma_f32_16x16x32_bf16 a[20:23], v[192:195], v[204:207], a[20:23]
    v_perm_b32 v198, v87, v83, s37
    v_perm_b32 v199, v95, v91, s37
    v_mfma_f32_16x16x32_bf16 a[52:55], v[192:195], v[208:211], a[52:55]
    s_add_u32 s40, s62, 0x18000
    ds_read_b128 a[248:251], v254 offset:24976
    v_mfma_f32_16x16x32_bf16 a[84:87], v[192:195], v[212:215], a[84:87]
    buffer_load_dwordx4 v[176:179], v249, s[12:15], s40 offen
    v_mfma_f32_16x16x32_bf16 a[116:119], v[192:195], v[216:219], a[116:119]
    v_mfma_f32_16x16x32_bf16 a[148:151], v[192:195], v[220:223], a[148:151]
    v_mfma_f32_16x16x32_bf16 a[180:183], v[192:195], v[224:227], a[180:183]
    s_add_u32 s41, s62, 0x1a000
    v_mfma_f32_16x16x32_bf16 a[212:215], v[192:195], v[228:231], a[212:215]
    buffer_load_dwordx4 v[180:183], v249, s[12:15], s41 offen
    v_mfma_f32_16x16x32_bf16 a[24:27], v[196:199], v[204:207], a[24:27]
    v_perm_b32 v200, v71, v67, s38
    v_perm_b32 v201, v79, v75, s38
    v_mfma_f32_16x16x32_bf16 a[56:59], v[196:199], v[208:211], a[56:59]
    v_perm_b32 v202, v87, v83, s38
    v_perm_b32 v203, v95, v91, s38
    v_mfma_f32_16x16x32_bf16 a[88:91], v[196:199], v[212:215], a[88:91]
    s_add_u32 s40, s62, 0x1c000
    v_mfma_f32_16x16x32_bf16 a[120:123], v[196:199], v[216:219], a[120:123]
    buffer_load_dwordx4 v[184:187], v249, s[12:15], s40 offen
    v_mfma_f32_16x16x32_bf16 a[152:155], v[196:199], v[220:223], a[152:155]
    v_mfma_f32_16x16x32_bf16 a[184:187], v[196:199], v[224:227], a[184:187]
    v_mfma_f32_16x16x32_bf16 a[216:219], v[196:199], v[228:231], a[216:219]
    s_waitcnt vmcnt(19)
    v_perm_b32 v192, v100, v96, s37
    v_perm_b32 v193, v108, v104, s37
    v_mfma_f32_16x16x32_bf16 a[28:31], v[200:203], v[204:207], a[28:31]
    s_waitcnt vmcnt(15)
    v_perm_b32 v194, v116, v112, s37
    v_perm_b32 v195, v124, v120, s37
    v_mfma_f32_16x16x32_bf16 a[60:63], v[200:203], v[208:211], a[60:63]
    v_mfma_f32_16x16x32_bf16 a[92:95], v[200:203], v[212:215], a[92:95]
    s_add_u32 s41, s62, 0x1e000
    v_mfma_f32_16x16x32_bf16 a[124:127], v[200:203], v[216:219], a[124:127]
    buffer_load_dwordx4 v[188:191], v249, s[12:15], s41 offen
    v_mfma_f32_16x16x32_bf16 a[156:159], v[200:203], v[220:223], a[156:159]
    s_add_u32 m0, s48, 0xe380
    v_mfma_f32_16x16x32_bf16 a[188:191], v[200:203], v[224:227], a[188:191]
    s_bfe_u32 s50, s59, 0x40000
    v_mfma_f32_16x16x32_bf16 a[220:223], v[200:203], v[228:231], a[220:223]
    s_waitcnt lgkmcnt(0)
    v_perm_b32 v196, v100, v96, s38
    v_perm_b32 v197, v108, v104, s38
    v_mfma_f32_16x16x32_bf16 a[0:3], v[192:195], a[224:227], a[0:3]
    s_lshl_b32 s50, s50, 14
    s_add_u32 s50, s50, s6
    v_perm_b32 v198, v116, v112, s38
    v_mfma_f32_16x16x32_bf16 a[32:35], v[192:195], a[228:231], a[32:35]
    buffer_load_dwordx4 v248, s[8:11], s50 offen lds
    v_mfma_f32_16x16x32_bf16 a[64:67], v[192:195], a[232:235], a[64:67]
    s_add_u32 m0, s48, 0xf3c0
    v_perm_b32 v199, v124, v120, s38
    v_mfma_f32_16x16x32_bf16 a[96:99], v[192:195], a[236:239], a[96:99]
    s_bfe_u32 s50, s59, 0x40004
    v_mfma_f32_16x16x32_bf16 a[128:131], v[192:195], a[240:243], a[128:131]
    s_lshl_b32 s50, s50, 14
    s_add_u32 s50, s50, s6
    s_barrier
    v_mfma_f32_16x16x32_bf16 a[160:163], v[192:195], a[244:247], a[160:163]
    buffer_load_dwordx4 v248, s[8:11], s50 offen lds
    v_mfma_f32_16x16x32_bf16 a[192:195], v[192:195], a[248:251], a[192:195]
    s_add_u32 m0, s48, 0x10400
    v_perm_b32 v200, v101, v97, s37
    v_perm_b32 v201, v109, v105, s37
    v_mfma_f32_16x16x32_bf16 a[4:7], v[196:199], a[224:227], a[4:7]
    s_bfe_u32 s50, s59, 0x40008
    v_perm_b32 v202, v117, v113, s37
    v_perm_b32 v203, v125, v121, s37
    v_mfma_f32_16x16x32_bf16 a[36:39], v[196:199], a[228:231], a[36:39]
    s_lshl_b32 s50, s50, 14
    ds_read_b128 v[204:207], v246 offset:29120
    s_add_u32 s50, s50, s6
    v_mfma_f32_16x16x32_bf16 a[68:71], v[196:199], a[232:235], a[68:71]
    buffer_load_dwordx4 v248, s[8:11], s50 offen lds
    v_mfma_f32_16x16x32_bf16 a[100:103], v[196:199], a[236:239], a[100:103]
    s_add_u32 m0, s48, 0x11440
    v_mfma_f32_16x16x32_bf16 a[132:135], v[196:199], a[240:243], a[132:135]
    s_bfe_u32 s50, s59, 0x4000c
    ds_read_b128 v[208:211], v246 offset:33280
    v_mfma_f32_16x16x32_bf16 a[164:167], v[196:199], a[244:247], a[164:167]
    s_lshl_b32 s50, s50, 14
    v_mfma_f32_16x16x32_bf16 a[196:199], v[196:199], a[248:251], a[196:199]
    s_add_u32 s50, s50, s6
    v_perm_b32 v192, v101, v97, s38
    v_perm_b32 v193, v109, v105, s38
    v_mfma_f32_16x16x32_bf16 a[8:11], v[200:203], a[224:227], a[8:11]
    buffer_load_dwordx4 v248, s[8:11], s50 offen lds
    v_mfma_f32_16x16x32_bf16 a[40:43], v[200:203], a[228:231], a[40:43]
    s_add_u32 m0, s48, 0x12480
    v_perm_b32 v194, v117, v113, s38
    v_perm_b32 v195, v125, v121, s38
    v_mfma_f32_16x16x32_bf16 a[72:75], v[200:203], a[232:235], a[72:75]
    s_bfe_u32 s50, s59, 0x40010
    ds_read_b128 v[212:215], v246 offset:37440
    v_mfma_f32_16x16x32_bf16 a[104:107], v[200:203], a[236:239], a[104:107]
    s_lshl_b32 s50, s50, 14
    s_add_u32 s50, s50, s6
    v_mfma_f32_16x16x32_bf16 a[136:139], v[200:203], a[240:243], a[136:139]
    buffer_load_dwordx4 v248, s[8:11], s50 offen lds
    v_mfma_f32_16x16x32_bf16 a[168:171], v[200:203], a[244:247], a[168:171]
    s_add_u32 m0, s48, 0x134c0
    v_mfma_f32_16x16x32_bf16 a[200:203], v[200:203], a[248:251], a[200:203]
    s_bfe_u32 s50, s59, 0x40014
    v_perm_b32 v196, v102, v98, s37
    v_perm_b32 v197, v110, v106, s37
    v_mfma_f32_16x16x32_bf16 a[12:15], v[192:195], a[224:227], a[12:15]
    s_lshl_b32 s50, s50, 14
    v_perm_b32 v198, v118, v114, s37
    v_perm_b32 v199, v126, v122, s37
    v_mfma_f32_16x16x32_bf16 a[44:47], v[192:195], a[228:231], a[44:47]
    s_add_u32 s50, s50, s6
    ds_read_b128 v[216:219], v246 offset:41600
    v_mfma_f32_16x16x32_bf16 a[76:79], v[192:195], a[232:235], a[76:79]
    buffer_load_dwordx4 v248, s[8:11], s50 offen lds
    v_mfma_f32_16x16x32_bf16 a[108:111], v[192:195], a[236:239], a[108:111]
    s_add_u32 m0, s48, 0x14500
    v_mfma_f32_16x16x32_bf16 a[140:143], v[192:195], a[240:243], a[140:143]
    s_bfe_u32 s50, s59, 0x40018
    v_mfma_f32_16x16x32_bf16 a[172:175], v[192:195], a[244:247], a[172:175]
    s_lshl_b32 s50, s50, 14
    ds_read_b128 v[220:223], v246 offset:45760
    s_add_u32 s50, s50, s6
    v_mfma_f32_16x16x32_bf16 a[204:207], v[192:195], a[248:251], a[204:207]
    buffer_load_dwordx4 v248, s[8:11], s50 offen lds
    v_mfma_f32_16x16x32_bf16 a[16:19], v[196:199], a[224:227], a[16:19]
    s_mov_b32 s6, 0x4000
    v_perm_b32 v200, v102, v98, s38
    v_perm_b32 v201, v110, v106, s38
    v_mfma_f32_16x16x32_bf16 a[48:51], v[196:199], a[228:231], a[48:51]
    s_mov_b32 s62, L_end-L_s2a
    v_perm_b32 v202, v118, v114, s38
    v_perm_b32 v203, v126, v122, s38
    v_mfma_f32_16x16x32_bf16 a[80:83], v[196:199], a[232:235], a[80:83]
    v_mfma_f32_16x16x32_bf16 a[112:115], v[196:199], a[236:239], a[112:115]
    ds_read_b128 v[224:227], v246 offset:49920
    v_mfma_f32_16x16x32_bf16 a[144:147], v[196:199], a[240:243], a[144:147]
    v_mfma_f32_16x16x32_bf16 a[176:179], v[196:199], a[244:247], a[176:179]
    v_mfma_f32_16x16x32_bf16 a[208:211], v[196:199], a[248:251], a[208:211]
    v_perm_b32 v192, v103, v99, s37
    v_perm_b32 v193, v111, v107, s37
    v_mfma_f32_16x16x32_bf16 a[20:23], v[200:203], a[224:227], a[20:23]
    v_perm_b32 v194, v119, v115, s37
    v_perm_b32 v195, v127, v123, s37
    v_mfma_f32_16x16x32_bf16 a[52:55], v[200:203], a[228:231], a[52:55]
    ds_read_b128 v[228:231], v246 offset:54080
    v_mfma_f32_16x16x32_bf16 a[84:87], v[200:203], a[232:235], a[84:87]
    v_mfma_f32_16x16x32_bf16 a[116:119], v[200:203], a[236:239], a[116:119]
    v_mfma_f32_16x16x32_bf16 a[148:151], v[200:203], a[240:243], a[148:151]
    v_mfma_f32_16x16x32_bf16 a[180:183], v[200:203], a[244:247], a[180:183]
    v_mfma_f32_16x16x32_bf16 a[212:215], v[200:203], a[248:251], a[212:215]
    v_perm_b32 v196, v103, v99, s38
    v_perm_b32 v197, v111, v107, s38
    v_mfma_f32_16x16x32_bf16 a[24:27], v[192:195], a[224:227], a[24:27]
    v_perm_b32 v198, v119, v115, s38
    v_perm_b32 v199, v127, v123, s38
    v_mfma_f32_16x16x32_bf16 a[56:59], v[192:195], a[228:231], a[56:59]
    v_mfma_f32_16x16x32_bf16 a[88:91], v[192:195], a[232:235], a[88:91]
    v_mfma_f32_16x16x32_bf16 a[120:123], v[192:195], a[236:239], a[120:123]
    v_mfma_f32_16x16x32_bf16 a[152:155], v[192:195], a[240:243], a[152:155]
    v_mfma_f32_16x16x32_bf16 a[184:187], v[192:195], a[244:247], a[184:187]
    v_mfma_f32_16x16x32_bf16 a[216:219], v[192:195], a[248:251], a[216:219]
    s_waitcnt vmcnt(19)
    v_perm_b32 v200, v132, v128, s37
    v_perm_b32 v201, v140, v136, s37
    v_mfma_f32_16x16x32_bf16 a[28:31], v[196:199], a[224:227], a[28:31]
    s_waitcnt vmcnt(15)
    v_perm_b32 v202, v148, v144, s37
    v_perm_b32 v203, v156, v152, s37
    v_mfma_f32_16x16x32_bf16 a[60:63], v[196:199], a[228:231], a[60:63]
    s_add_u32 s40, s63, 0
    v_mfma_f32_16x16x32_bf16 a[92:95], v[196:199], a[232:235], a[92:95]
    buffer_load_dwordx4 v[0:3], v249, s[12:15], s40 offen
    v_mfma_f32_16x16x32_bf16 a[124:127], v[196:199], a[236:239], a[124:127]
    s_add_u32 s41, s63, 0x2000
    v_mfma_f32_16x16x32_bf16 a[156:159], v[196:199], a[240:243], a[156:159]
    buffer_load_dwordx4 v[4:7], v249, s[12:15], s41 offen
    v_mfma_f32_16x16x32_bf16 a[188:191], v[196:199], a[244:247], a[188:191]
    v_mfma_f32_16x16x32_bf16 a[220:223], v[196:199], a[248:251], a[220:223]
    s_waitcnt lgkmcnt(0)
    v_perm_b32 v192, v132, v128, s38
    v_perm_b32 v193, v140, v136, s38
    v_mfma_f32_16x16x32_bf16 a[0:3], v[200:203], v[204:207], a[0:3]
    s_add_u32 s40, s63, 0x4000
    v_perm_b32 v194, v148, v144, s38
    v_perm_b32 v195, v156, v152, s38
    v_mfma_f32_16x16x32_bf16 a[32:35], v[200:203], v[208:211], a[32:35]
    buffer_load_dwordx4 v[8:11], v249, s[12:15], s40 offen
    v_mfma_f32_16x16x32_bf16 a[64:67], v[200:203], v[212:215], a[64:67]
    v_mfma_f32_16x16x32_bf16 a[96:99], v[200:203], v[216:219], a[96:99]
    v_mfma_f32_16x16x32_bf16 a[128:131], v[200:203], v[220:223], a[128:131]
    s_add_u32 s41, s63, 0x6000
    v_mfma_f32_16x16x32_bf16 a[160:163], v[200:203], v[224:227], a[160:163]
    buffer_load_dwordx4 v[12:15], v249, s[12:15], s41 offen
    v_mfma_f32_16x16x32_bf16 a[192:195], v[200:203], v[228:231], a[192:195]
    v_perm_b32 v196, v133, v129, s37
    v_perm_b32 v197, v141, v137, s37
    v_mfma_f32_16x16x32_bf16 a[4:7], v[192:195], v[204:207], a[4:7]
    v_perm_b32 v198, v149, v145, s37
    v_perm_b32 v199, v157, v153, s37
    v_mfma_f32_16x16x32_bf16 a[36:39], v[192:195], v[208:211], a[36:39]
    s_add_u32 s40, s63, 0x8000
    ds_read_b128 a[224:227], v246 offset:29136
    v_mfma_f32_16x16x32_bf16 a[68:71], v[192:195], v[212:215], a[68:71]
    buffer_load_dwordx4 v[16:19], v249, s[12:15], s40 offen
    v_mfma_f32_16x16x32_bf16 a[100:103], v[192:195], v[216:219], a[100:103]
    v_mfma_f32_16x16x32_bf16 a[132:135], v[192:195], v[220:223], a[132:135]
    ds_read_b128 a[228:231], v246 offset:33296
    v_mfma_f32_16x16x32_bf16 a[164:167], v[192:195], v[224:227], a[164:167]
    s_add_u32 s41, s63, 0xa000
    v_mfma_f32_16x16x32_bf16 a[196:199], v[192:195], v[228:231], a[196:199]
    buffer_load_dwordx4 v[20:23], v249, s[12:15], s41 offen
    v_mfma_f32_16x16x32_bf16 a[8:11], v[196:199], v[204:207], a[8:11]
    v_perm_b32 v200, v133, v129, s38
    v_perm_b32 v201, v141, v137, s38
    v_mfma_f32_16x16x32_bf16 a[40:43], v[196:199], v[208:211], a[40:43]
    v_perm_b32 v202, v149, v145, s38
    v_perm_b32 v203, v157, v153, s38
    v_mfma_f32_16x16x32_bf16 a[72:75], v[196:199], v[212:215], a[72:75]
    s_add_u32 s40, s63, 0xc000
    ds_read_b128 a[232:235], v246 offset:37456
    v_mfma_f32_16x16x32_bf16 a[104:107], v[196:199], v[216:219], a[104:107]
    buffer_load_dwordx4 v[24:27], v249, s[12:15], s40 offen
    v_mfma_f32_16x16x32_bf16 a[136:139], v[196:199], v[220:223], a[136:139]
    v_mfma_f32_16x16x32_bf16 a[168:171], v[196:199], v[224:227], a[168:171]
    v_mfma_f32_16x16x32_bf16 a[200:203], v[196:199], v[228:231], a[200:203]
    s_add_u32 s41, s63, 0xe000
    v_perm_b32 v192, v134, v130, s37
    v_perm_b32 v193, v142, v138, s37
    v_mfma_f32_16x16x32_bf16 a[12:15], v[200:203], v[204:207], a[12:15]
    buffer_load_dwordx4 v[28:31], v249, s[12:15], s41 offen
    v_mfma_f32_16x16x32_bf16 a[44:47], v[200:203], v[208:211], a[44:47]
    v_perm_b32 v194, v150, v146, s37
    v_perm_b32 v195, v158, v154, s37
    v_mfma_f32_16x16x32_bf16 a[76:79], v[200:203], v[212:215], a[76:79]
    ds_read_b128 a[236:239], v246 offset:41616
    v_mfma_f32_16x16x32_bf16 a[108:111], v[200:203], v[216:219], a[108:111]
    v_mfma_f32_16x16x32_bf16 a[140:143], v[200:203], v[220:223], a[140:143]
    s_add_u32 s40, s63, 0x10000
    v_mfma_f32_16x16x32_bf16 a[172:175], v[200:203], v[224:227], a[172:175]
    buffer_load_dwordx4 v[32:35], v249, s[12:15], s40 offen
    v_mfma_f32_16x16x32_bf16 a[204:207], v[200:203], v[228:231], a[204:207]
    s_add_u32 s41, s63, 0x12000
    v_perm_b32 v196, v134, v130, s38
    v_perm_b32 v197, v142, v138, s38
    v_mfma_f32_16x16x32_bf16 a[16:19], v[192:195], v[204:207], a[16:19]
    buffer_load_dwordx4 v[36:39], v249, s[12:15], s41 offen
    v_mfma_f32_16x16x32_bf16 a[48:51], v[192:195], v[208:211], a[48:51]
    v_perm_b32 v198, v150, v146, s38
    v_perm_b32 v199, v158, v154, s38
    v_mfma_f32_16x16x32_bf16 a[80:83], v[192:195], v[212:215], a[80:83]
    ds_read_b128 a[240:243], v246 offset:45776
    v_mfma_f32_16x16x32_bf16 a[112:115], v[192:195], v[216:219], a[112:115]
    s_add_u32 s40, s63, 0x14000
    ds_read_b128 a[244:247], v246 offset:49936
    v_mfma_f32_16x16x32_bf16 a[144:147], v[192:195], v[220:223], a[144:147]
    buffer_load_dwordx4 v[40:43], v249, s[12:15], s40 offen
    v_mfma_f32_16x16x32_bf16 a[176:179], v[192:195], v[224:227], a[176:179]
    v_mfma_f32_16x16x32_bf16 a[208:211], v[192:195], v[228:231], a[208:211]
    v_perm_b32 v200, v135, v131, s37
    v_perm_b32 v201, v143, v139, s37
    v_mfma_f32_16x16x32_bf16 a[20:23], v[196:199], v[204:207], a[20:23]
    s_add_u32 s41, s63, 0x16000
    v_perm_b32 v202, v151, v147, s37
    v_perm_b32 v203, v159, v155, s37
    v_mfma_f32_16x16x32_bf16 a[52:55], v[196:199], v[208:211], a[52:55]
    buffer_load_dwordx4 v[44:47], v249, s[12:15], s41 offen
    v_mfma_f32_16x16x32_bf16 a[84:87], v[196:199], v[212:215], a[84:87]
    ds_read_b128 a[248:251], v246 offset:54096
    v_add_u32 v246, s52, v251
    v_mfma_f32_16x16x32_bf16 a[116:119], v[196:199], v[216:219], a[116:119]
    v_mfma_f32_16x16x32_bf16 a[148:151], v[196:199], v[220:223], a[148:151]
    s_add_u32 s40, s63, 0x18000
    v_mfma_f32_16x16x32_bf16 a[180:183], v[196:199], v[224:227], a[180:183]
    buffer_load_dwordx4 v[48:51], v249, s[12:15], s40 offen
    v_mfma_f32_16x16x32_bf16 a[212:215], v[196:199], v[228:231], a[212:215]
    v_perm_b32 v192, v135, v131, s38
    v_perm_b32 v193, v143, v139, s38
    v_mfma_f32_16x16x32_bf16 a[24:27], v[200:203], v[204:207], a[24:27]
    v_perm_b32 v194, v151, v147, s38
    v_perm_b32 v195, v159, v155, s38
    v_mfma_f32_16x16x32_bf16 a[56:59], v[200:203], v[208:211], a[56:59]
    s_add_u32 s41, s63, 0x1a000
    v_mfma_f32_16x16x32_bf16 a[88:91], v[200:203], v[212:215], a[88:91]
    buffer_load_dwordx4 v[52:55], v249, s[12:15], s41 offen
    v_mfma_f32_16x16x32_bf16 a[120:123], v[200:203], v[216:219], a[120:123]
    v_mfma_f32_16x16x32_bf16 a[152:155], v[200:203], v[220:223], a[152:155]
    v_mfma_f32_16x16x32_bf16 a[184:187], v[200:203], v[224:227], a[184:187]
    s_add_u32 s40, s63, 0x1c000
    v_mfma_f32_16x16x32_bf16 a[216:219], v[200:203], v[228:231], a[216:219]
    buffer_load_dwordx4 v[56:59], v249, s[12:15], s40 offen
    v_mfma_f32_16x16x32_bf16 a[28:31], v[192:195], v[204:207], a[28:31]
    s_waitcnt vmcnt(26)
    v_perm_b32 v196, v164, v160, s37
    v_perm_b32 v197, v172, v168, s37
    v_mfma_f32_16x16x32_bf16 a[60:63], v[192:195], v[208:211], a[60:63]
    s_waitcnt vmcnt(22)
    v_perm_b32 v198, v180, v176, s37
    v_perm_b32 v199, v188, v184, s37
    v_mfma_f32_16x16x32_bf16 a[92:95], v[192:195], v[212:215], a[92:95]
    s_add_u32 s41, s63, 0x1e000
    v_mfma_f32_16x16x32_bf16 a[124:127], v[192:195], v[216:219], a[124:127]
    buffer_load_dwordx4 v[60:63], v249, s[12:15], s41 offen
    v_mfma_f32_16x16x32_bf16 a[156:159], v[192:195], v[220:223], a[156:159]
    s_mov_b32 s63, 0x20000
    v_mfma_f32_16x16x32_bf16 a[188:191], v[192:195], v[224:227], a[188:191]
    v_mfma_f32_16x16x32_bf16 a[220:223], v[192:195], v[228:231], a[220:223]
    s_waitcnt lgkmcnt(0)
    v_perm_b32 v200, v164, v160, s38
    v_perm_b32 v201, v172, v168, s38
    v_mfma_f32_16x16x32_bf16 a[0:3], v[196:199], a[224:227], a[0:3]
    s_add_u32 s40, s3, 0
    v_perm_b32 v202, v180, v176, s38
    v_perm_b32 v203, v188, v184, s38
    v_mfma_f32_16x16x32_bf16 a[32:35], v[196:199], a[228:231], a[32:35]
    buffer_load_dwordx4 v[64:67], v249, s[12:15], s40 offen
    v_mfma_f32_16x16x32_bf16 a[64:67], v[196:199], a[232:235], a[64:67]
    s_add_u32 s41, s3, 0x2000
    v_mfma_f32_16x16x32_bf16 a[96:99], v[196:199], a[236:239], a[96:99]
    buffer_load_dwordx4 v[68:71], v249, s[12:15], s41 offen
    v_mfma_f32_16x16x32_bf16 a[128:131], v[196:199], a[240:243], a[128:131]
    v_mfma_f32_16x16x32_bf16 a[160:163], v[196:199], a[244:247], a[160:163]
    v_mfma_f32_16x16x32_bf16 a[192:195], v[196:199], a[248:251], a[192:195]
    s_add_u32 s40, s3, 0x4000
    v_perm_b32 v192, v165, v161, s37
    v_perm_b32 v193, v173, v169, s37
    v_mfma_f32_16x16x32_bf16 a[4:7], v[200:203], a[224:227], a[4:7]
    buffer_load_dwordx4 v[72:75], v249, s[12:15], s40 offen
    v_mfma_f32_16x16x32_bf16 a[36:39], v[200:203], a[228:231], a[36:39]
    v_perm_b32 v194, v181, v177, s37
    v_perm_b32 v195, v189, v185, s37
    v_mfma_f32_16x16x32_bf16 a[68:71], v[200:203], a[232:235], a[68:71]
    ds_read_b128 v[204:207], v254 offset:29120
    v_mfma_f32_16x16x32_bf16 a[100:103], v[200:203], a[236:239], a[100:103]
    s_add_u32 s41, s3, 0x6000
    v_mfma_f32_16x16x32_bf16 a[132:135], v[200:203], a[240:243], a[132:135]
    buffer_load_dwordx4 v[76:79], v249, s[12:15], s41 offen
    v_mfma_f32_16x16x32_bf16 a[164:167], v[200:203], a[244:247], a[164:167]
    ds_read_b128 v[208:211], v254 offset:33280
    v_mfma_f32_16x16x32_bf16 a[196:199], v[200:203], a[248:251], a[196:199]
    v_perm_b32 v196, v165, v161, s38
    v_perm_b32 v197, v173, v169, s38
    v_mfma_f32_16x16x32_bf16 a[8:11], v[192:195], a[224:227], a[8:11]
    s_add_u32 s40, s3, 0x8000
    v_perm_b32 v198, v181, v177, s38
    v_perm_b32 v199, v189, v185, s38
    v_mfma_f32_16x16x32_bf16 a[40:43], v[192:195], a[228:231], a[40:43]
    buffer_load_dwordx4 v[80:83], v249, s[12:15], s40 offen
    v_mfma_f32_16x16x32_bf16 a[72:75], v[192:195], a[232:235], a[72:75]
    ds_read_b128 v[212:215], v254 offset:37440
    v_mfma_f32_16x16x32_bf16 a[104:107], v[192:195], a[236:239], a[104:107]
    s_add_u32 s41, s3, 0xa000
    v_mfma_f32_16x16x32_bf16 a[136:139], v[192:195], a[240:243], a[136:139]
    buffer_load_dwordx4 v[84:87], v249, s[12:15], s41 offen
    v_mfma_f32_16x16x32_bf16 a[168:171], v[192:195], a[244:247], a[168:171]
    v_mfma_f32_16x16x32_bf16 a[200:203], v[192:195], a[248:251], a[200:203]
    v_perm_b32 v200, v166, v162, s37
    v_perm_b32 v201, v174, v170, s37
    v_mfma_f32_16x16x32_bf16 a[12:15], v[196:199], a[224:227], a[12:15]
    s_add_u32 s40, s3, 0xc000
    v_perm_b32 v202, v182, v178, s37
    v_perm_b32 v203, v190, v186, s37
    v_mfma_f32_16x16x32_bf16 a[44:47], v[196:199], a[228:231], a[44:47]
    buffer_load_dwordx4 v[88:91], v249, s[12:15], s40 offen
    v_mfma_f32_16x16x32_bf16 a[76:79], v[196:199], a[232:235], a[76:79]
    ds_read_b128 v[216:219], v254 offset:41600
    v_mfma_f32_16x16x32_bf16 a[108:111], v[196:199], a[236:239], a[108:111]
    v_mfma_f32_16x16x32_bf16 a[140:143], v[196:199], a[240:243], a[140:143]
    s_add_u32 s41, s3, 0xe000
    v_mfma_f32_16x16x32_bf16 a[172:175], v[196:199], a[244:247], a[172:175]
    buffer_load_dwordx4 v[92:95], v249, s[12:15], s41 offen
    v_mfma_f32_16x16x32_bf16 a[204:207], v[196:199], a[248:251], a[204:207]
    v_perm_b32 v192, v166, v162, s38
    v_perm_b32 v193, v174, v170, s38
    v_mfma_f32_16x16x32_bf16 a[16:19], v[200:203], a[224:227], a[16:19]
    v_perm_b32 v194, v182, v178, s38
    v_perm_b32 v195, v190, v186, s38
    v_mfma_f32_16x16x32_bf16 a[48:51], v[200:203], a[228:231], a[48:51]
    ds_read_b128 v[220:223], v254 offset:45760
    v_mfma_f32_16x16x32_bf16 a[80:83], v[200:203], a[232:235], a[80:83]
    v_mfma_f32_16x16x32_bf16 a[112:115], v[200:203], a[236:239], a[112:115]
    ds_read_b128 v[224:227], v254 offset:49920
    v_mfma_f32_16x16x32_bf16 a[144:147], v[200:203], a[240:243], a[144:147]
    v_mfma_f32_16x16x32_bf16 a[176:179], v[200:203], a[244:247], a[176:179]
    v_mfma_f32_16x16x32_bf16 a[208:211], v[200:203], a[248:251], a[208:211]
    v_perm_b32 v196, v167, v163, s37
    v_perm_b32 v197, v175, v171, s37
    v_mfma_f32_16x16x32_bf16 a[20:23], v[192:195], a[224:227], a[20:23]
    v_perm_b32 v198, v183, v179, s37
    v_perm_b32 v199, v191, v187, s37
    v_mfma_f32_16x16x32_bf16 a[52:55], v[192:195], a[228:231], a[52:55]
    ds_read_b128 v[228:231], v254 offset:54080
    v_mfma_f32_16x16x32_bf16 a[84:87], v[192:195], a[232:235], a[84:87]
    v_mfma_f32_16x16x32_bf16 a[116:119], v[192:195], a[236:239], a[116:119]
    v_mfma_f32_16x16x32_bf16 a[148:151], v[192:195], a[240:243], a[148:151]
    v_mfma_f32_16x16x32_bf16 a[180:183], v[192:195], a[244:247], a[180:183]
    v_mfma_f32_16x16x32_bf16 a[212:215], v[192:195], a[248:251], a[212:215]
    v_perm_b32 v200, v167, v163, s38
    v_perm_b32 v201, v175, v171, s38
    v_mfma_f32_16x16x32_bf16 a[24:27], v[196:199], a[224:227], a[24:27]
    v_perm_b32 v202, v183, v179, s38
    v_perm_b32 v203, v191, v187, s38
    v_mfma_f32_16x16x32_bf16 a[56:59], v[196:199], a[228:231], a[56:59]
    v_mfma_f32_16x16x32_bf16 a[88:91], v[196:199], a[232:235], a[88:91]
    v_mfma_f32_16x16x32_bf16 a[120:123], v[196:199], a[236:239], a[120:123]
    v_mfma_f32_16x16x32_bf16 a[152:155], v[196:199], a[240:243], a[152:155]
    v_mfma_f32_16x16x32_bf16 a[184:187], v[196:199], a[244:247], a[184:187]
    v_mfma_f32_16x16x32_bf16 a[216:219], v[196:199], a[248:251], a[216:219]
    s_waitcnt vmcnt(20)
    v_perm_b32 v192, v4, v0, s37
    v_perm_b32 v193, v12, v8, s37
    v_mfma_f32_16x16x32_bf16 a[28:31], v[200:203], a[224:227], a[28:31]
    s_waitcnt vmcnt(16)
    v_perm_b32 v194, v20, v16, s37
    v_perm_b32 v195, v28, v24, s37
    v_mfma_f32_16x16x32_bf16 a[60:63], v[200:203], a[228:231], a[60:63]
    v_mfma_f32_16x16x32_bf16 a[92:95], v[200:203], a[232:235], a[92:95]
    v_mfma_f32_16x16x32_bf16 a[124:127], v[200:203], a[236:239], a[124:127]
    v_mfma_f32_16x16x32_bf16 a[156:159], v[200:203], a[240:243], a[156:159]
    v_mfma_f32_16x16x32_bf16 a[188:191], v[200:203], a[244:247], a[188:191]
    v_mfma_f32_16x16x32_bf16 a[220:223], v[200:203], a[248:251], a[220:223]
    s_waitcnt lgkmcnt(0)
    v_perm_b32 v196, v4, v0, s38
    v_perm_b32 v197, v12, v8, s38
    v_mfma_f32_16x16x32_bf16 a[0:3], v[192:195], v[204:207], a[0:3]
    s_add_u32 s40, s3, 0x10000
    v_perm_b32 v198, v20, v16, s38
    v_perm_b32 v199, v28, v24, s38
    v_mfma_f32_16x16x32_bf16 a[32:35], v[192:195], v[208:211], a[32:35]
    buffer_load_dwordx4 v[96:99], v249, s[12:15], s40 offen
    v_mfma_f32_16x16x32_bf16 a[64:67], v[192:195], v[212:215], a[64:67]
    s_add_u32 s41, s3, 0x12000
    v_mfma_f32_16x16x32_bf16 a[96:99], v[192:195], v[216:219], a[96:99]
    buffer_load_dwordx4 v[100:103], v249, s[12:15], s41 offen
    v_mfma_f32_16x16x32_bf16 a[128:131], v[192:195], v[220:223], a[128:131]
    v_mfma_f32_16x16x32_bf16 a[160:163], v[192:195], v[224:227], a[160:163]
    v_mfma_f32_16x16x32_bf16 a[192:195], v[192:195], v[228:231], a[192:195]
    s_add_u32 s40, s3, 0x14000
    v_perm_b32 v200, v5, v1, s37
    v_perm_b32 v201, v13, v9, s37
    v_mfma_f32_16x16x32_bf16 a[4:7], v[196:199], v[204:207], a[4:7]
    buffer_load_dwordx4 v[104:107], v249, s[12:15], s40 offen
    v_mfma_f32_16x16x32_bf16 a[36:39], v[196:199], v[208:211], a[36:39]
    v_perm_b32 v202, v21, v17, s37
    v_perm_b32 v203, v29, v25, s37
    v_mfma_f32_16x16x32_bf16 a[68:71], v[196:199], v[212:215], a[68:71]
    ds_read_b128 a[224:227], v254 offset:29136
    v_mfma_f32_16x16x32_bf16 a[100:103], v[196:199], v[216:219], a[100:103]
    s_add_u32 s41, s3, 0x16000
    v_mfma_f32_16x16x32_bf16 a[132:135], v[196:199], v[220:223], a[132:135]
    buffer_load_dwordx4 v[108:111], v249, s[12:15], s41 offen
    v_mfma_f32_16x16x32_bf16 a[164:167], v[196:199], v[224:227], a[164:167]
    ds_read_b128 a[228:231], v254 offset:33296
    v_mfma_f32_16x16x32_bf16 a[196:199], v[196:199], v[228:231], a[196:199]
    v_perm_b32 v192, v5, v1, s38
    v_perm_b32 v193, v13, v9, s38
    v_mfma_f32_16x16x32_bf16 a[8:11], v[200:203], v[204:207], a[8:11]
    s_add_u32 s40, s3, 0x18000
    v_perm_b32 v194, v21, v17, s38
    v_perm_b32 v195, v29, v25, s38
    v_mfma_f32_16x16x32_bf16 a[40:43], v[200:203], v[208:211], a[40:43]
    buffer_load_dwordx4 v[112:115], v249, s[12:15], s40 offen
    v_mfma_f32_16x16x32_bf16 a[72:75], v[200:203], v[212:215], a[72:75]
    ds_read_b128 a[232:235], v254 offset:37456
    v_mfma_f32_16x16x32_bf16 a[104:107], v[200:203], v[216:219], a[104:107]
    s_add_u32 s41, s3, 0x1a000
    v_mfma_f32_16x16x32_bf16 a[136:139], v[200:203], v[220:223], a[136:139]
    buffer_load_dwordx4 v[116:119], v249, s[12:15], s41 offen
    v_mfma_f32_16x16x32_bf16 a[168:171], v[200:203], v[224:227], a[168:171]
    v_mfma_f32_16x16x32_bf16 a[200:203], v[200:203], v[228:231], a[200:203]
    v_perm_b32 v196, v6, v2, s37
    v_perm_b32 v197, v14, v10, s37
    v_mfma_f32_16x16x32_bf16 a[12:15], v[192:195], v[204:207], a[12:15]
    s_add_u32 s40, s3, 0x1c000
    v_perm_b32 v198, v22, v18, s37
    v_perm_b32 v199, v30, v26, s37
    v_mfma_f32_16x16x32_bf16 a[44:47], v[192:195], v[208:211], a[44:47]
    buffer_load_dwordx4 v[120:123], v249, s[12:15], s40 offen
    v_mfma_f32_16x16x32_bf16 a[76:79], v[192:195], v[212:215], a[76:79]
    ds_read_b128 a[236:239], v254 offset:41616
    v_mfma_f32_16x16x32_bf16 a[108:111], v[192:195], v[216:219], a[108:111]
    v_mfma_f32_16x16x32_bf16 a[140:143], v[192:195], v[220:223], a[140:143]
    s_add_u32 s41, s3, 0x1e000
    v_mfma_f32_16x16x32_bf16 a[172:175], v[192:195], v[224:227], a[172:175]
    buffer_load_dwordx4 v[124:127], v249, s[12:15], s41 offen
    v_mfma_f32_16x16x32_bf16 a[204:207], v[192:195], v[228:231], a[204:207]
    v_perm_b32 v200, v6, v2, s38
    v_perm_b32 v201, v14, v10, s38
    v_mfma_f32_16x16x32_bf16 a[16:19], v[196:199], v[204:207], a[16:19]
    v_perm_b32 v202, v22, v18, s38
    v_perm_b32 v203, v30, v26, s38
    v_mfma_f32_16x16x32_bf16 a[48:51], v[196:199], v[208:211], a[48:51]
    ds_read_b128 a[240:243], v254 offset:45776
    v_mfma_f32_16x16x32_bf16 a[80:83], v[196:199], v[212:215], a[80:83]
    v_mfma_f32_16x16x32_bf16 a[112:115], v[196:199], v[216:219], a[112:115]
    ds_read_b128 a[244:247], v254 offset:49936
    v_mfma_f32_16x16x32_bf16 a[144:147], v[196:199], v[220:223], a[144:147]
    v_mfma_f32_16x16x32_bf16 a[176:179], v[196:199], v[224:227], a[176:179]
    v_mfma_f32_16x16x32_bf16 a[208:211], v[196:199], v[228:231], a[208:211]
    v_perm_b32 v192, v7, v3, s37
    v_perm_b32 v193, v15, v11, s37
    v_mfma_f32_16x16x32_bf16 a[20:23], v[200:203], v[204:207], a[20:23]
    v_perm_b32 v194, v23, v19, s37
    v_perm_b32 v195, v31, v27, s37
    v_mfma_f32_16x16x32_bf16 a[52:55], v[200:203], v[208:211], a[52:55]
    ds_read_b128 a[248:251], v254 offset:54096
    v_add_u32 v254, 57344, v251
    v_mfma_f32_16x16x32_bf16 a[84:87], v[200:203], v[212:215], a[84:87]
    v_mfma_f32_16x16x32_bf16 a[116:119], v[200:203], v[216:219], a[116:119]
    v_mfma_f32_16x16x32_bf16 a[148:151], v[200:203], v[220:223], a[148:151]
    v_mfma_f32_16x16x32_bf16 a[180:183], v[200:203], v[224:227], a[180:183]
    v_mfma_f32_16x16x32_bf16 a[212:215], v[200:203], v[228:231], a[212:215]
    v_perm_b32 v196, v7, v3, s38
    v_perm_b32 v197, v15, v11, s38
    v_mfma_f32_16x16x32_bf16 a[24:27], v[192:195], v[204:207], a[24:27]
    v_perm_b32 v198, v23, v19, s38
    v_perm_b32 v199, v31, v27, s38
    v_mfma_f32_16x16x32_bf16 a[56:59], v[192:195], v[208:211], a[56:59]
    v_mfma_f32_16x16x32_bf16 a[88:91], v[192:195], v[212:215], a[88:91]
    v_mfma_f32_16x16x32_bf16 a[120:123], v[192:195], v[216:219], a[120:123]
    v_mfma_f32_16x16x32_bf16 a[152:155], v[192:195], v[220:223], a[152:155]
    v_mfma_f32_16x16x32_bf16 a[184:187], v[192:195], v[224:227], a[184:187]
    v_mfma_f32_16x16x32_bf16 a[216:219], v[192:195], v[228:231], a[216:219]
    s_waitcnt vmcnt(20)
    v_perm_b32 v200, v36, v32, s37
    v_perm_b32 v201, v44, v40, s37
    v_mfma_f32_16x16x32_bf16 a[28:31], v[196:199], v[204:207], a[28:31]
    s_waitcnt vmcnt(16)
    v_perm_b32 v202, v52, v48, s37
    v_perm_b32 v203, v60, v56, s37
    v_mfma_f32_16x16x32_bf16 a[60:63], v[196:199], v[208:211], a[60:63]
    v_mfma_f32_16x16x32_bf16 a[92:95], v[196:199], v[212:215], a[92:95]
    v_mfma_f32_16x16x32_bf16 a[124:127], v[196:199], v[216:219], a[124:127]
    v_mfma_f32_16x16x32_bf16 a[156:159], v[196:199], v[220:223], a[156:159]
    v_mfma_f32_16x16x32_bf16 a[188:191], v[196:199], v[224:227], a[188:191]
    v_mfma_f32_16x16x32_bf16 a[220:223], v[196:199], v[228:231], a[220:223]
    s_waitcnt lgkmcnt(0)
    v_perm_b32 v192, v36, v32, s38
    v_perm_b32 v193, v44, v40, s38
    v_mfma_f32_16x16x32_bf16 a[0:3], v[200:203], a[224:227], a[0:3]
    v_perm_b32 v194, v52, v48, s38
    v_perm_b32 v195, v60, v56, s38
    v_mfma_f32_16x16x32_bf16 a[32:35], v[200:203], a[228:231], a[32:35]
    v_mfma_f32_16x16x32_bf16 a[64:67], v[200:203], a[232:235], a[64:67]
    s_barrier
    v_mfma_f32_16x16x32_bf16 a[96:99], v[200:203], a[236:239], a[96:99]
    v_mfma_f32_16x16x32_bf16 a[128:131], v[200:203], a[240:243], a[128:131]
    v_mfma_f32_16x16x32_bf16 a[160:163], v[200:203], a[244:247], a[160:163]
    s_add_u32 s40, s81, 0
    v_mfma_f32_16x16x32_bf16 a[192:195], v[200:203], a[248:251], a[192:195]
    buffer_load_dwordx4 v[128:131], v249, s[12:15], s40 offen
    v_mfma_f32_16x16x32_bf16 a[4:7], v[192:195], a[224:227], a[4:7]
    s_add_u32 s41, s81, 0x2000
    v_perm_b32 v196, v37, v33, s37
    v_perm_b32 v197, v45, v41, s37
    v_mfma_f32_16x16x32_bf16 a[36:39], v[192:195], a[228:231], a[36:39]
    buffer_load_dwordx4 v[132:135], v249, s[12:15], s41 offen
    v_mfma_f32_16x16x32_bf16 a[68:71], v[192:195], a[232:235], a[68:71]
    v_perm_b32 v198, v53, v49, s37
    v_perm_b32 v199, v61, v57, s37
    v_mfma_f32_16x16x32_bf16 a[100:103], v[192:195], a[236:239], a[100:103]
    ds_read_b128 v[204:207], v247 offset:0
    v_mfma_f32_16x16x32_bf16 a[132:135], v[192:195], a[240:243], a[132:135]
    s_add_u32 s40, s81, 0x4000
    ds_read_b128 v[208:211], v247 offset:4160
    v_mfma_f32_16x16x32_bf16 a[164:167], v[192:195], a[244:247], a[164:167]
    buffer_load_dwordx4 v[136:139], v249, s[12:15], s40 offen
    v_mfma_f32_16x16x32_bf16 a[196:199], v[192:195], a[248:251], a[196:199]
    v_perm_b32 v200, v37, v33, s38
    v_perm_b32 v201, v45, v41, s38
    v_mfma_f32_16x16x32_bf16 a[8:11], v[196:199], a[224:227], a[8:11]
    v_perm_b32 v202, v53, v49, s38
    v_perm_b32 v203, v61, v57, s38
    v_mfma_f32_16x16x32_bf16 a[40:43], v[196:199], a[228:231], a[40:43]
    s_add_u32 s41, s81, 0x6000
    v_mfma_f32_16x16x32_bf16 a[72:75], v[196:199], a[232:235], a[72:75]
    buffer_load_dwordx4 v[140:143], v249, s[12:15], s41 offen
    v_mfma_f32_16x16x32_bf16 a[104:107], v[196:199], a[236:239], a[104:107]
    ds_read_b128 v[212:215], v247 offset:8320
    v_mfma_f32_16x16x32_bf16 a[136:139], v[196:199], a[240:243], a[136:139]
    v_mfma_f32_16x16x32_bf16 a[168:171], v[196:199], a[244:247], a[168:171]
    s_add_u32 s40, s81, 0x8000
    v_mfma_f32_16x16x32_bf16 a[200:203], v[196:199], a[248:251], a[200:203]
    buffer_load_dwordx4 v[144:147], v249, s[12:15], s40 offen
    v_mfma_f32_16x16x32_bf16 a[12:15], v[200:203], a[224:227], a[12:15]
    v_perm_b32 v192, v38, v34, s37
    v_perm_b32 v193, v46, v42, s37
    v_mfma_f32_16x16x32_bf16 a[44:47], v[200:203], a[228:231], a[44:47]
    v_perm_b32 v194, v54, v50, s37
    v_perm_b32 v195, v62, v58, s37
    v_mfma_f32_16x16x32_bf16 a[76:79], v[200:203], a[232:235], a[76:79]
    s_add_u32 s41, s81, 0xa000
    ds_read_b128 v[216:219], v247 offset:12480
    v_mfma_f32_16x16x32_bf16 a[108:111], v[200:203], a[236:239], a[108:111]
    buffer_load_dwordx4 v[148:151], v249, s[12:15], s41 offen
    v_mfma_f32_16x16x32_bf16 a[140:143], v[200:203], a[240:243], a[140:143]
    v_mfma_f32_16x16x32_bf16 a[172:175], v[200:203], a[244:247], a[172:175]
    ds_read_b128 v[220:223], v247 offset:16640
    v_mfma_f32_16x16x32_bf16 a[204:207], v[200:203], a[248:251], a[204:207]
    s_add_u32 s40, s81, 0xc000
    v_perm_b32 v196, v38, v34, s38
    v_perm_b32 v197, v46, v42, s38
    v_mfma_f32_16x16x32_bf16 a[16:19], v[192:195], a[224:227], a[16:19]
    buffer_load_dwordx4 v[152:155], v249, s[12:15], s40 offen
    v_mfma_f32_16x16x32_bf16 a[48:51], v[192:195], a[228:231], a[48:51]
    v_perm_b32 v198, v54, v50, s38
    v_perm_b32 v199, v62, v58, s38
    v_mfma_f32_16x16x32_bf16 a[80:83], v[192:195], a[232:235], a[80:83]
    v_mfma_f32_16x16x32_bf16 a[112:115], v[192:195], a[236:239], a[112:115]
    s_add_u32 s41, s81, 0xe000
    ds_read_b128 v[224:227], v247 offset:20800
    v_mfma_f32_16x16x32_bf16 a[144:147], v[192:195], a[240:243], a[144:147]
    buffer_load_dwordx4 v[156:159], v249, s[12:15], s41 offen
    v_mfma_f32_16x16x32_bf16 a[176:179], v[192:195], a[244:247], a[176:179]
    v_mfma_f32_16x16x32_bf16 a[208:211], v[192:195], a[248:251], a[208:211]
    v_perm_b32 v200, v39, v35, s37
    v_perm_b32 v201, v47, v43, s37
    v_mfma_f32_16x16x32_bf16 a[20:23], v[196:199], a[224:227], a[20:23]
    v_perm_b32 v202, v55, v51, s37
    v_perm_b32 v203, v63, v59, s37
    v_mfma_f32_16x16x32_bf16 a[52:55], v[196:199], a[228:231], a[52:55]
    s_add_u32 m0, s48, 0x15540
    ds_read_b128 v[228:231], v247 offset:24960
    v_mfma_f32_16x16x32_bf16 a[84:87], v[196:199], a[232:235], a[84:87]
    s_bfe_u32 s50, s59, 0x40000
    v_mfma_f32_16x16x32_bf16 a[116:119], v[196:199], a[236:239], a[116:119]
    s_lshl_b32 s50, s50, 14
    v_mfma_f32_16x16x32_bf16 a[148:151], v[196:199], a[240:243], a[148:151]
    s_add_u32 s50, s50, s7
    v_mfma_f32_16x16x32_bf16 a[180:183], v[196:199], a[244:247], a[180:183]
    buffer_load_dwordx4 v248, s[8:11], s50 offen lds
    v_mfma_f32_16x16x32_bf16 a[212:215], v[196:199], a[248:251], a[212:215]
    s_add_u32 m0, s48, 0x16580
    v_perm_b32 v192, v39, v35, s38
    v_perm_b32 v193, v47, v43, s38
    v_mfma_f32_16x16x32_bf16 a[24:27], v[200:203], a[224:227], a[24:27]
    s_bfe_u32 s50, s59, 0x40004
    v_perm_b32 v194, v55, v51, s38
    v_perm_b32 v195, v63, v59, s38
    v_mfma_f32_16x16x32_bf16 a[56:59], v[200:203], a[228:231], a[56:59]
    s_lshl_b32 s50, s50, 14
    s_add_u32 s50, s50, s7
    v_mfma_f32_16x16x32_bf16 a[88:91], v[200:203], a[232:235], a[88:91]
    buffer_load_dwordx4 v248, s[8:11], s50 offen lds
    v_mfma_f32_16x16x32_bf16 a[120:123], v[200:203], a[236:239], a[120:123]
    s_add_u32 m0, s48, 0x175c0
    v_mfma_f32_16x16x32_bf16 a[152:155], v[200:203], a[240:243], a[152:155]
    s_bfe_u32 s50, s59, 0x40008
    v_mfma_f32_16x16x32_bf16 a[184:187], v[200:203], a[244:247], a[184:187]
    s_lshl_b32 s50, s50, 14
    s_add_u32 s50, s50, s7
    v_mfma_f32_16x16x32_bf16 a[216:219], v[200:203], a[248:251], a[216:219]
    buffer_load_dwordx4 v248, s[8:11], s50 offen lds
    v_mfma_f32_16x16x32_bf16 a[28:31], v[192:195], a[224:227], a[28:31]
    s_waitcnt vmcnt(23)
    v_perm_b32 v196, v68, v64, s37
    v_perm_b32 v197, v76, v72, s37
    v_mfma_f32_16x16x32_bf16 a[60:63], v[192:195], a[228:231], a[60:63]
    s_waitcnt vmcnt(19)
    v_perm_b32 v198, v84, v80, s37
    v_perm_b32 v199, v92, v88, s37
    v_mfma_f32_16x16x32_bf16 a[92:95], v[192:195], a[232:235], a[92:95]
    s_add_u32 m0, s48, 0x18600
    v_mfma_f32_16x16x32_bf16 a[124:127], v[192:195], a[236:239], a[124:127]
    s_bfe_u32 s50, s59, 0x4000c
    s_lshl_b32 s50, s50, 14
    s_add_u32 s50, s50, s7
    v_mfma_f32_16x16x32_bf16 a[156:159], v[192:195], a[240:243], a[156:159]
    buffer_load_dwordx4 v248, s[8:11], s50 offen lds
    v_mfma_f32_16x16x32_bf16 a[188:191], v[192:195], a[244:247], a[188:191]
    s_add_u32 m0, s48, 0x19640
    v_mfma_f32_16x16x32_bf16 a[220:223], v[192:195], a[248:251], a[220:223]
    s_waitcnt lgkmcnt(0)
    v_perm_b32 v200, v68, v64, s38
    v_perm_b32 v201, v76, v72, s38
    v_mfma_f32_16x16x32_bf16 a[0:3], v[196:199], v[204:207], a[0:3]
    s_bfe_u32 s50, s59, 0x40010
    s_lshl_b32 s50, s50, 14
    s_add_u32 s50, s50, s7
    v_mfma_f32_16x16x32_bf16 a[32:35], v[196:199], v[208:211], a[32:35]
    buffer_load_dwordx4 v248, s[8:11], s50 offen lds
    v_mfma_f32_16x16x32_bf16 a[64:67], v[196:199], v[212:215], a[64:67]
    s_add_u32 m0, s48, 0x1a680
    v_perm_b32 v202, v84, v80, s38
    v_perm_b32 v203, v92, v88, s38
    v_mfma_f32_16x16x32_bf16 a[96:99], v[196:199], v[216:219], a[96:99]
    s_bfe_u32 s50, s59, 0x40014
    v_mfma_f32_16x16x32_bf16 a[128:131], v[196:199], v[220:223], a[128:131]
    s_lshl_b32 s50, s50, 14
    v_mfma_f32_16x16x32_bf16 a[160:163], v[196:199], v[224:227], a[160:163]
    s_add_u32 s50, s50, s7
    v_mfma_f32_16x16x32_bf16 a[192:195], v[196:199], v[228:231], a[192:195]
    buffer_load_dwordx4 v248, s[8:11], s50 offen lds
    v_mfma_f32_16x16x32_bf16 a[4:7], v[200:203], v[204:207], a[4:7]
    s_add_u32 m0, s48, 0x1b6c0
    v_perm_b32 v192, v69, v65, s37
    v_perm_b32 v193, v77, v73, s37
    v_mfma_f32_16x16x32_bf16 a[36:39], v[200:203], v[208:211], a[36:39]
    s_bfe_u32 s50, s59, 0x40018
    v_perm_b32 v194, v85, v81, s37
    v_perm_b32 v195, v93, v89, s37
    v_mfma_f32_16x16x32_bf16 a[68:71], v[200:203], v[212:215], a[68:71]
    s_lshl_b32 s50, s50, 14
    ds_read_b128 a[224:227], v247 offset:16
    s_add_u32 s50, s50, s7
    v_mfma_f32_16x16x32_bf16 a[100:103], v[200:203], v[216:219], a[100:103]
    buffer_load_dwordx4 v248, s[8:11], s50 offen lds
    v_mfma_f32_16x16x32_bf16 a[132:135], v[200:203], v[220:223], a[132:135]
    s_add_u32 s40, s81, 0x10000
    ds_read_b128 a[228:231], v247 offset:4176
    v_add_u32 v248, 16384, v250
    v_mfma_f32_16x16x32_bf16 a[164:167], v[200:203], v[224:227], a[164:167]
    buffer_load_dwordx4 v[160:163], v249, s[12:15], s40 offen
    v_mfma_f32_16x16x32_bf16 a[196:199], v[200:203], v[228:231], a[196:199]
    s_add_u32 s41, s81, 0x12000
    v_perm_b32 v196, v69, v65, s38
    v_perm_b32 v197, v77, v73, s38
    v_mfma_f32_16x16x32_bf16 a[8:11], v[192:195], v[204:207], a[8:11]
    buffer_load_dwordx4 v[164:167], v249, s[12:15], s41 offen
    v_mfma_f32_16x16x32_bf16 a[40:43], v[192:195], v[208:211], a[40:43]
    s_mov_b32 s7, 0x20000
    v_perm_b32 v198, v85, v81, s38
    v_perm_b32 v199, v93, v89, s38
    v_mfma_f32_16x16x32_bf16 a[72:75], v[192:195], v[212:215], a[72:75]
    ds_read_b128 a[232:235], v247 offset:8336
    v_mfma_f32_16x16x32_bf16 a[104:107], v[192:195], v[216:219], a[104:107]
    s_add_u32 s40, s81, 0x14000
    v_mfma_f32_16x16x32_bf16 a[136:139], v[192:195], v[220:223], a[136:139]
    buffer_load_dwordx4 v[168:171], v249, s[12:15], s40 offen
    v_mfma_f32_16x16x32_bf16 a[168:171], v[192:195], v[224:227], a[168:171]
    v_mfma_f32_16x16x32_bf16 a[200:203], v[192:195], v[228:231], a[200:203]
    v_perm_b32 v200, v70, v66, s37
    v_perm_b32 v201, v78, v74, s37
    v_mfma_f32_16x16x32_bf16 a[12:15], v[196:199], v[204:207], a[12:15]
    s_add_u32 s41, s81, 0x16000
    v_perm_b32 v202, v86, v82, s37
    v_perm_b32 v203, v94, v90, s37
    v_mfma_f32_16x16x32_bf16 a[44:47], v[196:199], v[208:211], a[44:47]
    buffer_load_dwordx4 v[172:175], v249, s[12:15], s41 offen
    v_mfma_f32_16x16x32_bf16 a[76:79], v[196:199], v[212:215], a[76:79]
    ds_read_b128 a[236:239], v247 offset:12496
    v_mfma_f32_16x16x32_bf16 a[108:111], v[196:199], v[216:219], a[108:111]
    v_mfma_f32_16x16x32_bf16 a[140:143], v[196:199], v[220:223], a[140:143]
    s_add_u32 s40, s81, 0x18000
    v_mfma_f32_16x16x32_bf16 a[172:175], v[196:199], v[224:227], a[172:175]
    buffer_load_dwordx4 v[176:179], v249, s[12:15], s40 offen
    v_mfma_f32_16x16x32_bf16 a[204:207], v[196:199], v[228:231], a[204:207]
    v_perm_b32 v192, v70, v66, s38
    v_perm_b32 v193, v78, v74, s38
    v_mfma_f32_16x16x32_bf16 a[16:19], v[200:203], v[204:207], a[16:19]
    v_perm_b32 v194, v86, v82, s38
    v_perm_b32 v195, v94, v90, s38
    v_mfma_f32_16x16x32_bf16 a[48:51], v[200:203], v[208:211], a[48:51]
    s_add_u32 s41, s81, 0x1a000
    ds_read_b128 a[240:243], v247 offset:16656
    v_mfma_f32_16x16x32_bf16 a[80:83], v[200:203], v[212:215], a[80:83]
    buffer_load_dwordx4 v[180:183], v249, s[12:15], s41 offen
    v_mfma_f32_16x16x32_bf16 a[112:115], v[200:203], v[216:219], a[112:115]
    ds_read_b128 a[244:247], v247 offset:20816
    v_mfma_f32_16x16x32_bf16 a[144:147], v[200:203], v[220:223], a[144:147]
    v_mfma_f32_16x16x32_bf16 a[176:179], v[200:203], v[224:227], a[176:179]
    s_add_u32 s40, s81, 0x1c000
    v_mfma_f32_16x16x32_bf16 a[208:211], v[200:203], v[228:231], a[208:211]
    buffer_load_dwordx4 v[184:187], v249, s[12:15], s40 offen
    v_mfma_f32_16x16x32_bf16 a[20:23], v[192:195], v[204:207], a[20:23]
    v_perm_b32 v196, v71, v67, s37
    v_perm_b32 v197, v79, v75, s37
    v_mfma_f32_16x16x32_bf16 a[52:55], v[192:195], v[208:211], a[52:55]
    v_perm_b32 v198, v87, v83, s37
    v_perm_b32 v199, v95, v91, s37
    v_mfma_f32_16x16x32_bf16 a[84:87], v[192:195], v[212:215], a[84:87]
    s_add_u32 s41, s81, 0x1e000
    ds_read_b128 a[248:251], v247 offset:24976
    v_mfma_f32_16x16x32_bf16 a[116:119], v[192:195], v[216:219], a[116:119]
    buffer_load_dwordx4 v[188:191], v249, s[12:15], s41 offen
    v_mfma_f32_16x16x32_bf16 a[148:151], v[192:195], v[220:223], a[148:151]
    v_mfma_f32_16x16x32_bf16 a[180:183], v[192:195], v[224:227], a[180:183]
    v_mfma_f32_16x16x32_bf16 a[212:215], v[192:195], v[228:231], a[212:215]
    v_perm_b32 v200, v71, v67, s38
    v_perm_b32 v201, v79, v75, s38
    v_mfma_f32_16x16x32_bf16 a[24:27], v[196:199], v[204:207], a[24:27]
    s_add_u32 s40, s82, 0
    v_perm_b32 v202, v87, v83, s38
    v_perm_b32 v203, v95, v91, s38
    v_mfma_f32_16x16x32_bf16 a[56:59], v[196:199], v[208:211], a[56:59]
    buffer_load_dwordx4 v[0:3], v249, s[12:15], s40 offen
    v_mfma_f32_16x16x32_bf16 a[88:91], v[196:199], v[212:215], a[88:91]
    s_add_u32 s41, s82, 0x2000
    v_mfma_f32_16x16x32_bf16 a[120:123], v[196:199], v[216:219], a[120:123]
    buffer_load_dwordx4 v[4:7], v249, s[12:15], s41 offen
    v_mfma_f32_16x16x32_bf16 a[152:155], v[196:199], v[220:223], a[152:155]
    v_mfma_f32_16x16x32_bf16 a[184:187], v[196:199], v[224:227], a[184:187]
    v_mfma_f32_16x16x32_bf16 a[216:219], v[196:199], v[228:231], a[216:219]
    s_waitcnt vmcnt(29)
    v_perm_b32 v192, v100, v96, s37
    v_perm_b32 v193, v108, v104, s37
    v_mfma_f32_16x16x32_bf16 a[28:31], v[200:203], v[204:207], a[28:31]
    s_waitcnt vmcnt(25)
    v_perm_b32 v194, v116, v112, s37
    v_perm_b32 v195, v124, v120, s37
    v_mfma_f32_16x16x32_bf16 a[60:63], v[200:203], v[208:211], a[60:63]
    v_mfma_f32_16x16x32_bf16 a[92:95], v[200:203], v[212:215], a[92:95]
    s_add_u32 s40, s82, 0x4000
    v_mfma_f32_16x16x32_bf16 a[124:127], v[200:203], v[216:219], a[124:127]
    buffer_load_dwordx4 v[8:11], v249, s[12:15], s40 offen
    v_mfma_f32_16x16x32_bf16 a[156:159], v[200:203], v[220:223], a[156:159]
    s_add_u32 s41, s82, 0x6000
    v_mfma_f32_16x16x32_bf16 a[188:191], v[200:203], v[224:227], a[188:191]
    buffer_load_dwordx4 v[12:15], v249, s[12:15], s41 offen
    v_mfma_f32_16x16x32_bf16 a[220:223], v[200:203], v[228:231], a[220:223]
    s_waitcnt lgkmcnt(0)
    v_perm_b32 v196, v100, v96, s38
    v_perm_b32 v197, v108, v104, s38
    v_mfma_f32_16x16x32_bf16 a[0:3], v[192:195], a[224:227], a[0:3]
    s_add_u32 s40, s82, 0x8000
    v_perm_b32 v198, v116, v112, s38
    v_perm_b32 v199, v124, v120, s38
    v_mfma_f32_16x16x32_bf16 a[32:35], v[192:195], a[228:231], a[32:35]
    buffer_load_dwordx4 v[16:19], v249, s[12:15], s40 offen
    v_mfma_f32_16x16x32_bf16 a[64:67], v[192:195], a[232:235], a[64:67]
    v_mfma_f32_16x16x32_bf16 a[96:99], v[192:195], a[236:239], a[96:99]
    s_add_u32 s41, s82, 0xa000
    v_mfma_f32_16x16x32_bf16 a[128:131], v[192:195], a[240:243], a[128:131]
    buffer_load_dwordx4 v[20:23], v249, s[12:15], s41 offen
    v_mfma_f32_16x16x32_bf16 a[160:163], v[192:195], a[244:247], a[160:163]
    v_mfma_f32_16x16x32_bf16 a[192:195], v[192:195], a[248:251], a[192:195]
    v_perm_b32 v200, v101, v97, s37
    v_perm_b32 v201, v109, v105, s37
    v_mfma_f32_16x16x32_bf16 a[4:7], v[196:199], a[224:227], a[4:7]
    s_add_u32 s40, s82, 0xc000
    v_perm_b32 v202, v117, v113, s37
    v_perm_b32 v203, v125, v121, s37
    v_mfma_f32_16x16x32_bf16 a[36:39], v[196:199], a[228:231], a[36:39]
    buffer_load_dwordx4 v[24:27], v249, s[12:15], s40 offen
    v_mfma_f32_16x16x32_bf16 a[68:71], v[196:199], a[232:235], a[68:71]
    ds_read_b128 v[204:207], v255 offset:0
    v_mfma_f32_16x16x32_bf16 a[100:103], v[196:199], a[236:239], a[100:103]
    v_mfma_f32_16x16x32_bf16 a[132:135], v[196:199], a[240:243], a[132:135]
    s_add_u32 s41, s82, 0xe000
    ds_read_b128 v[208:211], v255 offset:4160
    v_mfma_f32_16x16x32_bf16 a[164:167], v[196:199], a[244:247], a[164:167]
    buffer_load_dwordx4 v[28:31], v249, s[12:15], s41 offen
    v_mfma_f32_16x16x32_bf16 a[196:199], v[196:199], a[248:251], a[196:199]
    v_perm_b32 v192, v101, v97, s38
    v_perm_b32 v193, v109, v105, s38
    v_mfma_f32_16x16x32_bf16 a[8:11], v[200:203], a[224:227], a[8:11]
    v_perm_b32 v194, v117, v113, s38
    v_perm_b32 v195, v125, v121, s38
    v_mfma_f32_16x16x32_bf16 a[40:43], v[200:203], a[228:231], a[40:43]
    v_mfma_f32_16x16x32_bf16 a[72:75], v[200:203], a[232:235], a[72:75]
    s_add_u32 s40, s82, 0x10000
    ds_read_b128 v[212:215], v255 offset:8320
    v_mfma_f32_16x16x32_bf16 a[104:107], v[200:203], a[236:239], a[104:107]
    buffer_load_dwordx4 v[32:35], v249, s[12:15], s40 offen
    v_mfma_f32_16x16x32_bf16 a[136:139], v[200:203], a[240:243], a[136:139]
    s_add_u32 s41, s82, 0x12000
    v_mfma_f32_16x16x32_bf16 a[168:171], v[200:203], a[244:247], a[168:171]
    buffer_load_dwordx4 v[36:39], v249, s[12:15], s41 offen
    v_mfma_f32_16x16x32_bf16 a[200:203], v[200:203], a[248:251], a[200:203]
    v_perm_b32 v196, v102, v98, s37
    v_perm_b32 v197, v110, v106, s37
    v_mfma_f32_16x16x32_bf16 a[12:15], v[192:195], a[224:227], a[12:15]
    v_perm_b32 v198, v118, v114, s37
    v_perm_b32 v199, v126, v122, s37
    v_mfma_f32_16x16x32_bf16 a[44:47], v[192:195], a[228:231], a[44:47]
    s_add_u32 s40, s82, 0x14000
    ds_read_b128 v[216:219], v255 offset:12480
    v_mfma_f32_16x16x32_bf16 a[76:79], v[192:195], a[232:235], a[76:79]
    buffer_load_dwordx4 v[40:43], v249, s[12:15], s40 offen
    v_mfma_f32_16x16x32_bf16 a[108:111], v[192:195], a[236:239], a[108:111]
    v_mfma_f32_16x16x32_bf16 a[140:143], v[192:195], a[240:243], a[140:143]
    v_mfma_f32_16x16x32_bf16 a[172:175], v[192:195], a[244:247], a[172:175]
    s_add_u32 s41, s82, 0x16000
    ds_read_b128 v[220:223], v255 offset:16640
    v_mfma_f32_16x16x32_bf16 a[204:207], v[192:195], a[248:251], a[204:207]
    buffer_load_dwordx4 v[44:47], v249, s[12:15], s41 offen
    v_mfma_f32_16x16x32_bf16 a[16:19], v[196:199], a[224:227], a[16:19]
    v_perm_b32 v200, v102, v98, s38
    v_perm_b32 v201, v110, v106, s38
    v_mfma_f32_16x16x32_bf16 a[48:51], v[196:199], a[228:231], a[48:51]
    v_perm_b32 v202, v118, v114, s38
    v_perm_b32 v203, v126, v122, s38
    v_mfma_f32_16x16x32_bf16 a[80:83], v[196:199], a[232:235], a[80:83]
    s_add_u32 s40, s82, 0x18000
    v_mfma_f32_16x16x32_bf16 a[112:115], v[196:199], a[236:239], a[112:115]
    buffer_load_dwordx4 v[48:51], v249, s[12:15], s40 offen
    v_mfma_f32_16x16x32_bf16 a[144:147], v[196:199], a[240:243], a[144:147]
    ds_read_b128 v[224:227], v255 offset:20800
    v_mfma_f32_16x16x32_bf16 a[176:179], v[196:199], a[244:247], a[176:179]
    v_mfma_f32_16x16x32_bf16 a[208:211], v[196:199], a[248:251], a[208:211]
    s_add_u32 s41, s82, 0x1a000
    v_perm_b32 v192, v103, v99, s37
    v_perm_b32 v193, v111, v107, s37
    v_mfma_f32_16x16x32_bf16 a[20:23], v[200:203], a[224:227], a[20:23]
    buffer_load_dwordx4 v[52:55], v249, s[12:15], s41 offen
    v_mfma_f32_16x16x32_bf16 a[52:55], v[200:203], a[228:231], a[52:55]
    v_perm_b32 v194, v119, v115, s37
    v_perm_b32 v195, v127, v123, s37
    v_mfma_f32_16x16x32_bf16 a[84:87], v[200:203], a[232:235], a[84:87]
    ds_read_b128 v[228:231], v255 offset:24960
    v_mfma_f32_16x16x32_bf16 a[116:119], v[200:203], a[236:239], a[116:119]
    s_add_u32 s40, s82, 0x1c000
    v_mfma_f32_16x16x32_bf16 a[148:151], v[200:203], a[240:243], a[148:151]
    buffer_load_dwordx4 v[56:59], v249, s[12:15], s40 offen
    v_mfma_f32_16x16x32_bf16 a[180:183], v[200:203], a[244:247], a[180:183]
    v_mfma_f32_16x16x32_bf16 a[212:215], v[200:203], a[248:251], a[212:215]
    v_perm_b32 v196, v103, v99, s38
    v_perm_b32 v197, v111, v107, s38
    v_mfma_f32_16x16x32_bf16 a[24:27], v[192:195], a[224:227], a[24:27]
    s_add_u32 s41, s82, 0x1e000
    v_perm_b32 v198, v119, v115, s38
    v_perm_b32 v199, v127, v123, s38
    v_mfma_f32_16x16x32_bf16 a[56:59], v[192:195], a[228:231], a[56:59]
    buffer_load_dwordx4 v[60:63], v249, s[12:15], s41 offen
    v_mfma_f32_16x16x32_bf16 a[88:91], v[192:195], a[232:235], a[88:91]
    v_mfma_f32_16x16x32_bf16 a[120:123], v[192:195], a[236:239], a[120:123]
    v_mfma_f32_16x16x32_bf16 a[152:155], v[192:195], a[240:243], a[152:155]
    v_mfma_f32_16x16x32_bf16 a[184:187], v[192:195], a[244:247], a[184:187]
    s_add_u32 s40, s83, 0
    v_mfma_f32_16x16x32_bf16 a[216:219], v[192:195], a[248:251], a[216:219]
    buffer_load_dwordx4 v[64:67], v249, s[12:15], s40 offen
    v_mfma_f32_16x16x32_bf16 a[28:31], v[196:199], a[224:227], a[28:31]
    s_waitcnt vmcnt(36)
    v_perm_b32 v200, v132, v128, s37
    v_perm_b32 v201, v140, v136, s37
    v_mfma_f32_16x16x32_bf16 a[60:63], v[196:199], a[228:231], a[60:63]
    s_waitcnt vmcnt(32)
    v_perm_b32 v202, v148, v144, s37
    v_perm_b32 v203, v156, v152, s37
    v_mfma_f32_16x16x32_bf16 a[92:95], v[196:199], a[232:235], a[92:95]
    v_mfma_f32_16x16x32_bf16 a[124:127], v[196:199], a[236:239], a[124:127]
    s_add_u32 s41, s83, 0x2000
    v_mfma_f32_16x16x32_bf16 a[156:159], v[196:199], a[240:243], a[156:159]
    buffer_load_dwordx4 v[68:71], v249, s[12:15], s41 offen
    v_mfma_f32_16x16x32_bf16 a[188:191], v[196:199], a[244:247], a[188:191]
    s_add_u32 s40, s83, 0x4000
    v_mfma_f32_16x16x32_bf16 a[220:223], v[196:199], a[248:251], a[220:223]
    s_waitcnt lgkmcnt(0)
    buffer_load_dwordx4 v[72:75], v249, s[12:15], s40 offen
    v_mfma_f32_16x16x32_bf16 a[0:3], v[200:203], v[204:207], a[0:3]
    v_perm_b32 v192, v132, v128, s38
    v_perm_b32 v193, v140, v136, s38
    v_mfma_f32_16x16x32_bf16 a[32:35], v[200:203], v[208:211], a[32:35]
    s_add_u32 s41, s83, 0x6000
    v_perm_b32 v194, v148, v144, s38
    v_perm_b32 v195, v156, v152, s38
    v_mfma_f32_16x16x32_bf16 a[64:67], v[200:203], v[212:215], a[64:67]
    buffer_load_dwordx4 v[76:79], v249, s[12:15], s41 offen
    v_mfma_f32_16x16x32_bf16 a[96:99], v[200:203], v[216:219], a[96:99]
    v_mfma_f32_16x16x32_bf16 a[128:131], v[200:203], v[220:223], a[128:131]
    v_mfma_f32_16x16x32_bf16 a[160:163], v[200:203], v[224:227], a[160:163]
    s_add_u32 s40, s83, 0x8000
    v_mfma_f32_16x16x32_bf16 a[192:195], v[200:203], v[228:231], a[192:195]
    buffer_load_dwordx4 v[80:83], v249, s[12:15], s40 offen
    v_mfma_f32_16x16x32_bf16 a[4:7], v[192:195], v[204:207], a[4:7]
    v_perm_b32 v196, v133, v129, s37
    v_perm_b32 v197, v141, v137, s37
    v_mfma_f32_16x16x32_bf16 a[36:39], v[192:195], v[208:211], a[36:39]
    v_perm_b32 v198, v149, v145, s37
    v_perm_b32 v199, v157, v153, s37
    v_mfma_f32_16x16x32_bf16 a[68:71], v[192:195], v[212:215], a[68:71]
    s_add_u32 s41, s83, 0xa000
    ds_read_b128 a[224:227], v255 offset:16
    v_mfma_f32_16x16x32_bf16 a[100:103], v[192:195], v[216:219], a[100:103]
    buffer_load_dwordx4 v[84:87], v249, s[12:15], s41 offen
    v_mfma_f32_16x16x32_bf16 a[132:135], v[192:195], v[220:223], a[132:135]
    ds_read_b128 a[228:231], v255 offset:4176
    v_mfma_f32_16x16x32_bf16 a[164:167], v[192:195], v[224:227], a[164:167]
    v_mfma_f32_16x16x32_bf16 a[196:199], v[192:195], v[228:231], a[196:199]
    s_add_u32 s40, s83, 0xc000
    v_perm_b32 v200, v133, v129, s38
    v_perm_b32 v201, v141, v137, s38
    v_mfma_f32_16x16x32_bf16 a[8:11], v[196:199], v[204:207], a[8:11]
    buffer_load_dwordx4 v[88:91], v249, s[12:15], s40 offen
    v_mfma_f32_16x16x32_bf16 a[40:43], v[196:199], v[208:211], a[40:43]
    v_perm_b32 v202, v149, v145, s38
    v_perm_b32 v203, v157, v153, s38
    v_mfma_f32_16x16x32_bf16 a[72:75], v[196:199], v[212:215], a[72:75]
    ds_read_b128 a[232:235], v255 offset:8336
    v_mfma_f32_16x16x32_bf16 a[104:107], v[196:199], v[216:219], a[104:107]
    s_add_u32 s41, s83, 0xe000
    v_mfma_f32_16x16x32_bf16 a[136:139], v[196:199], v[220:223], a[136:139]
    buffer_load_dwordx4 v[92:95], v249, s[12:15], s41 offen
    v_mfma_f32_16x16x32_bf16 a[168:171], v[196:199], v[224:227], a[168:171]
    v_mfma_f32_16x16x32_bf16 a[200:203], v[196:199], v[228:231], a[200:203]
    v_perm_b32 v192, v134, v130, s37
    v_perm_b32 v193, v142, v138, s37
    v_mfma_f32_16x16x32_bf16 a[12:15], v[200:203], v[204:207], a[12:15]
    v_perm_b32 v194, v150, v146, s37
    v_perm_b32 v195, v158, v154, s37
    v_mfma_f32_16x16x32_bf16 a[44:47], v[200:203], v[208:211], a[44:47]
    s_add_u32 s40, s83, 0x10000
    ds_read_b128 a[236:239], v255 offset:12496
    v_mfma_f32_16x16x32_bf16 a[76:79], v[200:203], v[212:215], a[76:79]
    buffer_load_dwordx4 v[96:99], v249, s[12:15], s40 offen
    v_mfma_f32_16x16x32_bf16 a[108:111], v[200:203], v[216:219], a[108:111]
    s_add_u32 s41, s83, 0x12000
    v_mfma_f32_16x16x32_bf16 a[140:143], v[200:203], v[220:223], a[140:143]
    buffer_load_dwordx4 v[100:103], v249, s[12:15], s41 offen
    v_mfma_f32_16x16x32_bf16 a[172:175], v[200:203], v[224:227], a[172:175]
    ds_read_b128 a[240:243], v255 offset:16656
    v_mfma_f32_16x16x32_bf16 a[204:207], v[200:203], v[228:231], a[204:207]
    v_perm_b32 v196, v134, v130, s38
    v_perm_b32 v197, v142, v138, s38
    v_mfma_f32_16x16x32_bf16 a[16:19], v[192:195], v[204:207], a[16:19]
    s_add_u32 s40, s83, 0x14000
    v_perm_b32 v198, v150, v146, s38
    v_perm_b32 v199, v158, v154, s38
    v_mfma_f32_16x16x32_bf16 a[48:51], v[192:195], v[208:211], a[48:51]
    buffer_load_dwordx4 v[104:107], v249, s[12:15], s40 offen
    v_mfma_f32_16x16x32_bf16 a[80:83], v[192:195], v[212:215], a[80:83]
    v_mfma_f32_16x16x32_bf16 a[112:115], v[192:195], v[216:219], a[112:115]
    ds_read_b128 a[244:247], v255 offset:20816
    v_mfma_f32_16x16x32_bf16 a[144:147], v[192:195], v[220:223], a[144:147]
    s_add_u32 s41, s83, 0x16000
    v_mfma_f32_16x16x32_bf16 a[176:179], v[192:195], v[224:227], a[176:179]
    buffer_load_dwordx4 v[108:111], v249, s[12:15], s41 offen
    v_mfma_f32_16x16x32_bf16 a[208:211], v[192:195], v[228:231], a[208:211]
    v_perm_b32 v200, v135, v131, s37
    v_perm_b32 v201, v143, v139, s37
    v_mfma_f32_16x16x32_bf16 a[20:23], v[196:199], v[204:207], a[20:23]
    v_perm_b32 v202, v151, v147, s37
    v_perm_b32 v203, v159, v155, s37
    v_mfma_f32_16x16x32_bf16 a[52:55], v[196:199], v[208:211], a[52:55]
    s_add_u32 s40, s83, 0x18000
    ds_read_b128 a[248:251], v255 offset:24976
    v_mfma_f32_16x16x32_bf16 a[84:87], v[196:199], v[212:215], a[84:87]
    buffer_load_dwordx4 v[112:115], v249, s[12:15], s40 offen
    v_mfma_f32_16x16x32_bf16 a[116:119], v[196:199], v[216:219], a[116:119]
    v_mfma_f32_16x16x32_bf16 a[148:151], v[196:199], v[220:223], a[148:151]
    v_mfma_f32_16x16x32_bf16 a[180:183], v[196:199], v[224:227], a[180:183]
    s_add_u32 s41, s83, 0x1a000
    v_mfma_f32_16x16x32_bf16 a[212:215], v[196:199], v[228:231], a[212:215]
    buffer_load_dwordx4 v[116:119], v249, s[12:15], s41 offen
    v_mfma_f32_16x16x32_bf16 a[24:27], v[200:203], v[204:207], a[24:27]
    v_perm_b32 v192, v135, v131, s38
    v_perm_b32 v193, v143, v139, s38
    v_mfma_f32_16x16x32_bf16 a[56:59], v[200:203], v[208:211], a[56:59]
    v_perm_b32 v194, v151, v147, s38
    v_perm_b32 v195, v159, v155, s38
    v_mfma_f32_16x16x32_bf16 a[88:91], v[200:203], v[212:215], a[88:91]
    s_add_u32 s40, s83, 0x1c000
    v_mfma_f32_16x16x32_bf16 a[120:123], v[200:203], v[216:219], a[120:123]
    buffer_load_dwordx4 v[120:123], v249, s[12:15], s40 offen
    v_mfma_f32_16x16x32_bf16 a[152:155], v[200:203], v[220:223], a[152:155]
    v_mfma_f32_16x16x32_bf16 a[184:187], v[200:203], v[224:227], a[184:187]
    v_mfma_f32_16x16x32_bf16 a[216:219], v[200:203], v[228:231], a[216:219]
    s_waitcnt vmcnt(35)
    v_perm_b32 v196, v164, v160, s37
    v_perm_b32 v197, v172, v168, s37
    v_mfma_f32_16x16x32_bf16 a[28:31], v[192:195], v[204:207], a[28:31]
    s_waitcnt vmcnt(31)
    v_perm_b32 v198, v180, v176, s37
    v_perm_b32 v199, v188, v184, s37
    v_mfma_f32_16x16x32_bf16 a[60:63], v[192:195], v[208:211], a[60:63]
    v_mfma_f32_16x16x32_bf16 a[92:95], v[192:195], v[212:215], a[92:95]
    s_add_u32 s41, s83, 0x1e000
    v_mfma_f32_16x16x32_bf16 a[124:127], v[192:195], v[216:219], a[124:127]
    buffer_load_dwordx4 v[124:127], v249, s[12:15], s41 offen
    v_mfma_f32_16x16x32_bf16 a[156:159], v[192:195], v[220:223], a[156:159]
    s_add_u32 s50, s56, 0
    v_mfma_f32_16x16x32_bf16 a[188:191], v[192:195], v[224:227], a[188:191]
    s_and_b32 s50, s50, 0x1ffff
    v_mfma_f32_16x16x32_bf16 a[220:223], v[192:195], v[228:231], a[220:223]
    s_waitcnt lgkmcnt(0)
    v_perm_b32 v200, v164, v160, s38
    v_perm_b32 v201, v172, v168, s38
    v_mfma_f32_16x16x32_bf16 a[0:3], v[196:199], a[224:227], a[0:3]
    s_add_u32 m0, s46, 0
    v_perm_b32 v202, v180, v176, s38
    v_perm_b32 v203, v188, v184, s38
    v_mfma_f32_16x16x32_bf16 a[32:35], v[196:199], a[228:231], a[32:35]
    buffer_load_dwordx4 v245, s[16:19], s50 offen nt lds
    v_mfma_f32_16x16x32_bf16 a[64:67], v[196:199], a[232:235], a[64:67]
    s_barrier
    v_mfma_f32_16x16x32_bf16 a[96:99], v[196:199], a[236:239], a[96:99]
    s_waitcnt vmcnt(29)
    v_perm_b32 v128, v4, v0, s37
    v_perm_b32 v129, v12, v8, s37
    v_mfma_f32_16x16x32_bf16 a[128:131], v[196:199], a[240:243], a[128:131]
    s_waitcnt vmcnt(25)
    v_perm_b32 v130, v20, v16, s37
    v_perm_b32 v131, v28, v24, s37
    v_mfma_f32_16x16x32_bf16 a[160:163], v[196:199], a[244:247], a[160:163]
    v_perm_b32 v132, v4, v0, s38
    v_perm_b32 v133, v12, v8, s38
    v_mfma_f32_16x16x32_bf16 a[192:195], v[196:199], a[248:251], a[192:195]
    s_add_u32 m0, s46, 16
    v_perm_b32 v192, v165, v161, s37
    v_perm_b32 v193, v173, v169, s37
    v_mfma_f32_16x16x32_bf16 a[4:7], v[200:203], a[224:227], a[4:7]
    buffer_load_dwordx4 v245, s[16:19], s50 offen offset:1024 nt lds
    v_mfma_f32_16x16x32_bf16 a[36:39], v[200:203], a[228:231], a[36:39]
    s_add_u32 m0, s46, 32
    v_perm_b32 v194, v181, v177, s37
    v_perm_b32 v195, v189, v185, s37
    v_mfma_f32_16x16x32_bf16 a[68:71], v[200:203], a[232:235], a[68:71]
    buffer_load_dwordx4 v245, s[16:19], s50 offen offset:2048 nt lds
    v_mfma_f32_16x16x32_bf16 a[100:103], v[200:203], a[236:239], a[100:103]
    ds_read_b128 v[204:207], v247 offset:29120
    v_perm_b32 v134, v20, v16, s38
    v_mfma_f32_16x16x32_bf16 a[132:135], v[200:203], a[240:243], a[132:135]
    ds_read_b128 v[208:211], v247 offset:29136
    v_perm_b32 v135, v28, v24, s38
    v_mfma_f32_16x16x32_bf16 a[164:167], v[200:203], a[244:247], a[164:167]
    v_perm_b32 v136, v5, v1, s37
    v_perm_b32 v137, v13, v9, s37
    v_mfma_f32_16x16x32_bf16 a[196:199], v[200:203], a[248:251], a[196:199]
    v_perm_b32 v196, v165, v161, s38
    v_perm_b32 v197, v173, v169, s38
    v_mfma_f32_16x16x32_bf16 a[8:11], v[192:195], a[224:227], a[8:11]
    s_add_u32 m0, s46, 48
    v_perm_b32 v198, v181, v177, s38
    v_perm_b32 v199, v189, v185, s38
    v_mfma_f32_16x16x32_bf16 a[40:43], v[192:195], a[228:231], a[40:43]
    buffer_load_dwordx4 v245, s[16:19], s50 offen offset:3072 nt lds
    v_mfma_f32_16x16x32_bf16 a[72:75], v[192:195], a[232:235], a[72:75]
    v_perm_b32 v138, v21, v17, s37
    v_perm_b32 v139, v29, v25, s37
    v_mfma_f32_16x16x32_bf16 a[104:107], v[192:195], a[236:239], a[104:107]
    v_perm_b32 v140, v5, v1, s38
    v_perm_b32 v141, v13, v9, s38
    v_mfma_f32_16x16x32_bf16 a[136:139], v[192:195], a[240:243], a[136:139]
    v_perm_b32 v142, v21, v17, s38
    v_perm_b32 v143, v29, v25, s38
    v_mfma_f32_16x16x32_bf16 a[168:171], v[192:195], a[244:247], a[168:171]
    v_perm_b32 v144, v6, v2, s37
    v_perm_b32 v145, v14, v10, s37
    v_mfma_f32_16x16x32_bf16 a[200:203], v[192:195], a[248:251], a[200:203]
    s_xor_b32 s50, s50, 4096
    v_perm_b32 v200, v166, v162, s37
    v_perm_b32 v201, v174, v170, s37
    v_mfma_f32_16x16x32_bf16 a[12:15], v[196:199], a[224:227], a[12:15]
    s_add_u32 m0, s46, 0x1040
    v_perm_b32 v202, v182, v178, s37
    v_perm_b32 v203, v190, v186, s37
    v_mfma_f32_16x16x32_bf16 a[44:47], v[196:199], a[228:231], a[44:47]
    buffer_load_dwordx4 v245, s[16:19], s50 offen nt lds
    v_mfma_f32_16x16x32_bf16 a[76:79], v[196:199], a[232:235], a[76:79]
    v_perm_b32 v146, v22, v18, s37
    v_perm_b32 v147, v30, v26, s37
    v_mfma_f32_16x16x32_bf16 a[108:111], v[196:199], a[236:239], a[108:111]
    v_perm_b32 v148, v6, v2, s38
    v_perm_b32 v149, v14, v10, s38
    v_mfma_f32_16x16x32_bf16 a[140:143], v[196:199], a[240:243], a[140:143]
    v_perm_b32 v150, v22, v18, s38
    v_perm_b32 v151, v30, v26, s38
    v_mfma_f32_16x16x32_bf16 a[172:175], v[196:199], a[244:247], a[172:175]
    v_perm_b32 v152, v7, v3, s37
    v_perm_b32 v153, v15, v11, s37
    v_mfma_f32_16x16x32_bf16 a[204:207], v[196:199], a[248:251], a[204:207]
    s_add_u32 m0, s46, 0x1050
    v_perm_b32 v192, v166, v162, s38
    v_perm_b32 v193, v174, v170, s38
    v_mfma_f32_16x16x32_bf16 a[16:19], v[200:203], a[224:227], a[16:19]
    buffer_load_dwordx4 v245, s[16:19], s50 offen offset:1024 nt lds
    v_mfma_f32_16x16x32_bf16 a[48:51], v[200:203], a[228:231], a[48:51]
    v_perm_b32 v194, v182, v178, s38
    v_perm_b32 v195, v190, v186, s38
    v_mfma_f32_16x16x32_bf16 a[80:83], v[200:203], a[232:235], a[80:83]
    v_perm_b32 v154, v23, v19, s37
    v_perm_b32 v155, v31, v27, s37
    v_mfma_f32_16x16x32_bf16 a[112:115], v[200:203], a[236:239], a[112:115]
    v_perm_b32 v156, v7, v3, s38
    v_perm_b32 v157, v15, v11, s38
    v_mfma_f32_16x16x32_bf16 a[144:147], v[200:203], a[240:243], a[144:147]
    v_perm_b32 v158, v23, v19, s38
    v_perm_b32 v159, v31, v27, s38
    v_mfma_f32_16x16x32_bf16 a[176:179], v[200:203], a[244:247], a[176:179]
    s_waitcnt vmcnt(26)
    v_perm_b32 v0, v36, v32, s37
    v_perm_b32 v1, v44, v40, s37
    v_mfma_f32_16x16x32_bf16 a[208:211], v[200:203], a[248:251], a[208:211]
    s_add_u32 m0, s46, 0x1060
    v_perm_b32 v196, v167, v163, s37
    v_perm_b32 v197, v175, v171, s37
    v_mfma_f32_16x16x32_bf16 a[20:23], v[192:195], a[224:227], a[20:23]
    buffer_load_dwordx4 v245, s[16:19], s50 offen offset:2048 nt lds
    v_mfma_f32_16x16x32_bf16 a[52:55], v[192:195], a[228:231], a[52:55]
    v_perm_b32 v198, v183, v179, s37
    v_perm_b32 v199, v191, v187, s37
    v_mfma_f32_16x16x32_bf16 a[84:87], v[192:195], a[232:235], a[84:87]
    s_waitcnt vmcnt(23)
    v_perm_b32 v2, v52, v48, s37
    v_perm_b32 v3, v60, v56, s37
    v_mfma_f32_16x16x32_bf16 a[116:119], v[192:195], a[236:239], a[116:119]
    v_perm_b32 v4, v36, v32, s38
    v_perm_b32 v5, v44, v40, s38
    v_mfma_f32_16x16x32_bf16 a[148:151], v[192:195], a[240:243], a[148:151]
    s_add_u32 m0, s46, 0x1070
    v_perm_b32 v6, v52, v48, s38
    v_perm_b32 v7, v60, v56, s38
    v_mfma_f32_16x16x32_bf16 a[180:183], v[192:195], a[244:247], a[180:183]
    buffer_load_dwordx4 v245, s[16:19], s50 offen offset:3072 nt lds
    v_mfma_f32_16x16x32_bf16 a[212:215], v[192:195], a[248:251], a[212:215]
    v_perm_b32 v200, v167, v163, s38
    v_perm_b32 v201, v175, v171, s38
    v_mfma_f32_16x16x32_bf16 a[24:27], v[196:199], a[224:227], a[24:27]
    v_perm_b32 v202, v183, v179, s38
    v_perm_b32 v203, v191, v187, s38
    v_mfma_f32_16x16x32_bf16 a[56:59], v[196:199], a[228:231], a[56:59]
    ds_read_b128 v[212:215], v255 offset:29120
    v_perm_b32 v8, v37, v33, s37
    v_mfma_f32_16x16x32_bf16 a[88:91], v[196:199], a[232:235], a[88:91]
    v_perm_b32 v9, v45, v41, s37
    v_perm_b32 v10, v53, v49, s37
    v_mfma_f32_16x16x32_bf16 a[120:123], v[196:199], a[236:239], a[120:123]
    v_perm_b32 v11, v61, v57, s37
    v_perm_b32 v12, v37, v33, s38
    v_mfma_f32_16x16x32_bf16 a[152:155], v[196:199], a[240:243], a[152:155]
    v_perm_b32 v13, v45, v41, s38
    v_perm_b32 v14, v53, v49, s38
    v_mfma_f32_16x16x32_bf16 a[184:187], v[196:199], a[244:247], a[184:187]
    v_perm_b32 v15, v61, v57, s38
    v_perm_b32 v16, v38, v34, s37
    v_mfma_f32_16x16x32_bf16 a[216:219], v[196:199], a[248:251], a[216:219]
    v_perm_b32 v17, v46, v42, s37
    v_perm_b32 v18, v54, v50, s37
    v_mfma_f32_16x16x32_bf16 a[28:31], v[200:203], a[224:227], a[28:31]
    v_perm_b32 v19, v62, v58, s37
    v_perm_b32 v20, v38, v34, s38
    v_mfma_f32_16x16x32_bf16 a[60:63], v[200:203], a[228:231], a[60:63]
    s_add_u32 s50, s56, 0
    v_perm_b32 v21, v46, v42, s38
    v_perm_b32 v22, v54, v50, s38
    v_mfma_f32_16x16x32_bf16 a[92:95], v[200:203], a[232:235], a[92:95]
    s_and_b32 s50, s50, 0x1ffff
    v_perm_b32 v23, v62, v58, s38
    v_perm_b32 v24, v39, v35, s37
    v_mfma_f32_16x16x32_bf16 a[124:127], v[200:203], a[236:239], a[124:127]
    s_add_u32 m0, s47, 0
    v_perm_b32 v25, v47, v43, s37
    v_perm_b32 v26, v55, v51, s37
    v_mfma_f32_16x16x32_bf16 a[156:159], v[200:203], a[240:243], a[156:159]
    buffer_load_dwordx4 v245, s[20:23], s50 offen nt lds
    v_mfma_f32_16x16x32_bf16 a[188:191], v[200:203], a[244:247], a[188:191]
    v_perm_b32 v27, v63, v59, s37
    v_perm_b32 v28, v39, v35, s38
    v_mfma_f32_16x16x32_bf16 a[220:223], v[200:203], a[248:251], a[220:223]
    s_waitcnt lgkmcnt(0)
    v_perm_b32 v29, v47, v43, s38
    v_perm_b32 v30, v55, v51, s38
    v_mfma_f32_16x16x32_bf16 a[0:3], v[128:131], v[204:207], a[0:3]
    s_waitcnt vmcnt(23)
    v_perm_b32 v31, v63, v59, s38
    v_perm_b32 v160, v68, v64, s37
    v_mfma_f32_16x16x32_bf16 a[4:7], v[132:135], v[204:207], a[4:7]
    s_waitcnt vmcnt(19)
    v_perm_b32 v161, v76, v72, s37
    v_perm_b32 v162, v84, v80, s37
    v_mfma_f32_16x16x32_bf16 a[8:11], v[136:139], v[204:207], a[8:11]
    s_waitcnt vmcnt(17)
    v_perm_b32 v163, v92, v88, s37
    v_perm_b32 v164, v68, v64, s38
    v_mfma_f32_16x16x32_bf16 a[12:15], v[140:143], v[204:207], a[12:15]
    s_add_u32 m0, s47, 32
    v_perm_b32 v165, v76, v72, s38
    v_mfma_f32_16x16x32_bf16 a[16:19], v[144:147], v[204:207], a[16:19]
    buffer_load_dwordx4 v245, s[20:23], s50 offen offset:1024 nt lds
    v_mfma_f32_16x16x32_bf16 a[20:23], v[148:151], v[204:207], a[20:23]
    s_add_u32 m0, s47, 64
    v_perm_b32 v166, v84, v80, s38
    v_perm_b32 v167, v92, v88, s38
    v_mfma_f32_16x16x32_bf16 a[24:27], v[152:155], v[204:207], a[24:27]
    buffer_load_dwordx4 v245, s[20:23], s50 offen offset:2048 nt lds
    v_mfma_f32_16x16x32_bf16 a[28:31], v[156:159], v[204:207], a[28:31]
    ds_read_b128 v[216:219], v255 offset:29136
    v_perm_b32 v168, v69, v65, s37
    v_mfma_f32_16x16x32_bf16 a[0:3], v[0:3], v[208:211], a[0:3]
    v_perm_b32 v169, v77, v73, s37
    v_perm_b32 v170, v85, v81, s37
    v_mfma_f32_16x16x32_bf16 a[4:7], v[4:7], v[208:211], a[4:7]
    v_perm_b32 v171, v93, v89, s37
    v_perm_b32 v172, v69, v65, s38
    v_mfma_f32_16x16x32_bf16 a[8:11], v[8:11], v[208:211], a[8:11]
    v_perm_b32 v173, v77, v73, s38
    v_perm_b32 v174, v85, v81, s38
    v_mfma_f32_16x16x32_bf16 a[12:15], v[12:15], v[208:211], a[12:15]
    s_add_u32 m0, s47, 0x60
    v_perm_b32 v175, v93, v89, s38
    v_perm_b32 v176, v70, v66, s37
    v_mfma_f32_16x16x32_bf16 a[16:19], v[16:19], v[208:211], a[16:19]
    buffer_load_dwordx4 v245, s[20:23], s50 offen offset:3072 nt lds
    v_mfma_f32_16x16x32_bf16 a[20:23], v[20:23], v[208:211], a[20:23]
    v_perm_b32 v177, v78, v74, s37
    v_perm_b32 v178, v86, v82, s37
    v_mfma_f32_16x16x32_bf16 a[24:27], v[24:27], v[208:211], a[24:27]
    v_perm_b32 v179, v94, v90, s37
    v_perm_b32 v180, v70, v66, s38
    v_mfma_f32_16x16x32_bf16 a[28:31], v[28:31], v[208:211], a[28:31]
    v_perm_b32 v181, v78, v74, s38
    v_perm_b32 v182, v86, v82, s38
    v_mfma_f32_16x16x32_bf16 a[0:3], v[160:163], v[212:215], a[0:3]
    v_perm_b32 v183, v94, v90, s38
    v_perm_b32 v184, v71, v67, s37
    v_mfma_f32_16x16x32_bf16 a[4:7], v[164:167], v[212:215], a[4:7]
    s_xor_b32 s50, s50, 4096
    v_perm_b32 v185, v79, v75, s37
    v_perm_b32 v186, v87, v83, s37
    v_mfma_f32_16x16x32_bf16 a[8:11], v[168:171], v[212:215], a[8:11]
    s_add_u32 m0, s47, 0x1080
    v_perm_b32 v187, v95, v91, s37
    v_perm_b32 v188, v71, v67, s38
    v_mfma_f32_16x16x32_bf16 a[12:15], v[172:175], v[212:215], a[12:15]
    v_perm_b32 v189, v79, v75, s38
    v_perm_b32 v190, v87, v83, s38
    v_mfma_f32_16x16x32_bf16 a[16:19], v[176:179], v[212:215], a[16:19]
    s_waitcnt vmcnt(18)
    v_perm_b32 v191, v95, v91, s38
    v_perm_b32 v32, v100, v96, s37
    v_mfma_f32_16x16x32_bf16 a[20:23], v[180:183], v[212:215], a[20:23]
    s_waitcnt vmcnt(14)
    v_perm_b32 v33, v108, v104, s37
    v_perm_b32 v34, v116, v112, s37
    v_mfma_f32_16x16x32_bf16 a[24:27], v[184:187], v[212:215], a[24:27]
    s_waitcnt vmcnt(12)
    v_perm_b32 v35, v124, v120, s37
    v_perm_b32 v36, v100, v96, s38
    v_mfma_f32_16x16x32_bf16 a[28:31], v[188:191], v[212:215], a[28:31]
    s_waitcnt lgkmcnt(0)
    buffer_load_dwordx4 v245, s[20:23], s50 offen nt lds
    v_perm_b32 v37, v108, v104, s38
    v_perm_b32 v38, v116, v112, s38
    v_perm_b32 v39, v124, v120, s38
    v_mfma_f32_16x16x32_bf16 a[0:3], v[32:35], v[216:219], a[0:3]
    s_add_u32 m0, s47, 0x10a0
    ds_read_b128 a[224:227], v247 offset:33280
    v_perm_b32 v40, v101, v97, s37
    v_perm_b32 v41, v109, v105, s37
    v_perm_b32 v42, v117, v113, s37
    v_perm_b32 v43, v125, v121, s37
    v_mfma_f32_16x16x32_bf16 a[4:7], v[36:39], v[216:219], a[4:7]
    v_perm_b32 v44, v101, v97, s38
    v_perm_b32 v45, v109, v105, s38
    v_perm_b32 v46, v117, v113, s38
    v_perm_b32 v47, v125, v121, s38
    v_mfma_f32_16x16x32_bf16 a[8:11], v[40:43], v[216:219], a[8:11]
    v_perm_b32 v48, v102, v98, s37
    v_perm_b32 v49, v110, v106, s37
    v_perm_b32 v50, v118, v114, s37
    v_perm_b32 v51, v126, v122, s37
    v_mfma_f32_16x16x32_bf16 a[12:15], v[44:47], v[216:219], a[12:15]
    v_perm_b32 v52, v102, v98, s38
    v_perm_b32 v53, v110, v106, s38
    v_perm_b32 v54, v118, v114, s38
    v_perm_b32 v55, v126, v122, s38
    v_mfma_f32_16x16x32_bf16 a[16:19], v[48:51], v[216:219], a[16:19]
    v_perm_b32 v56, v103, v99, s37
    v_perm_b32 v57, v111, v107, s37
    v_perm_b32 v58, v119, v115, s37
    v_perm_b32 v59, v127, v123, s37
    v_mfma_f32_16x16x32_bf16 a[20:23], v[52:55], v[216:219], a[20:23]
    buffer_load_dwordx4 v245, s[20:23], s50 offen offset:1024 nt lds
    v_perm_b32 v60, v103, v99, s38
    v_perm_b32 v61, v111, v107, s38
    v_perm_b32 v62, v119, v115, s38
    v_perm_b32 v63, v127, v123, s38
    v_mfma_f32_16x16x32_bf16 a[24:27], v[56:59], v[216:219], a[24:27]
    s_add_u32 m0, s47, 0x10c0
    ds_read_b128 a[228:231], v247 offset:33296
    ds_read_b128 a[232:235], v255 offset:33280
    v_mfma_f32_16x16x32_bf16 a[28:31], v[60:63], v[216:219], a[28:31]
    s_waitcnt lgkmcnt(2)
    buffer_load_dwordx4 v245, s[20:23], s50 offen offset:2048 nt lds
    v_mfma_f32_16x16x32_bf16 a[32:35], v[128:131], a[224:227], a[32:35]
    ds_read_b128 a[236:239], v255 offset:33296
    v_accvgpr_read_b32 v224, a0
    v_mfma_f32_16x16x32_bf16 a[36:39], v[132:135], a[224:227], a[36:39]
    v_accvgpr_read_b32 v225, a4
    v_accvgpr_read_b32 v226, a8
    v_mfma_f32_16x16x32_bf16 a[40:43], v[136:139], a[224:227], a[40:43]
    v_accvgpr_read_b32 v227, a12
    v_accvgpr_read_b32 v228, a16
    v_mfma_f32_16x16x32_bf16 a[44:47], v[140:143], a[224:227], a[44:47]
    v_accvgpr_read_b32 v229, a20
    v_accvgpr_read_b32 v230, a24
    v_mfma_f32_16x16x32_bf16 a[48:51], v[144:147], a[224:227], a[48:51]
    s_add_u32 m0, s47, 0x10e0
    ds_read_b128 a[240:243], v247 offset:37440
    v_accvgpr_read_b32 v231, a28
    v_mfma_f32_16x16x32_bf16 a[52:55], v[148:151], a[224:227], a[52:55]
    buffer_load_dwordx4 v245, s[20:23], s50 offen offset:3072 nt lds
    v_mfma_f32_16x16x32_bf16 a[56:59], v[152:155], a[224:227], a[56:59]
    v_mul_f32 v224, s49, v224
    v_mul_f32 v225, s49, v225
    v_mfma_f32_16x16x32_bf16 a[60:63], v[156:159], a[224:227], a[60:63]
    s_waitcnt lgkmcnt(2)
    v_mul_f32 v226, s49, v226
    v_mul_f32 v227, s49, v227
    v_mfma_f32_16x16x32_bf16 a[32:35], v[0:3], a[228:231], a[32:35]
    ds_read_b128 a[244:247], v247 offset:37456
    v_mul_f32 v228, s49, v228
    v_mfma_f32_16x16x32_bf16 a[36:39], v[4:7], a[228:231], a[36:39]
    v_mul_f32 v229, s49, v229
    v_mul_f32 v230, s49, v230
    v_mfma_f32_16x16x32_bf16 a[40:43], v[8:11], a[228:231], a[40:43]
    v_mul_f32 v231, s49, v231
    v_cvt_pk_bf16_f32 v64, v224, v225
    v_mfma_f32_16x16x32_bf16 a[44:47], v[12:15], a[228:231], a[44:47]
    v_cvt_pk_bf16_f32 v65, v226, v227
    v_cvt_pk_bf16_f32 v66, v228, v229
    v_mfma_f32_16x16x32_bf16 a[48:51], v[16:19], a[228:231], a[48:51]
    ds_read_b128 a[248:251], v255 offset:37440
    v_cvt_pk_bf16_f32 v67, v230, v231
    v_mfma_f32_16x16x32_bf16 a[52:55], v[20:23], a[228:231], a[52:55]
    v_accvgpr_read_b32 v232, a1
    v_accvgpr_read_b32 v233, a5
    v_mfma_f32_16x16x32_bf16 a[56:59], v[24:27], a[228:231], a[56:59]
    v_accvgpr_read_b32 v234, a9
    v_accvgpr_read_b32 v235, a13
    v_mfma_f32_16x16x32_bf16 a[60:63], v[28:31], a[228:231], a[60:63]
    s_add_u32 s50, s56, 0x2000
    v_accvgpr_read_b32 v236, a17
    v_accvgpr_read_b32 v237, a21
    v_mfma_f32_16x16x32_bf16 a[32:35], v[160:163], a[232:235], a[32:35]
    s_and_b32 s50, s50, 0x1ffff
    ds_read_b128 a[252:255], v255 offset:37456
    v_accvgpr_read_b32 v238, a25
    v_mfma_f32_16x16x32_bf16 a[36:39], v[164:167], a[232:235], a[36:39]
    s_add_u32 m0, s46, 0x8200
    v_accvgpr_read_b32 v239, a29
    v_mul_f32 v232, s49, v232
    v_mfma_f32_16x16x32_bf16 a[40:43], v[168:171], a[232:235], a[40:43]
    buffer_load_dwordx4 v245, s[16:19], s50 offen nt lds
    v_mfma_f32_16x16x32_bf16 a[44:47], v[172:175], a[232:235], a[44:47]
    v_mul_f32 v233, s49, v233
    v_mul_f32 v234, s49, v234
    v_mfma_f32_16x16x32_bf16 a[48:51], v[176:179], a[232:235], a[48:51]
    s_add_u32 m0, s46, 0x8210
    v_mul_f32 v235, s49, v235
    v_mul_f32 v236, s49, v236
    v_mfma_f32_16x16x32_bf16 a[52:55], v[180:183], a[232:235], a[52:55]
    buffer_load_dwordx4 v245, s[16:19], s50 offen offset:1024 nt lds
    v_mfma_f32_16x16x32_bf16 a[56:59], v[184:187], a[232:235], a[56:59]
    v_mul_f32 v237, s49, v237
    v_mul_f32 v238, s49, v238
    v_mfma_f32_16x16x32_bf16 a[60:63], v[188:191], a[232:235], a[60:63]
    s_waitcnt lgkmcnt(1)
    v_mul_f32 v239, s49, v239
    v_cvt_pk_bf16_f32 v68, v232, v233
    v_mfma_f32_16x16x32_bf16 a[32:35], v[32:35], a[236:239], a[32:35]
    v_cvt_pk_bf16_f32 v69, v234, v235
    v_cvt_pk_bf16_f32 v70, v236, v237
    v_mfma_f32_16x16x32_bf16 a[36:39], v[36:39], a[236:239], a[36:39]
    v_cvt_pk_bf16_f32 v71, v238, v239
    v_accvgpr_read_b32 v224, a2
    v_mfma_f32_16x16x32_bf16 a[40:43], v[40:43], a[236:239], a[40:43]
    s_add_u32 m0, s46, 0x8220
    v_accvgpr_read_b32 v225, a6
    v_accvgpr_read_b32 v226, a10
    v_mfma_f32_16x16x32_bf16 a[44:47], v[44:47], a[236:239], a[44:47]
    buffer_load_dwordx4 v245, s[16:19], s50 offen offset:2048 nt lds
    v_mfma_f32_16x16x32_bf16 a[48:51], v[48:51], a[236:239], a[48:51]
    v_accvgpr_read_b32 v227, a14
    v_accvgpr_read_b32 v228, a18
    v_mfma_f32_16x16x32_bf16 a[52:55], v[52:55], a[236:239], a[52:55]
    v_accvgpr_read_b32 v229, a22
    v_accvgpr_read_b32 v230, a26
    v_mfma_f32_16x16x32_bf16 a[56:59], v[56:59], a[236:239], a[56:59]
    v_accvgpr_read_b32 v231, a30
    v_mul_f32 v224, s49, v224
    v_mfma_f32_16x16x32_bf16 a[60:63], v[60:63], a[236:239], a[60:63]
    v_mul_f32 v225, s49, v225
    v_mul_f32 v226, s49, v226
    v_mfma_f32_16x16x32_bf16 a[64:67], v[128:131], a[240:243], a[64:67]
    v_mul_f32 v227, s49, v227
    v_mul_f32 v228, s49, v228
    v_mfma_f32_16x16x32_bf16 a[68:71], v[132:135], a[240:243], a[68:71]
    s_add_u32 m0, s46, 0x8230
    v_mul_f32 v229, s49, v229
    v_mul_f32 v230, s49, v230
    v_mfma_f32_16x16x32_bf16 a[72:75], v[136:139], a[240:243], a[72:75]
    buffer_load_dwordx4 v245, s[16:19], s50 offen offset:3072 nt lds
    v_mfma_f32_16x16x32_bf16 a[76:79], v[140:143], a[240:243], a[76:79]
    v_mul_f32 v231, s49, v231
    v_cvt_pk_bf16_f32 v72, v224, v225
    v_mfma_f32_16x16x32_bf16 a[80:83], v[144:147], a[240:243], a[80:83]
    ds_read_b128 a[224:227], v247 offset:41600
    v_cvt_pk_bf16_f32 v73, v226, v227
    v_mfma_f32_16x16x32_bf16 a[84:87], v[148:151], a[240:243], a[84:87]
    v_cvt_pk_bf16_f32 v74, v228, v229
    v_cvt_pk_bf16_f32 v75, v230, v231
    v_mfma_f32_16x16x32_bf16 a[88:91], v[152:155], a[240:243], a[88:91]
    s_xor_b32 s50, s50, 4096
    v_accvgpr_read_b32 v232, a3
    v_accvgpr_read_b32 v233, a7
    v_mfma_f32_16x16x32_bf16 a[92:95], v[156:159], a[240:243], a[92:95]
    s_add_u32 m0, s46, 0x9240
    v_accvgpr_read_b32 v234, a11
    v_accvgpr_read_b32 v235, a15
    v_mfma_f32_16x16x32_bf16 a[64:67], v[0:3], a[244:247], a[64:67]
    buffer_load_dwordx4 v245, s[16:19], s50 offen nt lds
    v_mfma_f32_16x16x32_bf16 a[68:71], v[4:7], a[244:247], a[68:71]
    ds_read_b128 a[228:231], v247 offset:41616
    v_accvgpr_read_b32 v236, a19
    v_mfma_f32_16x16x32_bf16 a[72:75], v[8:11], a[244:247], a[72:75]
    v_accvgpr_read_b32 v237, a23
    v_accvgpr_read_b32 v238, a27
    v_mfma_f32_16x16x32_bf16 a[76:79], v[12:15], a[244:247], a[76:79]
    v_accvgpr_read_b32 v239, a31
    v_mul_f32 v232, s49, v232
    v_mfma_f32_16x16x32_bf16 a[80:83], v[16:19], a[244:247], a[80:83]
    ds_read_b128 a[232:235], v255 offset:41600
    v_mul_f32 v233, s49, v233
    v_mfma_f32_16x16x32_bf16 a[84:87], v[20:23], a[244:247], a[84:87]
    s_add_u32 m0, s46, 0x9250
    v_mul_f32 v234, s49, v234
    v_mul_f32 v235, s49, v235
    v_mfma_f32_16x16x32_bf16 a[88:91], v[24:27], a[244:247], a[88:91]
    buffer_load_dwordx4 v245, s[16:19], s50 offen offset:1024 nt lds
    v_mfma_f32_16x16x32_bf16 a[92:95], v[28:31], a[244:247], a[92:95]
    v_mul_f32 v236, s49, v236
    v_mul_f32 v237, s49, v237
    v_mfma_f32_16x16x32_bf16 a[64:67], v[160:163], a[248:251], a[64:67]
    ds_read_b128 a[236:239], v255 offset:41616
    v_mul_f32 v238, s49, v238
    v_mfma_f32_16x16x32_bf16 a[68:71], v[164:167], a[248:251], a[68:71]
    v_mul_f32 v239, s49, v239
    v_cvt_pk_bf16_f32 v76, v232, v233
    v_mfma_f32_16x16x32_bf16 a[72:75], v[168:171], a[248:251], a[72:75]
    v_cvt_pk_bf16_f32 v77, v234, v235
    v_cvt_pk_bf16_f32 v78, v236, v237
    v_mfma_f32_16x16x32_bf16 a[76:79], v[172:175], a[248:251], a[76:79]
    v_cvt_pk_bf16_f32 v79, v238, v239
    v_accvgpr_read_b32 v224, a32
    v_mfma_f32_16x16x32_bf16 a[80:83], v[176:179], a[248:251], a[80:83]
    s_add_u32 m0, s46, 0x9260
    v_accvgpr_read_b32 v225, a36
    v_accvgpr_read_b32 v226, a40
    v_mfma_f32_16x16x32_bf16 a[84:87], v[180:183], a[248:251], a[84:87]
    buffer_load_dwordx4 v245, s[16:19], s50 offen offset:2048 nt lds
    v_mfma_f32_16x16x32_bf16 a[88:91], v[184:187], a[248:251], a[88:91]
    v_accvgpr_read_b32 v227, a44
    v_accvgpr_read_b32 v228, a48
    v_mfma_f32_16x16x32_bf16 a[92:95], v[188:191], a[248:251], a[92:95]
    s_waitcnt lgkmcnt(1)
    v_accvgpr_read_b32 v229, a52
    v_accvgpr_read_b32 v230, a56
    v_mfma_f32_16x16x32_bf16 a[64:67], v[32:35], a[252:255], a[64:67]
    v_accvgpr_read_b32 v231, a60
    v_mul_f32 v224, s49, v224
    v_mfma_f32_16x16x32_bf16 a[68:71], v[36:39], a[252:255], a[68:71]
    v_mul_f32 v225, s49, v225
    v_mul_f32 v226, s49, v226
    v_mfma_f32_16x16x32_bf16 a[72:75], v[40:43], a[252:255], a[72:75]
    s_add_u32 m0, s46, 0x9270
    v_mul_f32 v227, s49, v227
    v_mul_f32 v228, s49, v228
    v_mfma_f32_16x16x32_bf16 a[76:79], v[44:47], a[252:255], a[76:79]
    buffer_load_dwordx4 v245, s[16:19], s50 offen offset:3072 nt lds
    v_mfma_f32_16x16x32_bf16 a[80:83], v[48:51], a[252:255], a[80:83]
    v_mul_f32 v229, s49, v229
    v_mul_f32 v230, s49, v230
    v_mfma_f32_16x16x32_bf16 a[84:87], v[52:55], a[252:255], a[84:87]
    v_mul_f32 v231, s49, v231
    v_cvt_pk_bf16_f32 v80, v224, v225
    v_mfma_f32_16x16x32_bf16 a[88:91], v[56:59], a[252:255], a[88:91]
    v_cvt_pk_bf16_f32 v81, v226, v227
    v_cvt_pk_bf16_f32 v82, v228, v229
    v_mfma_f32_16x16x32_bf16 a[92:95], v[60:63], a[252:255], a[92:95]
    v_cvt_pk_bf16_f32 v83, v230, v231
    v_accvgpr_read_b32 v232, a33
    v_mfma_f32_16x16x32_bf16 a[96:99], v[128:131], a[224:227], a[96:99]
    v_accvgpr_read_b32 v233, a37
    v_accvgpr_read_b32 v234, a41
    v_mfma_f32_16x16x32_bf16 a[100:103], v[132:135], a[224:227], a[100:103]
    v_accvgpr_read_b32 v235, a45
    v_accvgpr_read_b32 v236, a49
    v_mfma_f32_16x16x32_bf16 a[104:107], v[136:139], a[224:227], a[104:107]
    v_accvgpr_read_b32 v237, a53
    v_accvgpr_read_b32 v238, a57
    v_mfma_f32_16x16x32_bf16 a[108:111], v[140:143], a[224:227], a[108:111]
    v_accvgpr_read_b32 v239, a61
    v_mul_f32 v232, s49, v232
    v_mfma_f32_16x16x32_bf16 a[112:115], v[144:147], a[224:227], a[112:115]
    s_add_u32 s50, s56, 0x2000
    ds_read_b128 a[240:243], v247 offset:45760
    v_mul_f32 v233, s49, v233
    v_mfma_f32_16x16x32_bf16 a[116:119], v[148:151], a[224:227], a[116:119]
    s_and_b32 s50, s50, 0x1ffff
    v_mul_f32 v234, s49, v234
    v_mul_f32 v235, s49, v235
    v_mfma_f32_16x16x32_bf16 a[120:123], v[152:155], a[224:227], a[120:123]
    s_add_u32 m0, s47, 0x8400
    v_mul_f32 v236, s49, v236
    v_mul_f32 v237, s49, v237
    v_mfma_f32_16x16x32_bf16 a[124:127], v[156:159], a[224:227], a[124:127]
    buffer_load_dwordx4 v245, s[20:23], s50 offen nt lds
    v_mfma_f32_16x16x32_bf16 a[96:99], v[0:3], a[228:231], a[96:99]
    s_mov_b64 s[56:57], 0
    ds_read_b128 a[244:247], v247 offset:45776
    v_mul_f32 v238, s49, v238
    v_mfma_f32_16x16x32_bf16 a[100:103], v[4:7], a[228:231], a[100:103]
    s_add_u32 m0, s47, 0x8420
    v_mul_f32 v239, s49, v239
    v_cvt_pk_bf16_f32 v84, v232, v233
    v_mfma_f32_16x16x32_bf16 a[104:107], v[8:11], a[228:231], a[104:107]
    buffer_load_dwordx4 v245, s[20:23], s50 offen offset:1024 nt lds
    v_mfma_f32_16x16x32_bf16 a[108:111], v[12:15], a[228:231], a[108:111]
    v_cvt_pk_bf16_f32 v85, v234, v235
    v_cvt_pk_bf16_f32 v86, v236, v237
    v_mfma_f32_16x16x32_bf16 a[112:115], v[16:19], a[228:231], a[112:115]
    ds_read_b128 a[248:251], v255 offset:45760
    v_cvt_pk_bf16_f32 v87, v238, v239
    v_mfma_f32_16x16x32_bf16 a[116:119], v[20:23], a[228:231], a[116:119]
    v_accvgpr_read_b32 v224, a34
    v_accvgpr_read_b32 v225, a38
    v_mfma_f32_16x16x32_bf16 a[120:123], v[24:27], a[228:231], a[120:123]
    v_accvgpr_read_b32 v226, a42
    v_accvgpr_read_b32 v227, a46
    v_mfma_f32_16x16x32_bf16 a[124:127], v[28:31], a[228:231], a[124:127]
    s_add_u32 m0, s47, 0x8440
    v_accvgpr_read_b32 v228, a50
    v_accvgpr_read_b32 v229, a54
    v_mfma_f32_16x16x32_bf16 a[96:99], v[160:163], a[232:235], a[96:99]
    buffer_load_dwordx4 v245, s[20:23], s50 offen offset:2048 nt lds
    v_mfma_f32_16x16x32_bf16 a[100:103], v[164:167], a[232:235], a[100:103]
    ds_read_b128 a[252:255], v255 offset:45776
    v_accvgpr_read_b32 v230, a58
    v_mfma_f32_16x16x32_bf16 a[104:107], v[168:171], a[232:235], a[104:107]
    v_accvgpr_read_b32 v231, a62
    v_mul_f32 v224, s49, v224
    v_mfma_f32_16x16x32_bf16 a[108:111], v[172:175], a[232:235], a[108:111]
    v_mul_f32 v225, s49, v225
    v_mul_f32 v226, s49, v226
    v_mfma_f32_16x16x32_bf16 a[112:115], v[176:179], a[232:235], a[112:115]
    v_mul_f32 v227, s49, v227
    v_mul_f32 v228, s49, v228
    v_mfma_f32_16x16x32_bf16 a[116:119], v[180:183], a[232:235], a[116:119]
    v_mul_f32 v229, s49, v229
    v_mul_f32 v230, s49, v230
    v_mfma_f32_16x16x32_bf16 a[120:123], v[184:187], a[232:235], a[120:123]
    s_add_u32 m0, s47, 0x8460
    v_mul_f32 v231, s49, v231
    v_cvt_pk_bf16_f32 v88, v224, v225
    v_mfma_f32_16x16x32_bf16 a[124:127], v[188:191], a[232:235], a[124:127]
    s_waitcnt lgkmcnt(1)
    buffer_load_dwordx4 v245, s[20:23], s50 offen offset:3072 nt lds
    v_mfma_f32_16x16x32_bf16 a[96:99], v[32:35], a[236:239], a[96:99]
    v_cvt_pk_bf16_f32 v89, v226, v227
    v_cvt_pk_bf16_f32 v90, v228, v229
    v_mfma_f32_16x16x32_bf16 a[100:103], v[36:39], a[236:239], a[100:103]
    v_cvt_pk_bf16_f32 v91, v230, v231
    v_accvgpr_read_b32 v232, a35
    v_mfma_f32_16x16x32_bf16 a[104:107], v[40:43], a[236:239], a[104:107]
    v_accvgpr_read_b32 v233, a39
    v_accvgpr_read_b32 v234, a43
    v_mfma_f32_16x16x32_bf16 a[108:111], v[44:47], a[236:239], a[108:111]
    s_xor_b32 s50, s50, 4096
    v_accvgpr_read_b32 v235, a47
    v_accvgpr_read_b32 v236, a51
    v_mfma_f32_16x16x32_bf16 a[112:115], v[48:51], a[236:239], a[112:115]
    s_add_u32 m0, s47, 0x9480
    v_accvgpr_read_b32 v237, a55
    v_accvgpr_read_b32 v238, a59
    v_mfma_f32_16x16x32_bf16 a[116:119], v[52:55], a[236:239], a[116:119]
    buffer_load_dwordx4 v245, s[20:23], s50 offen nt lds
    v_mfma_f32_16x16x32_bf16 a[120:123], v[56:59], a[236:239], a[120:123]
    v_accvgpr_read_b32 v239, a63
    v_mul_f32 v232, s49, v232
    v_mfma_f32_16x16x32_bf16 a[124:127], v[60:63], a[236:239], a[124:127]
    v_mul_f32 v233, s49, v233
    v_mul_f32 v234, s49, v234
    v_mfma_f32_16x16x32_bf16 a[128:131], v[128:131], a[240:243], a[128:131]
    v_mul_f32 v235, s49, v235
    v_mul_f32 v236, s49, v236
    v_mfma_f32_16x16x32_bf16 a[132:135], v[132:135], a[240:243], a[132:135]
    v_mul_f32 v237, s49, v237
    v_mul_f32 v238, s49, v238
    v_mfma_f32_16x16x32_bf16 a[136:139], v[136:139], a[240:243], a[136:139]
    s_add_u32 m0, s47, 0x94a0
    v_mul_f32 v239, s49, v239
    v_cvt_pk_bf16_f32 v92, v232, v233
    v_mfma_f32_16x16x32_bf16 a[140:143], v[140:143], a[240:243], a[140:143]
    buffer_load_dwordx4 v245, s[20:23], s50 offen offset:1024 nt lds
    v_mfma_f32_16x16x32_bf16 a[144:147], v[144:147], a[240:243], a[144:147]
    ds_read_b128 a[224:227], v247 offset:49920
    v_cvt_pk_bf16_f32 v93, v234, v235
    v_mfma_f32_16x16x32_bf16 a[148:151], v[148:151], a[240:243], a[148:151]
    v_cvt_pk_bf16_f32 v94, v236, v237
    v_cvt_pk_bf16_f32 v95, v238, v239
    v_mfma_f32_16x16x32_bf16 a[152:155], v[152:155], a[240:243], a[152:155]
    v_accvgpr_read_b32 v224, a64
    v_accvgpr_read_b32 v225, a68
    v_mfma_f32_16x16x32_bf16 a[156:159], v[156:159], a[240:243], a[156:159]
    v_accvgpr_read_b32 v226, a72
    v_accvgpr_read_b32 v227, a76
    v_mfma_f32_16x16x32_bf16 a[128:131], v[0:3], a[244:247], a[128:131]
    ds_read_b128 a[228:231], v247 offset:49936
    v_accvgpr_read_b32 v228, a80
    v_mfma_f32_16x16x32_bf16 a[132:135], v[4:7], a[244:247], a[132:135]
    s_add_u32 m0, s47, 0x94c0
    v_accvgpr_read_b32 v229, a84
    v_accvgpr_read_b32 v230, a88
    v_mfma_f32_16x16x32_bf16 a[136:139], v[8:11], a[244:247], a[136:139]
    buffer_load_dwordx4 v245, s[20:23], s50 offen offset:2048 nt lds
    v_mfma_f32_16x16x32_bf16 a[140:143], v[12:15], a[244:247], a[140:143]
    v_accvgpr_read_b32 v231, a92
    v_mul_f32 v224, s49, v224
    v_mfma_f32_16x16x32_bf16 a[144:147], v[16:19], a[244:247], a[144:147]
    ds_read_b128 a[232:235], v255 offset:49920
    v_mul_f32 v225, s49, v225
    v_mfma_f32_16x16x32_bf16 a[148:151], v[20:23], a[244:247], a[148:151]
    v_mul_f32 v226, s49, v226
    v_mul_f32 v227, s49, v227
    v_mfma_f32_16x16x32_bf16 a[152:155], v[24:27], a[244:247], a[152:155]
    v_mul_f32 v228, s49, v228
    v_mul_f32 v229, s49, v229
    v_mfma_f32_16x16x32_bf16 a[156:159], v[28:31], a[244:247], a[156:159]
    s_add_u32 m0, s47, 0x94e0
    v_mul_f32 v230, s49, v230
    v_mul_f32 v231, s49, v231
    v_mfma_f32_16x16x32_bf16 a[128:131], v[160:163], a[248:251], a[128:131]
    buffer_load_dwordx4 v245, s[20:23], s50 offen offset:3072 nt lds
    v_mfma_f32_16x16x32_bf16 a[132:135], v[164:167], a[248:251], a[132:135]
    ds_read_b128 a[236:239], v255 offset:49936
    v_cvt_pk_bf16_f32 v96, v224, v225
    v_mfma_f32_16x16x32_bf16 a[136:139], v[168:171], a[248:251], a[136:139]
    v_cvt_pk_bf16_f32 v97, v226, v227
    v_cvt_pk_bf16_f32 v98, v228, v229
    v_mfma_f32_16x16x32_bf16 a[140:143], v[172:175], a[248:251], a[140:143]
    v_cvt_pk_bf16_f32 v99, v230, v231
    v_accvgpr_read_b32 v232, a65
    v_mfma_f32_16x16x32_bf16 a[144:147], v[176:179], a[248:251], a[144:147]
    v_accvgpr_read_b32 v233, a69
    v_accvgpr_read_b32 v234, a73
    v_mfma_f32_16x16x32_bf16 a[148:151], v[180:183], a[248:251], a[148:151]
    v_accvgpr_read_b32 v235, a77
    v_accvgpr_read_b32 v236, a81
    v_mfma_f32_16x16x32_bf16 a[152:155], v[184:187], a[248:251], a[152:155]
    v_accvgpr_read_b32 v237, a85
    v_accvgpr_read_b32 v238, a89
    v_mfma_f32_16x16x32_bf16 a[156:159], v[188:191], a[248:251], a[156:159]
    s_waitcnt lgkmcnt(1)
    v_accvgpr_read_b32 v239, a93
    v_mul_f32 v232, s49, v232
    v_mfma_f32_16x16x32_bf16 a[128:131], v[32:35], a[252:255], a[128:131]
    v_mul_f32 v233, s49, v233
    v_mul_f32 v234, s49, v234
    v_mfma_f32_16x16x32_bf16 a[132:135], v[36:39], a[252:255], a[132:135]
    v_mul_f32 v235, s49, v235
    v_mul_f32 v236, s49, v236
    v_mfma_f32_16x16x32_bf16 a[136:139], v[40:43], a[252:255], a[136:139]
    v_mul_f32 v237, s49, v237
    v_mul_f32 v238, s49, v238
    v_mfma_f32_16x16x32_bf16 a[140:143], v[44:47], a[252:255], a[140:143]
    v_mul_f32 v239, s49, v239
    v_cvt_pk_bf16_f32 v100, v232, v233
    v_mfma_f32_16x16x32_bf16 a[144:147], v[48:51], a[252:255], a[144:147]
    v_cvt_pk_bf16_f32 v101, v234, v235
    v_cvt_pk_bf16_f32 v102, v236, v237
    v_mfma_f32_16x16x32_bf16 a[148:151], v[52:55], a[252:255], a[148:151]
    v_cvt_pk_bf16_f32 v103, v238, v239
    v_accvgpr_read_b32 v224, a66
    v_mfma_f32_16x16x32_bf16 a[152:155], v[56:59], a[252:255], a[152:155]
    v_accvgpr_read_b32 v225, a70
    v_accvgpr_read_b32 v226, a74
    v_mfma_f32_16x16x32_bf16 a[156:159], v[60:63], a[252:255], a[156:159]
    v_accvgpr_read_b32 v227, a78
    v_accvgpr_read_b32 v228, a82
    v_mfma_f32_16x16x32_bf16 a[160:163], v[128:131], a[224:227], a[160:163]
    v_accvgpr_read_b32 v229, a86
    v_accvgpr_read_b32 v230, a90
    v_mfma_f32_16x16x32_bf16 a[164:167], v[132:135], a[224:227], a[164:167]
    v_accvgpr_read_b32 v231, a94
    v_mul_f32 v224, s49, v224
    v_mfma_f32_16x16x32_bf16 a[168:171], v[136:139], a[224:227], a[168:171]
    v_mul_f32 v225, s49, v225
    v_mul_f32 v226, s49, v226
    v_mfma_f32_16x16x32_bf16 a[172:175], v[140:143], a[224:227], a[172:175]
    v_mul_f32 v227, s49, v227
    v_mul_f32 v228, s49, v228
    v_mfma_f32_16x16x32_bf16 a[176:179], v[144:147], a[224:227], a[176:179]
    ds_read_b128 a[240:243], v247 offset:54080
    v_mul_f32 v229, s49, v229
    v_mfma_f32_16x16x32_bf16 a[180:183], v[148:151], a[224:227], a[180:183]
    v_mul_f32 v230, s49, v230
    v_mul_f32 v231, s49, v231
    v_mfma_f32_16x16x32_bf16 a[184:187], v[152:155], a[224:227], a[184:187]
    v_cvt_pk_bf16_f32 v104, v224, v225
    v_cvt_pk_bf16_f32 v105, v226, v227
    v_mfma_f32_16x16x32_bf16 a[188:191], v[156:159], a[224:227], a[188:191]
    v_cvt_pk_bf16_f32 v106, v228, v229
    v_cvt_pk_bf16_f32 v107, v230, v231
    v_mfma_f32_16x16x32_bf16 a[160:163], v[0:3], a[228:231], a[160:163]
    ds_read_b128 a[244:247], v247 offset:54096
    v_accvgpr_read_b32 v232, a67
    v_mfma_f32_16x16x32_bf16 a[164:167], v[4:7], a[228:231], a[164:167]
    v_accvgpr_read_b32 v233, a71
    v_accvgpr_read_b32 v234, a75
    v_mfma_f32_16x16x32_bf16 a[168:171], v[8:11], a[228:231], a[168:171]
    v_accvgpr_read_b32 v235, a79
    v_accvgpr_read_b32 v236, a83
    v_mfma_f32_16x16x32_bf16 a[172:175], v[12:15], a[228:231], a[172:175]
    v_accvgpr_read_b32 v237, a87
    v_accvgpr_read_b32 v238, a91
    v_mfma_f32_16x16x32_bf16 a[176:179], v[16:19], a[228:231], a[176:179]
    ds_read_b128 a[248:251], v255 offset:54080
    v_accvgpr_read_b32 v239, a95
    v_mfma_f32_16x16x32_bf16 a[180:183], v[20:23], a[228:231], a[180:183]
    v_mul_f32 v232, s49, v232
    v_mul_f32 v233, s49, v233
    v_mfma_f32_16x16x32_bf16 a[184:187], v[24:27], a[228:231], a[184:187]
    v_mul_f32 v234, s49, v234
    v_mul_f32 v235, s49, v235
    v_mfma_f32_16x16x32_bf16 a[188:191], v[28:31], a[228:231], a[188:191]
    v_mul_f32 v236, s49, v236
    v_mul_f32 v237, s49, v237
    v_mfma_f32_16x16x32_bf16 a[160:163], v[160:163], a[232:235], a[160:163]
    ds_read_b128 a[252:255], v255 offset:54096
    v_mul_f32 v238, s49, v238
    v_mfma_f32_16x16x32_bf16 a[164:167], v[164:167], a[232:235], a[164:167]
    v_mul_f32 v239, s49, v239
    v_cvt_pk_bf16_f32 v108, v232, v233
    v_mfma_f32_16x16x32_bf16 a[168:171], v[168:171], a[232:235], a[168:171]
    v_cvt_pk_bf16_f32 v109, v234, v235
    v_cvt_pk_bf16_f32 v110, v236, v237
    v_mfma_f32_16x16x32_bf16 a[172:175], v[172:175], a[232:235], a[172:175]
    v_cvt_pk_bf16_f32 v111, v238, v239
    v_accvgpr_read_b32 v236, a113
    v_mfma_f32_16x16x32_bf16 a[176:179], v[176:179], a[232:235], a[176:179]
    v_accvgpr_read_b32 v237, a117
    v_mul_f32 v236, s49, v236
    v_mfma_f32_16x16x32_bf16 a[180:183], v[180:183], a[232:235], a[180:183]
    v_mul_f32 v237, s49, v237
    v_cvt_pk_bf16_f32 v118, v236, v237
    v_mfma_f32_16x16x32_bf16 a[184:187], v[184:187], a[232:235], a[184:187]
    v_accvgpr_read_b32 v236, a115
    v_accvgpr_read_b32 v237, a119
    v_mfma_f32_16x16x32_bf16 a[188:191], v[188:191], a[232:235], a[188:191]
    s_waitcnt lgkmcnt(1)
    v_mul_f32 v236, s49, v236
    v_mul_f32 v237, s49, v237
    v_mfma_f32_16x16x32_bf16 a[160:163], v[32:35], a[236:239], a[160:163]
    v_cvt_pk_bf16_f32 v126, v236, v237
    v_accvgpr_read_b32 v236, a145
    v_mfma_f32_16x16x32_bf16 a[164:167], v[36:39], a[236:239], a[164:167]
    v_accvgpr_read_b32 v237, a149
    v_mul_f32 v236, s49, v236
    v_mfma_f32_16x16x32_bf16 a[168:171], v[40:43], a[236:239], a[168:171]
    v_mul_f32 v237, s49, v237
    v_cvt_pk_bf16_f32 v198, v236, v237
    v_mfma_f32_16x16x32_bf16 a[172:175], v[44:47], a[236:239], a[172:175]
    v_accvgpr_read_b32 v236, a147
    v_accvgpr_read_b32 v237, a151
    v_mfma_f32_16x16x32_bf16 a[176:179], v[48:51], a[236:239], a[176:179]
    v_mul_f32 v236, s49, v236
    v_mul_f32 v237, s49, v237
    v_mfma_f32_16x16x32_bf16 a[180:183], v[52:55], a[236:239], a[180:183]
    v_cvt_pk_bf16_f32 v206, v236, v237
    v_accvgpr_read_b32 v224, a96
    v_mfma_f32_16x16x32_bf16 a[184:187], v[56:59], a[236:239], a[184:187]
    v_accvgpr_read_b32 v225, a100
    v_accvgpr_read_b32 v226, a104
    v_mfma_f32_16x16x32_bf16 a[188:191], v[60:63], a[236:239], a[188:191]
    v_accvgpr_read_b32 v236, a177
    v_mul_f32 v236, s49, v236
    v_mfma_f32_16x16x32_bf16 a[192:195], v[128:131], a[240:243], a[192:195]
    s_waitcnt vmcnt(24)
    ds_read_b128 v[128:131], v240 offset:0
    v_accvgpr_read_b32 v237, a181
    v_mfma_f32_16x16x32_bf16 a[196:199], v[132:135], a[240:243], a[196:199]
    ds_read_b128 v[132:135], v240 offset:16
    v_mul_f32 v237, s49, v237
    v_mfma_f32_16x16x32_bf16 a[200:203], v[136:139], a[240:243], a[200:203]
    ds_read_b128 v[136:139], v240 offset:32
    v_cvt_pk_bf16_f32 v214, v236, v237
    v_mfma_f32_16x16x32_bf16 a[204:207], v[140:143], a[240:243], a[204:207]
    ds_read_b128 v[140:143], v240 offset:48
    v_accvgpr_read_b32 v236, a179
    v_mfma_f32_16x16x32_bf16 a[208:211], v[144:147], a[240:243], a[208:211]
    ds_read_b128 v[144:147], v240 offset:4160
    v_accvgpr_read_b32 v237, a183
    v_mfma_f32_16x16x32_bf16 a[212:215], v[148:151], a[240:243], a[212:215]
    ds_read_b128 v[148:151], v240 offset:4176
    v_mul_f32 v236, s49, v236
    v_mfma_f32_16x16x32_bf16 a[216:219], v[152:155], a[240:243], a[216:219]
    ds_read_b128 v[152:155], v240 offset:4192
    v_mul_f32 v237, s49, v237
    v_mfma_f32_16x16x32_bf16 a[220:223], v[156:159], a[240:243], a[220:223]
    ds_read_b128 v[156:159], v240 offset:4208
    v_cvt_pk_bf16_f32 v222, v236, v237
    v_mfma_f32_16x16x32_bf16 a[192:195], v[0:3], a[244:247], a[192:195]
    v_mov_b32 v236, 0x3f803f80
    v_accvgpr_read_b32 v227, a108
    v_mfma_f32_16x16x32_bf16 a[196:199], v[4:7], a[244:247], a[196:199]
    v_accvgpr_read_b32 v228, a112
    v_accvgpr_read_b32 v229, a116
    v_mfma_f32_16x16x32_bf16 a[200:203], v[8:11], a[244:247], a[200:203]
    v_accvgpr_read_b32 v230, a120
    v_accvgpr_read_b32 v231, a124
    v_mfma_f32_16x16x32_bf16 a[204:207], v[12:15], a[244:247], a[204:207]
    v_mul_f32 v224, s49, v224
    v_mul_f32 v225, s49, v225
    v_mfma_f32_16x16x32_bf16 a[208:211], v[16:19], a[244:247], a[208:211]
    v_mul_f32 v226, s49, v226
    v_mul_f32 v227, s49, v227
    v_mfma_f32_16x16x32_bf16 a[212:215], v[20:23], a[244:247], a[212:215]
    v_mul_f32 v228, s49, v228
    v_mul_f32 v229, s49, v229
    v_mfma_f32_16x16x32_bf16 a[216:219], v[24:27], a[244:247], a[216:219]
    v_mul_f32 v230, s49, v230
    v_mul_f32 v231, s49, v231
    v_mfma_f32_16x16x32_bf16 a[220:223], v[28:31], a[244:247], a[220:223]
    v_cvt_pk_bf16_f32 v112, v224, v225
    v_cvt_pk_bf16_f32 v113, v226, v227
    v_mfma_f32_16x16x32_bf16 a[192:195], v[160:163], a[248:251], a[192:195]
    s_waitcnt vmcnt(16)
    ds_read_b64_tr_b16 v[160:161], v241 offset:0
    ds_read_b64_tr_b16 v[162:163], v241 offset:4224
    v_mfma_f32_16x16x32_bf16 a[196:199], v[164:167], a[248:251], a[196:199]
    s_nop 0
    ds_read_b64_tr_b16 v[164:165], v241 offset:32
    ds_read_b64_tr_b16 v[166:167], v241 offset:4256
    v_mfma_f32_16x16x32_bf16 a[200:203], v[168:171], a[248:251], a[200:203]
    s_nop 0
    ds_read_b64_tr_b16 v[168:169], v242 offset:0
    ds_read_b64_tr_b16 v[170:171], v242 offset:4224
    v_mfma_f32_16x16x32_bf16 a[204:207], v[172:175], a[248:251], a[204:207]
    s_nop 0
    ds_read_b64_tr_b16 v[172:173], v242 offset:32
    ds_read_b64_tr_b16 v[174:175], v242 offset:4256
    v_mfma_f32_16x16x32_bf16 a[208:211], v[176:179], a[248:251], a[208:211]
    s_nop 0
    ds_read_b64_tr_b16 v[176:177], v243 offset:0
    ds_read_b64_tr_b16 v[178:179], v243 offset:4224
    v_mfma_f32_16x16x32_bf16 a[212:215], v[180:183], a[248:251], a[212:215]
    s_nop 0
    ds_read_b64_tr_b16 v[180:181], v243 offset:32
    ds_read_b64_tr_b16 v[182:183], v243 offset:4256
    v_mfma_f32_16x16x32_bf16 a[216:219], v[184:187], a[248:251], a[216:219]
    s_nop 0
    ds_read_b64_tr_b16 v[184:185], v244 offset:0
    ds_read_b64_tr_b16 v[186:187], v244 offset:4224
    v_mfma_f32_16x16x32_bf16 a[220:223], v[188:191], a[248:251], a[220:223]
    s_waitcnt lgkmcnt(14)
    ds_read_b64_tr_b16 v[188:189], v244 offset:32
    ds_read_b64_tr_b16 v[190:191], v244 offset:4256
    v_mfma_f32_16x16x32_bf16 a[192:195], v[32:35], a[252:255], a[192:195]
    v_cvt_pk_bf16_f32 v114, v228, v229
    v_cvt_pk_bf16_f32 v115, v230, v231
    v_mfma_f32_16x16x32_bf16 a[196:199], v[36:39], a[252:255], a[196:199]
    v_accvgpr_read_b32 v232, a97
    v_accvgpr_read_b32 v233, a101
    v_mfma_f32_16x16x32_bf16 a[200:203], v[40:43], a[252:255], a[200:203]
    v_accvgpr_read_b32 v234, a105
    v_accvgpr_read_b32 v235, a109
    v_mfma_f32_16x16x32_bf16 a[204:207], v[44:47], a[252:255], a[204:207]
    v_accvgpr_read_b32 v238, a121
    v_accvgpr_read_b32 v239, a125
    v_mfma_f32_16x16x32_bf16 a[208:211], v[48:51], a[252:255], a[208:211]
    v_mul_f32 v232, s49, v232
    v_mul_f32 v233, s49, v233
    v_mfma_f32_16x16x32_bf16 a[212:215], v[52:55], a[252:255], a[212:215]
    v_mul_f32 v234, s49, v234
    v_mul_f32 v235, s49, v235
    v_mfma_f32_16x16x32_bf16 a[216:219], v[56:59], a[252:255], a[216:219]
    v_mul_f32 v238, s49, v238
    v_mul_f32 v239, s49, v239
    v_mfma_f32_16x16x32_bf16 a[220:223], v[60:63], a[252:255], a[220:223]
    v_accvgpr_write_b32 a252, v236
    v_accvgpr_write_b32 a253, v236
    v_mfma_f32_16x16x32_bf16 v[0:3], v[128:131], v[64:67], 0
    v_accvgpr_write_b32 a254, v236
    v_accvgpr_write_b32 a255, v236
    v_mfma_f32_16x16x32_bf16 v[0:3], v[132:135], v[68:71], v[0:3]
    v_cvt_pk_bf16_f32 v116, v232, v233
    v_cvt_pk_bf16_f32 v117, v234, v235
    v_mfma_f32_16x16x32_bf16 v[0:3], v[136:139], v[72:75], v[0:3]
    s_add_u32 m0, s46, 0
    v_cvt_pk_bf16_f32 v119, v238, v239
    v_accvgpr_read_b32 v224, a98
    v_mfma_f32_16x16x32_bf16 v[0:3], v[140:143], v[76:79], v[0:3]
    buffer_load_dwordx4 v245, s[16:19], s42 offen nt lds
    v_mfma_f32_16x16x32_bf16 v[4:7], v[144:147], v[64:67], 0
    s_add_u32 m0, s46, 16
    v_accvgpr_read_b32 v225, a102
    v_accvgpr_read_b32 v226, a106
    v_mfma_f32_16x16x32_bf16 v[4:7], v[148:151], v[68:71], v[4:7]
    buffer_load_dwordx4 v245, s[16:19], s42 offen offset:1024 nt lds
    v_mfma_f32_16x16x32_bf16 v[4:7], v[152:155], v[72:75], v[4:7]
    s_add_u32 m0, s46, 32
    v_max3_f32 v40, v0, v1, v2
    v_accvgpr_read_b32 v227, a110
    v_mfma_f32_16x16x32_bf16 v[4:7], v[156:159], v[76:79], v[4:7]
    buffer_load_dwordx4 v245, s[16:19], s42 offen offset:2048 nt lds
    v_mfma_f32_16x16x32_bf16 v[8:11], v[128:131], v[80:83], 0
    s_add_u32 m0, s46, 48
    v_accvgpr_read_b32 v228, a114
    v_accvgpr_read_b32 v229, a118
    v_mfma_f32_16x16x32_bf16 v[8:11], v[132:135], v[84:87], v[8:11]
    buffer_load_dwordx4 v245, s[16:19], s42 offen offset:3072 nt lds
    v_mfma_f32_16x16x32_bf16 v[8:11], v[136:139], v[88:91], v[8:11]
    s_add_u32 m0, s46, 0x1040
    v_max3_f32 v41, v3, v4, v5
    v_max3_f32 v40, v40, v6, v7
    v_mfma_f32_16x16x32_bf16 v[8:11], v[140:143], v[92:95], v[8:11]
    v_max_f32 v40, v40, v41
    v_mov_b32 v41, v40
    v_mfma_f32_16x16x32_bf16 v[12:15], v[144:147], v[80:83], 0
    s_nop 0
    v_permlane32_swap_b32 v40, v41
    v_max_f32 v40, v40, v41
    v_mfma_f32_16x16x32_bf16 v[12:15], v[148:151], v[84:87], v[12:15]
    v_mov_b32 v41, v40
    v_accvgpr_read_b32 v230, a122
    v_mfma_f32_16x16x32_bf16 v[12:15], v[152:155], v[88:91], v[12:15]
    buffer_load_dwordx4 v245, s[16:19], s43 offen nt lds
    v_permlane16_swap_b32 v40, v41
    v_max_f32 v40, v40, v41
    v_sub_f32 v0, v0, v40
    v_sub_f32 v1, v1, v40
    v_sub_f32 v2, v2, v40
    v_sub_f32 v3, v3, v40
    v_exp_f32 v0, v0
    v_exp_f32 v1, v1
    v_exp_f32 v2, v2
    v_exp_f32 v3, v3
    v_mfma_f32_16x16x32_bf16 v[12:15], v[156:159], v[92:95], v[12:15]
    s_add_u32 m0, s46, 0x1050
    v_cvt_pk_bf16_f32 v32, v0, v1
    v_cvt_pk_bf16_f32 v33, v2, v3
    v_mfma_f32_16x16x32_bf16 v[0:3], v[128:131], v[96:99], 0
    buffer_load_dwordx4 v245, s[16:19], s43 offen offset:1024 nt lds
    v_mfma_f32_16x16x32_bf16 v[0:3], v[132:135], v[100:103], v[0:3]
    s_add_u32 m0, s46, 0x1060
    v_sub_f32 v4, v4, v40
    v_sub_f32 v5, v5, v40
    v_mfma_f32_16x16x32_bf16 v[0:3], v[136:139], v[104:107], v[0:3]
    v_sub_f32 v6, v6, v40
    v_sub_f32 v7, v7, v40
    v_exp_f32 v4, v4
    v_exp_f32 v5, v5
    v_exp_f32 v6, v6
    v_exp_f32 v7, v7
    v_mfma_f32_16x16x32_bf16 v[0:3], v[140:143], v[108:111], v[0:3]
    buffer_load_dwordx4 v245, s[16:19], s43 offen offset:2048 nt lds
    v_cvt_pk_bf16_f32 v34, v4, v5
    v_cvt_pk_bf16_f32 v35, v6, v7
    v_mfma_f32_16x16x32_bf16 v[4:7], v[144:147], v[96:99], 0
    s_add_u32 m0, s46, 0x1070
    v_max3_f32 v44, v8, v9, v10
    v_max3_f32 v45, v11, v12, v13
    v_mfma_f32_16x16x32_bf16 v[4:7], v[148:151], v[100:103], v[4:7]
    buffer_load_dwordx4 v245, s[16:19], s43 offen offset:3072 nt lds
    v_mfma_f32_16x16x32_bf16 v[4:7], v[152:155], v[104:107], v[4:7]
    s_add_u32 s42, s42, 8192
    v_max3_f32 v44, v44, v14, v15
    v_max_f32 v44, v44, v45
    v_mfma_f32_16x16x32_bf16 v[4:7], v[156:159], v[108:111], v[4:7]
    s_waitcnt lgkmcnt(0)
    v_mov_b32 v45, v44
    v_accvgpr_read_b32 v231, a126
    v_mfma_f32_16x16x32_bf16 a[0:3], v[160:163], v[32:35], 0
    s_and_b32 s42, s42, 0x1ffff
    s_xor_b32 s43, s42, 4096
    v_permlane32_swap_b32 v44, v45
    v_mfma_f32_16x16x32_bf16 a[4:7], v[164:167], v[32:35], 0
    v_max_f32 v44, v44, v45
    v_mov_b32 v45, v44
    v_mfma_f32_16x16x32_bf16 a[8:11], v[168:171], v[32:35], 0
    s_nop 0
    v_permlane16_swap_b32 v44, v45
    v_max_f32 v44, v44, v45
    v_mfma_f32_16x16x32_bf16 a[12:15], v[172:175], v[32:35], 0
    s_add_u32 m0, s47, 0
    v_sub_f32 v8, v8, v44
    v_sub_f32 v9, v9, v44
    v_mfma_f32_16x16x32_bf16 a[16:19], v[176:179], v[32:35], 0
    buffer_load_dwordx4 v245, s[20:23], s44 offen nt lds
    v_mfma_f32_16x16x32_bf16 a[20:23], v[180:183], v[32:35], 0
    s_add_u32 m0, s47, 32
    v_sub_f32 v10, v10, v44
    v_sub_f32 v11, v11, v44
    v_mfma_f32_16x16x32_bf16 a[24:27], v[184:187], v[32:35], 0
    v_exp_f32 v8, v8
    v_mfma_f32_16x16x32_bf16 a[28:31], v[188:191], v[32:35], 0
    v_exp_f32 v9, v9
    v_exp_f32 v10, v10
    v_exp_f32 v11, v11
    v_mfma_f32_16x16x32_bf16 a[240:243], a[252:255], v[32:35], 0
    v_cvt_pk_bf16_f32 v36, v8, v9
    v_cvt_pk_bf16_f32 v37, v10, v11
    v_mfma_f32_16x16x32_bf16 v[8:11], v[128:131], v[112:115], 0
    buffer_load_dwordx4 v245, s[20:23], s44 offen offset:1024 nt lds
    v_mul_f32 v224, s49, v224
    v_mul_f32 v225, s49, v225
    v_mul_f32 v226, s49, v226
    v_mul_f32 v227, s49, v227
    v_mul_f32 v228, s49, v228
    v_mul_f32 v229, s49, v229
    v_mul_f32 v230, s49, v230
    v_mul_f32 v231, s49, v231
    v_cvt_pk_bf16_f32 v120, v224, v225
    v_cvt_pk_bf16_f32 v121, v226, v227
    v_cvt_pk_bf16_f32 v122, v228, v229
    v_cvt_pk_bf16_f32 v123, v230, v231
    v_mfma_f32_16x16x32_bf16 v[8:11], v[132:135], v[116:119], v[8:11]
    s_add_u32 m0, s47, 64
    v_accvgpr_read_b32 v232, a99
    v_accvgpr_read_b32 v233, a103
    v_accvgpr_read_b32 v234, a107
    v_accvgpr_read_b32 v235, a111
    v_accvgpr_read_b32 v238, a123
    v_accvgpr_read_b32 v239, a127
    v_mul_f32 v232, s49, v232
    v_mul_f32 v233, s49, v233
    v_mul_f32 v234, s49, v234
    v_mul_f32 v235, s49, v235
    v_mul_f32 v238, s49, v238
    v_mul_f32 v239, s49, v239
    v_cvt_pk_bf16_f32 v124, v232, v233
    v_cvt_pk_bf16_f32 v125, v234, v235
    v_cvt_pk_bf16_f32 v127, v238, v239
    v_mfma_f32_16x16x32_bf16 v[8:11], v[136:139], v[120:123], v[8:11]
    v_sub_f32 v12, v12, v44
    v_sub_f32 v13, v13, v44
    v_sub_f32 v14, v14, v44
    v_sub_f32 v15, v15, v44
    v_exp_f32 v12, v12
    v_exp_f32 v13, v13
    v_exp_f32 v14, v14
    v_exp_f32 v15, v15
    v_mfma_f32_16x16x32_bf16 v[8:11], v[140:143], v[124:127], v[8:11]
    v_cvt_pk_bf16_f32 v38, v12, v13
    v_cvt_pk_bf16_f32 v39, v14, v15
    v_mfma_f32_16x16x32_bf16 v[12:15], v[144:147], v[112:115], 0
    buffer_load_dwordx4 v245, s[20:23], s44 offen offset:2048 nt lds
    v_mfma_f32_16x16x32_bf16 v[12:15], v[148:151], v[116:119], v[12:15]
    s_add_u32 m0, s47, 0x60
    v_max3_f32 v48, v0, v1, v2
    v_max3_f32 v49, v3, v4, v5
    v_mfma_f32_16x16x32_bf16 v[12:15], v[152:155], v[120:123], v[12:15]
    buffer_load_dwordx4 v245, s[20:23], s44 offen offset:3072 nt lds
    v_mfma_f32_16x16x32_bf16 v[12:15], v[156:159], v[124:127], v[12:15]
    v_max3_f32 v48, v48, v6, v7
    v_max_f32 v48, v48, v49
    v_mfma_f32_16x16x32_bf16 a[32:35], v[160:163], v[36:39], 0
    s_add_u32 m0, s47, 0x1080
    v_mov_b32 v49, v48
    v_accvgpr_read_b32 v224, a128
    v_mfma_f32_16x16x32_bf16 a[36:39], v[164:167], v[36:39], 0
    buffer_load_dwordx4 v245, s[20:23], s45 offen nt lds
    v_mfma_f32_16x16x32_bf16 a[40:43], v[168:171], v[36:39], 0
    v_permlane32_swap_b32 v48, v49
    v_max_f32 v48, v48, v49
    v_mfma_f32_16x16x32_bf16 a[44:47], v[172:175], v[36:39], 0
    s_add_u32 m0, s47, 0x10a0
    v_mov_b32 v49, v48
    v_accvgpr_read_b32 v225, a132
    v_mfma_f32_16x16x32_bf16 a[48:51], v[176:179], v[36:39], 0
    v_accvgpr_read_b32 v226, a136
    v_accvgpr_read_b32 v227, a140
    v_mfma_f32_16x16x32_bf16 a[52:55], v[180:183], v[36:39], 0
    v_accvgpr_read_b32 v228, a144
    v_accvgpr_read_b32 v229, a148
    v_mfma_f32_16x16x32_bf16 a[56:59], v[184:187], v[36:39], 0
    v_accvgpr_read_b32 v230, a152
    v_accvgpr_read_b32 v231, a156
    v_mfma_f32_16x16x32_bf16 a[60:63], v[188:191], v[36:39], 0
    buffer_load_dwordx4 v245, s[20:23], s45 offen offset:1024 nt lds
    v_mul_f32 v224, s49, v224
    v_mul_f32 v225, s49, v225
    v_mul_f32 v226, s49, v226
    v_mul_f32 v227, s49, v227
    v_mul_f32 v228, s49, v228
    v_mul_f32 v229, s49, v229
    v_mul_f32 v230, s49, v230
    v_mul_f32 v231, s49, v231
    v_cvt_pk_bf16_f32 v192, v224, v225
    v_cvt_pk_bf16_f32 v193, v226, v227
    v_cvt_pk_bf16_f32 v194, v228, v229
    v_cvt_pk_bf16_f32 v195, v230, v231
    v_permlane16_swap_b32 v48, v49
    v_max_f32 v48, v48, v49
    v_sub_f32 v0, v0, v48
    v_sub_f32 v1, v1, v48
    v_sub_f32 v2, v2, v48
    v_sub_f32 v3, v3, v48
    v_exp_f32 v0, v0
    v_exp_f32 v1, v1
    v_exp_f32 v2, v2
    v_exp_f32 v3, v3
    v_mfma_f32_16x16x32_bf16 a[244:247], a[252:255], v[36:39], 0
    s_add_u32 m0, s47, 0x10c0
    v_accvgpr_read_b32 v232, a129
    v_accvgpr_read_b32 v233, a133
    v_accvgpr_read_b32 v234, a137
    v_accvgpr_read_b32 v235, a141
    v_accvgpr_read_b32 v238, a153
    v_accvgpr_read_b32 v239, a157
    v_mul_f32 v232, s49, v232
    v_mul_f32 v233, s49, v233
    v_mul_f32 v234, s49, v234
    v_mul_f32 v235, s49, v235
    v_mul_f32 v238, s49, v238
    v_mul_f32 v239, s49, v239
    v_cvt_pk_bf16_f32 v196, v232, v233
    v_cvt_pk_bf16_f32 v197, v234, v235
    v_cvt_pk_bf16_f32 v199, v238, v239
    v_cvt_pk_bf16_f32 v32, v0, v1
    v_cvt_pk_bf16_f32 v33, v2, v3
    v_mfma_f32_16x16x32_bf16 v[0:3], v[128:131], v[192:195], 0
    v_accvgpr_read_b32 v224, a130
    v_accvgpr_read_b32 v225, a134
    v_accvgpr_read_b32 v226, a138
    v_accvgpr_read_b32 v227, a142
    v_accvgpr_read_b32 v228, a146
    v_accvgpr_read_b32 v229, a150
    v_accvgpr_read_b32 v230, a154
    v_accvgpr_read_b32 v231, a158
    v_mul_f32 v224, s49, v224
    v_mul_f32 v225, s49, v225
    v_mul_f32 v226, s49, v226
    v_mul_f32 v227, s49, v227
    v_mul_f32 v228, s49, v228
    v_mul_f32 v229, s49, v229
    v_mul_f32 v230, s49, v230
    v_mul_f32 v231, s49, v231
    v_cvt_pk_bf16_f32 v200, v224, v225
    v_cvt_pk_bf16_f32 v201, v226, v227
    v_cvt_pk_bf16_f32 v202, v228, v229
    v_cvt_pk_bf16_f32 v203, v230, v231
    v_mfma_f32_16x16x32_bf16 v[0:3], v[132:135], v[196:199], v[0:3]
    v_accvgpr_read_b32 v232, a131
    v_accvgpr_read_b32 v233, a135
    v_accvgpr_read_b32 v234, a139
    v_accvgpr_read_b32 v235, a143
    v_accvgpr_read_b32 v238, a155
    v_accvgpr_read_b32 v239, a159
    v_mul_f32 v232, s49, v232
    v_mul_f32 v233, s49, v233
    v_mul_f32 v234, s49, v234
    v_mul_f32 v235, s49, v235
    v_mul_f32 v238, s49, v238
    v_mul_f32 v239, s49, v239
    v_cvt_pk_bf16_f32 v204, v232, v233
    v_cvt_pk_bf16_f32 v205, v234, v235
    v_cvt_pk_bf16_f32 v207, v238, v239
    v_mfma_f32_16x16x32_bf16 v[0:3], v[136:139], v[200:203], v[0:3]
    buffer_load_dwordx4 v245, s[20:23], s45 offen offset:2048 nt lds
    v_sub_f32 v4, v4, v48
    v_sub_f32 v5, v5, v48
    v_sub_f32 v6, v6, v48
    v_sub_f32 v7, v7, v48
    v_exp_f32 v4, v4
    v_exp_f32 v5, v5
    v_exp_f32 v6, v6
    v_exp_f32 v7, v7
    v_mfma_f32_16x16x32_bf16 v[0:3], v[140:143], v[204:207], v[0:3]
    s_add_u32 m0, s47, 0x10e0
    v_cvt_pk_bf16_f32 v34, v4, v5
    v_cvt_pk_bf16_f32 v35, v6, v7
    v_mfma_f32_16x16x32_bf16 v[4:7], v[144:147], v[192:195], 0
    buffer_load_dwordx4 v245, s[20:23], s45 offen offset:3072 nt lds
    v_mfma_f32_16x16x32_bf16 v[4:7], v[148:151], v[196:199], v[4:7]
    s_add_u32 s44, s44, 8192
    v_max3_f32 v52, v8, v9, v10
    v_max3_f32 v53, v11, v12, v13
    v_mfma_f32_16x16x32_bf16 v[4:7], v[152:155], v[200:203], v[4:7]
    s_and_b32 s44, s44, 0x1ffff
    v_max3_f32 v52, v52, v14, v15
    v_max_f32 v52, v52, v53
    v_mfma_f32_16x16x32_bf16 v[4:7], v[156:159], v[204:207], v[4:7]
    s_xor_b32 s45, s44, 4096
    v_mov_b32 v53, v52
    v_accvgpr_read_b32 v224, a160
    v_mfma_f32_16x16x32_bf16 a[64:67], v[160:163], v[32:35], 0
    v_permlane32_swap_b32 v52, v53
    v_max_f32 v52, v52, v53
    v_mfma_f32_16x16x32_bf16 a[68:71], v[164:167], v[32:35], 0
    v_mov_b32 v53, v52
    v_accvgpr_read_b32 v225, a164
    v_mfma_f32_16x16x32_bf16 a[72:75], v[168:171], v[32:35], 0
    v_accvgpr_read_b32 v226, a168
    v_accvgpr_read_b32 v227, a172
    v_mfma_f32_16x16x32_bf16 a[76:79], v[172:175], v[32:35], 0
    v_accvgpr_read_b32 v228, a176
    v_accvgpr_read_b32 v229, a180
    v_mfma_f32_16x16x32_bf16 a[80:83], v[176:179], v[32:35], 0
    v_accvgpr_read_b32 v230, a184
    v_accvgpr_read_b32 v231, a188
    v_mfma_f32_16x16x32_bf16 a[84:87], v[180:183], v[32:35], 0
    v_mul_f32 v224, s49, v224
    v_mul_f32 v225, s49, v225
    v_mfma_f32_16x16x32_bf16 a[88:91], v[184:187], v[32:35], 0
    v_mul_f32 v226, s49, v226
    v_mul_f32 v227, s49, v227
    v_mfma_f32_16x16x32_bf16 a[92:95], v[188:191], v[32:35], 0
    v_mul_f32 v228, s49, v228
    v_mul_f32 v229, s49, v229
    v_mul_f32 v230, s49, v230
    v_mul_f32 v231, s49, v231
    v_cvt_pk_bf16_f32 v208, v224, v225
    v_cvt_pk_bf16_f32 v209, v226, v227
    v_cvt_pk_bf16_f32 v210, v228, v229
    v_cvt_pk_bf16_f32 v211, v230, v231
    v_permlane16_swap_b32 v52, v53
    v_max_f32 v52, v52, v53
    v_sub_f32 v8, v8, v52
    v_sub_f32 v9, v9, v52
    v_sub_f32 v10, v10, v52
    v_sub_f32 v11, v11, v52
    v_exp_f32 v8, v8
    v_exp_f32 v9, v9
    v_exp_f32 v10, v10
    v_exp_f32 v11, v11
    v_mfma_f32_16x16x32_bf16 a[248:251], a[252:255], v[32:35], 0
    v_accvgpr_read_b32 v232, a161
    v_accvgpr_read_b32 v233, a165
    v_accvgpr_read_b32 v234, a169
    v_accvgpr_read_b32 v235, a173
    v_accvgpr_read_b32 v238, a185
    v_accvgpr_read_b32 v239, a189
    v_mul_f32 v232, s49, v232
    v_mul_f32 v233, s49, v233
    v_mul_f32 v234, s49, v234
    v_mul_f32 v235, s49, v235
    v_mul_f32 v238, s49, v238
    v_mul_f32 v239, s49, v239
    v_cvt_pk_bf16_f32 v212, v232, v233
    v_cvt_pk_bf16_f32 v213, v234, v235
    v_cvt_pk_bf16_f32 v215, v238, v239
    v_cvt_pk_bf16_f32 v36, v8, v9
    v_cvt_pk_bf16_f32 v37, v10, v11
    v_mfma_f32_16x16x32_bf16 v[8:11], v[128:131], v[208:211], 0
    v_accvgpr_read_b32 v224, a162
    v_accvgpr_read_b32 v225, a166
    v_accvgpr_read_b32 v226, a170
    v_accvgpr_read_b32 v227, a174
    v_accvgpr_read_b32 v228, a178
    v_accvgpr_read_b32 v229, a182
    v_accvgpr_read_b32 v230, a186
    v_accvgpr_read_b32 v231, a190
    v_mul_f32 v224, s49, v224
    v_mul_f32 v225, s49, v225
    v_mul_f32 v226, s49, v226
    v_mul_f32 v227, s49, v227
    v_mul_f32 v228, s49, v228
    v_mul_f32 v229, s49, v229
    v_mul_f32 v230, s49, v230
    v_mul_f32 v231, s49, v231
    v_cvt_pk_bf16_f32 v216, v224, v225
    v_cvt_pk_bf16_f32 v217, v226, v227
    v_cvt_pk_bf16_f32 v218, v228, v229
    v_cvt_pk_bf16_f32 v219, v230, v231
    v_mfma_f32_16x16x32_bf16 v[8:11], v[132:135], v[212:215], v[8:11]
    v_accvgpr_read_b32 v232, a163
    v_accvgpr_read_b32 v233, a167
    v_accvgpr_read_b32 v234, a171
    v_accvgpr_read_b32 v235, a175
    v_accvgpr_read_b32 v238, a187
    v_accvgpr_read_b32 v239, a191
    v_mul_f32 v232, s49, v232
    v_mul_f32 v233, s49, v233
    v_mul_f32 v234, s49, v234
    v_mul_f32 v235, s49, v235
    v_mul_f32 v238, s49, v238
    v_mul_f32 v239, s49, v239
    v_cvt_pk_bf16_f32 v220, v232, v233
    v_cvt_pk_bf16_f32 v221, v234, v235
    v_cvt_pk_bf16_f32 v223, v238, v239
    v_mfma_f32_16x16x32_bf16 v[8:11], v[136:139], v[216:219], v[8:11]
    v_sub_f32 v12, v12, v52
    v_sub_f32 v13, v13, v52
    v_sub_f32 v14, v14, v52
    v_sub_f32 v15, v15, v52
    v_exp_f32 v12, v12
    v_exp_f32 v13, v13
    v_exp_f32 v14, v14
    v_exp_f32 v15, v15
    v_mfma_f32_16x16x32_bf16 v[8:11], v[140:143], v[220:223], v[8:11]
    v_cvt_pk_bf16_f32 v38, v12, v13
    v_cvt_pk_bf16_f32 v39, v14, v15
    v_mfma_f32_16x16x32_bf16 v[12:15], v[144:147], v[208:211], 0
    v_max3_f32 v56, v0, v1, v2
    v_max3_f32 v57, v3, v4, v5
    v_mfma_f32_16x16x32_bf16 v[12:15], v[148:151], v[212:215], v[12:15]
    v_max3_f32 v56, v56, v6, v7
    v_max_f32 v56, v56, v57
    v_mfma_f32_16x16x32_bf16 v[12:15], v[152:155], v[216:219], v[12:15]
    v_mov_b32 v57, v56
    v_accvgpr_read_b32 v228, a192
    v_mfma_f32_16x16x32_bf16 v[12:15], v[156:159], v[220:223], v[12:15]
    v_permlane32_swap_b32 v56, v57
    v_max_f32 v56, v56, v57
    v_mfma_f32_16x16x32_bf16 a[96:99], v[160:163], v[36:39], 0
    v_mov_b32 v57, v56
    v_accvgpr_read_b32 v229, a196
    v_mfma_f32_16x16x32_bf16 a[100:103], v[164:167], v[36:39], 0
    v_accvgpr_read_b32 v230, a200
    v_accvgpr_read_b32 v231, a204
    v_mfma_f32_16x16x32_bf16 a[104:107], v[168:171], v[36:39], 0
    v_accvgpr_read_b32 v232, a208
    v_accvgpr_read_b32 v233, a212
    v_mfma_f32_16x16x32_bf16 a[108:111], v[172:175], v[36:39], 0
    v_accvgpr_read_b32 v234, a216
    v_accvgpr_read_b32 v235, a220
    v_mfma_f32_16x16x32_bf16 a[112:115], v[176:179], v[36:39], 0
    v_mul_f32 v228, s49, v228
    v_mul_f32 v229, s49, v229
    v_mfma_f32_16x16x32_bf16 a[116:119], v[180:183], v[36:39], 0
    v_mul_f32 v230, s49, v230
    v_mul_f32 v231, s49, v231
    v_mfma_f32_16x16x32_bf16 a[120:123], v[184:187], v[36:39], 0
    v_mul_f32 v232, s49, v232
    v_mul_f32 v233, s49, v233
    v_mfma_f32_16x16x32_bf16 a[124:127], v[188:191], v[36:39], 0
    v_mul_f32 v234, s49, v234
    v_mul_f32 v235, s49, v235
    v_cvt_pk_bf16_f32 v16, v228, v229
    v_cvt_pk_bf16_f32 v17, v230, v231
    v_cvt_pk_bf16_f32 v18, v232, v233
    v_cvt_pk_bf16_f32 v19, v234, v235
    v_permlane16_swap_b32 v56, v57
    v_max_f32 v56, v56, v57
    v_sub_f32 v0, v0, v56
    v_sub_f32 v1, v1, v56
    v_sub_f32 v2, v2, v56
    v_sub_f32 v3, v3, v56
    v_exp_f32 v0, v0
    v_exp_f32 v1, v1
    v_exp_f32 v2, v2
    v_exp_f32 v3, v3
    v_mfma_f32_16x16x32_bf16 a[224:227], a[252:255], v[36:39], 0
    v_accvgpr_read_b32 v228, a193
    v_accvgpr_read_b32 v229, a197
    v_accvgpr_read_b32 v230, a201
    v_accvgpr_read_b32 v231, a205
    v_accvgpr_read_b32 v232, a209
    v_accvgpr_read_b32 v233, a213
    v_accvgpr_read_b32 v234, a217
    v_accvgpr_read_b32 v235, a221
    v_mul_f32 v228, s49, v228
    v_mul_f32 v229, s49, v229
    v_mul_f32 v230, s49, v230
    v_mul_f32 v231, s49, v231
    v_mul_f32 v232, s49, v232
    v_mul_f32 v233, s49, v233
    v_mul_f32 v234, s49, v234
    v_mul_f32 v235, s49, v235
    v_cvt_pk_bf16_f32 v20, v228, v229
    v_cvt_pk_bf16_f32 v21, v230, v231
    v_cvt_pk_bf16_f32 v22, v232, v233
    v_cvt_pk_bf16_f32 v23, v234, v235
    v_cvt_pk_bf16_f32 v32, v0, v1
    v_cvt_pk_bf16_f32 v33, v2, v3
    v_mfma_f32_16x16x32_bf16 v[0:3], v[128:131], v[16:19], 0
    v_accvgpr_read_b32 v228, a194
    v_accvgpr_read_b32 v229, a198
    v_accvgpr_read_b32 v230, a202
    v_accvgpr_read_b32 v231, a206
    v_accvgpr_read_b32 v232, a210
    v_accvgpr_read_b32 v233, a214
    v_accvgpr_read_b32 v234, a218
    v_accvgpr_read_b32 v235, a222
    v_mul_f32 v228, s49, v228
    v_mul_f32 v229, s49, v229
    v_mul_f32 v230, s49, v230
    v_mul_f32 v231, s49, v231
    v_mul_f32 v232, s49, v232
    v_mul_f32 v233, s49, v233
    v_mul_f32 v234, s49, v234
    v_mul_f32 v235, s49, v235
    v_cvt_pk_bf16_f32 v24, v228, v229
    v_cvt_pk_bf16_f32 v25, v230, v231
    v_cvt_pk_bf16_f32 v26, v232, v233
    v_cvt_pk_bf16_f32 v27, v234, v235
    v_mfma_f32_16x16x32_bf16 v[0:3], v[132:135], v[20:23], v[0:3]
    v_accvgpr_read_b32 v228, a195
    v_accvgpr_read_b32 v229, a199
    v_accvgpr_read_b32 v230, a203
    v_accvgpr_read_b32 v231, a207
    v_accvgpr_read_b32 v232, a211
    v_accvgpr_read_b32 v233, a215
    v_accvgpr_read_b32 v234, a219
    v_accvgpr_read_b32 v235, a223
    v_mul_f32 v228, s49, v228
    v_mul_f32 v229, s49, v229
    v_mul_f32 v230, s49, v230
    v_mul_f32 v231, s49, v231
    v_mul_f32 v232, s49, v232
    v_mul_f32 v233, s49, v233
    v_mul_f32 v234, s49, v234
    v_mul_f32 v235, s49, v235
    v_cvt_pk_bf16_f32 v28, v228, v229
    v_cvt_pk_bf16_f32 v29, v230, v231
    v_cvt_pk_bf16_f32 v30, v232, v233
    v_cvt_pk_bf16_f32 v31, v234, v235
    v_mfma_f32_16x16x32_bf16 v[0:3], v[136:139], v[24:27], v[0:3]
    v_sub_f32 v4, v4, v56
    v_sub_f32 v5, v5, v56
    v_sub_f32 v6, v6, v56
    v_sub_f32 v7, v7, v56
    v_exp_f32 v4, v4
    v_exp_f32 v5, v5
    v_exp_f32 v6, v6
    v_exp_f32 v7, v7
    v_mfma_f32_16x16x32_bf16 v[0:3], v[140:143], v[28:31], v[0:3]
    v_cvt_pk_bf16_f32 v34, v4, v5
    v_cvt_pk_bf16_f32 v35, v6, v7
    v_mfma_f32_16x16x32_bf16 v[4:7], v[144:147], v[16:19], 0
    s_waitcnt vmcnt(24)
    ds_read_b128 v[128:131], v240 offset:33280
    ds_read_b128 v[132:135], v240 offset:33296
    v_mfma_f32_16x16x32_bf16 v[4:7], v[148:151], v[20:23], v[4:7]
    s_nop 0
    ds_read_b128 v[136:139], v240 offset:33312
    ds_read_b128 v[140:143], v240 offset:33328
    v_mfma_f32_16x16x32_bf16 v[4:7], v[152:155], v[24:27], v[4:7]
    ds_read_b128 v[144:147], v240 offset:37440
    v_max3_f32 v60, v8, v9, v10
    v_mfma_f32_16x16x32_bf16 v[4:7], v[156:159], v[28:31], v[4:7]
    v_max3_f32 v61, v11, v12, v13
    v_max3_f32 v60, v60, v14, v15
    v_mfma_f32_16x16x32_bf16 a[128:131], v[160:163], v[32:35], 0
    v_max_f32 v60, v60, v61
    v_mov_b32 v61, v60
    v_mfma_f32_16x16x32_bf16 a[132:135], v[164:167], v[32:35], 0
    ds_read_b128 v[148:151], v240 offset:37456
    v_permlane32_swap_b32 v60, v61
    v_mfma_f32_16x16x32_bf16 a[136:139], v[168:171], v[32:35], 0
    v_max_f32 v60, v60, v61
    v_mov_b32 v61, v60
    v_mfma_f32_16x16x32_bf16 a[140:143], v[172:175], v[32:35], 0
    v_sub_f32 v41, 0, v40
    v_sub_f32 v42, 0, v40
    v_mfma_f32_16x16x32_bf16 a[144:147], v[176:179], v[32:35], 0
    v_sub_f32 v43, 0, v40
    v_sub_f32 v40, 0, v40
    v_mfma_f32_16x16x32_bf16 a[148:151], v[180:183], v[32:35], 0
    ds_read_b128 v[152:155], v240 offset:37472
    v_permlane16_swap_b32 v60, v61
    v_mfma_f32_16x16x32_bf16 a[152:155], v[184:187], v[32:35], 0
    v_max_f32 v60, v60, v61
    v_sub_f32 v8, v8, v60
    v_mfma_f32_16x16x32_bf16 a[156:159], v[188:191], v[32:35], 0
    v_sub_f32 v9, v9, v60
    v_sub_f32 v10, v10, v60
    v_sub_f32 v11, v11, v60
    v_exp_f32 v8, v8
    v_exp_f32 v9, v9
    v_exp_f32 v10, v10
    v_exp_f32 v11, v11
    v_mfma_f32_16x16x32_bf16 a[228:231], a[252:255], v[32:35], 0
    s_waitcnt lgkmcnt(2)
    ds_read_b128 v[156:159], v240 offset:37488
    v_cvt_pk_bf16_f32 v36, v8, v9
    v_cvt_pk_bf16_f32 v37, v10, v11
    v_mfma_f32_16x16x32_bf16 v[8:11], v[128:131], v[64:67], v[40:43]
    v_sub_f32 v12, v12, v60
    v_sub_f32 v13, v13, v60
    v_mfma_f32_16x16x32_bf16 v[8:11], v[132:135], v[68:71], v[8:11]
    v_sub_f32 v14, v14, v60
    v_sub_f32 v15, v15, v60
    v_mfma_f32_16x16x32_bf16 v[8:11], v[136:139], v[72:75], v[8:11]
    v_exp_f32 v12, v12
    v_exp_f32 v13, v13
    v_exp_f32 v14, v14
    v_exp_f32 v15, v15
    v_mfma_f32_16x16x32_bf16 v[8:11], v[140:143], v[76:79], v[8:11]
    v_cvt_pk_bf16_f32 v38, v12, v13
    v_cvt_pk_bf16_f32 v39, v14, v15
    v_mfma_f32_16x16x32_bf16 v[12:15], v[144:147], v[64:67], v[40:43]
    s_waitcnt lgkmcnt(2)
    v_max3_f32 v224, v0, v1, v2
    v_max3_f32 v225, v3, v4, v5
    v_mfma_f32_16x16x32_bf16 v[12:15], v[148:151], v[68:71], v[12:15]
    s_waitcnt lgkmcnt(1)
    v_max3_f32 v224, v224, v6, v7
    v_max_f32 v224, v224, v225
    v_mfma_f32_16x16x32_bf16 v[12:15], v[152:155], v[72:75], v[12:15]
    s_waitcnt lgkmcnt(0)
    v_mov_b32 v225, v224
    v_sub_f32 v45, 0, v44
    v_mfma_f32_16x16x32_bf16 v[12:15], v[156:159], v[76:79], v[12:15]
    s_add_u32 m0, s46, 0x8200
    v_permlane32_swap_b32 v224, v225
    v_max_f32 v224, v224, v225
    v_mfma_f32_16x16x32_bf16 a[160:163], v[160:163], v[36:39], 0
    buffer_load_dwordx4 v245, s[16:19], s42 offen nt lds
    v_mfma_f32_16x16x32_bf16 a[164:167], v[164:167], v[36:39], 0
    s_add_u32 m0, s46, 0x8210
    v_mov_b32 v225, v224
    v_sub_f32 v46, 0, v44
    v_mfma_f32_16x16x32_bf16 a[168:171], v[168:171], v[36:39], 0
    buffer_load_dwordx4 v245, s[16:19], s42 offen offset:1024 nt lds
    v_mfma_f32_16x16x32_bf16 a[172:175], v[172:175], v[36:39], 0
    s_add_u32 m0, s46, 0x8220
    v_sub_f32 v47, 0, v44
    v_sub_f32 v44, 0, v44
    v_mfma_f32_16x16x32_bf16 a[176:179], v[176:179], v[36:39], 0
    buffer_load_dwordx4 v245, s[16:19], s42 offen offset:2048 nt lds
    v_mfma_f32_16x16x32_bf16 a[180:183], v[180:183], v[36:39], 0
    s_add_u32 m0, s46, 0x8230
    v_permlane16_swap_b32 v224, v225
    v_max_f32 v224, v224, v225
    v_mfma_f32_16x16x32_bf16 a[184:187], v[184:187], v[36:39], 0
    v_sub_f32 v0, v0, v224
    v_sub_f32 v1, v1, v224
    v_mfma_f32_16x16x32_bf16 a[188:191], v[188:191], v[36:39], 0
    v_sub_f32 v2, v2, v224
    v_sub_f32 v3, v3, v224
    v_exp_f32 v0, v0
    v_exp_f32 v1, v1
    v_exp_f32 v2, v2
    v_exp_f32 v3, v3
    v_mfma_f32_16x16x32_bf16 a[232:235], a[252:255], v[36:39], 0
    buffer_load_dwordx4 v245, s[16:19], s42 offen offset:3072 nt lds
    v_cvt_pk_bf16_f32 v32, v0, v1
    v_cvt_pk_bf16_f32 v33, v2, v3
    v_mfma_f32_16x16x32_bf16 v[0:3], v[128:131], v[80:83], v[44:47]
    s_add_u32 m0, s46, 0x9240
    v_sub_f32 v4, v4, v224
    v_sub_f32 v5, v5, v224
    v_mfma_f32_16x16x32_bf16 v[0:3], v[132:135], v[84:87], v[0:3]
    buffer_load_dwordx4 v245, s[16:19], s43 offen nt lds
    v_mfma_f32_16x16x32_bf16 v[0:3], v[136:139], v[88:91], v[0:3]
    s_add_u32 m0, s46, 0x9250
    v_sub_f32 v6, v6, v224
    v_sub_f32 v7, v7, v224
    v_exp_f32 v4, v4
    v_exp_f32 v5, v5
    v_exp_f32 v6, v6
    v_exp_f32 v7, v7
    v_mfma_f32_16x16x32_bf16 v[0:3], v[140:143], v[92:95], v[0:3]
    v_cvt_pk_bf16_f32 v34, v4, v5
    v_cvt_pk_bf16_f32 v35, v6, v7
    v_mfma_f32_16x16x32_bf16 v[4:7], v[144:147], v[80:83], v[44:47]
    buffer_load_dwordx4 v245, s[16:19], s43 offen offset:1024 nt lds
    v_mfma_f32_16x16x32_bf16 v[4:7], v[148:151], v[84:87], v[4:7]
    s_add_u32 m0, s46, 0x9260
    v_exp_f32 v8, v8
    v_mfma_f32_16x16x32_bf16 v[4:7], v[152:155], v[88:91], v[4:7]
    buffer_load_dwordx4 v245, s[16:19], s43 offen offset:2048 nt lds
    v_mfma_f32_16x16x32_bf16 v[4:7], v[156:159], v[92:95], v[4:7]
    s_add_u32 m0, s46, 0x9270
    v_exp_f32 v9, v9
    v_mfma_f32_16x16x32_bf16 a[192:195], v[160:163], v[32:35], 0
    buffer_load_dwordx4 v245, s[16:19], s43 offen offset:3072 nt lds
    v_mfma_f32_16x16x32_bf16 a[196:199], v[164:167], v[32:35], 0
    s_add_u32 s42, s42, 8192
    v_exp_f32 v10, v10
    v_mfma_f32_16x16x32_bf16 a[200:203], v[168:171], v[32:35], 0
    s_and_b32 s42, s42, 0x1ffff
    v_exp_f32 v11, v11
    v_mfma_f32_16x16x32_bf16 a[204:207], v[172:175], v[32:35], 0
    s_xor_b32 s43, s42, 4096
    v_exp_f32 v12, v12
    v_mfma_f32_16x16x32_bf16 a[208:211], v[176:179], v[32:35], 0
    v_exp_f32 v13, v13
    v_mfma_f32_16x16x32_bf16 a[212:215], v[180:183], v[32:35], 0
    v_exp_f32 v14, v14
    v_mfma_f32_16x16x32_bf16 a[216:219], v[184:187], v[32:35], 0
    v_exp_f32 v15, v15
    v_mfma_f32_16x16x32_bf16 a[220:223], v[188:191], v[32:35], 0
    v_lshrrev_b32 v234, 6, v251
    v_lshlrev_b32 v234, 7, v234
    v_mfma_f32_16x16x32_bf16 a[236:239], a[252:255], v[32:35], 0
    s_waitcnt vmcnt(24)
    ds_read_b64_tr_b16 v[160:161], v241 offset:33792
    ds_read_b64_tr_b16 v[162:163], v241 offset:38016
    ds_read_b64_tr_b16 v[164:165], v241 offset:33824
    ds_read_b64_tr_b16 v[166:167], v241 offset:38048
    ds_read_b64_tr_b16 v[168:169], v242 offset:33792
    ds_read_b64_tr_b16 v[170:171], v242 offset:38016
    ds_read_b64_tr_b16 v[172:173], v242 offset:33824
    ds_read_b64_tr_b16 v[174:175], v242 offset:38048
    ds_read_b64_tr_b16 v[176:177], v243 offset:33792
    ds_read_b64_tr_b16 v[178:179], v243 offset:38016
    ds_read_b64_tr_b16 v[180:181], v243 offset:33824
    ds_read_b64_tr_b16 v[182:183], v243 offset:38048
    ds_read_b64_tr_b16 v[184:185], v244 offset:33792
    ds_read_b64_tr_b16 v[186:187], v244 offset:38016
    ds_read_b64_tr_b16 v[188:189], v244 offset:33824
    ds_read_b64_tr_b16 v[190:191], v244 offset:38048
    v_lshlrev_b32 v239, 3, v251
    v_and_b32 v235, 128, v239
    v_and_b32 v237, 0x1f00, v239
    v_lshl_add_u32 v235, v237, 2, v235
    v_sub_f32 v49, 0, v48
    v_sub_f32 v50, 0, v48
    v_sub_f32 v51, 0, v48
    v_sub_f32 v48, 0, v48
    v_sub_f32 v53, 0, v52
    v_sub_f32 v54, 0, v52
    v_sub_f32 v55, 0, v52
    v_sub_f32 v52, 0, v52
    v_sub_f32 v57, 0, v56
    v_sub_f32 v58, 0, v56
    v_sub_f32 v59, 0, v56
    v_sub_f32 v56, 0, v56
    v_sub_f32 v61, 0, v60
    v_sub_f32 v62, 0, v60
    v_sub_f32 v63, 0, v60
    v_sub_f32 v60, 0, v60
    v_sub_f32 v225, 0, v224
    v_sub_f32 v226, 0, v224
    v_sub_f32 v227, 0, v224
    v_sub_f32 v224, 0, v224
    v_cvt_pk_bf16_f32 v36, v8, v9
    v_cvt_pk_bf16_f32 v37, v10, v11
    v_cvt_pk_bf16_f32 v38, v12, v13
    v_cvt_pk_bf16_f32 v39, v14, v15
L_att:
    v_mfma_f32_16x16x32_bf16 v[8:11], v[128:131], v[96:99], v[48:51]
    v_exp_f32 v0, v0
    v_mfma_f32_16x16x32_bf16 v[8:11], v[132:135], v[100:103], v[8:11]
    v_exp_f32 v1, v1
    v_mfma_f32_16x16x32_bf16 v[8:11], v[136:139], v[104:107], v[8:11]
    v_exp_f32 v2, v2
    v_mfma_f32_16x16x32_bf16 v[8:11], v[140:143], v[108:111], v[8:11]
    v_exp_f32 v3, v3
    v_mfma_f32_16x16x32_bf16 v[12:15], v[144:147], v[96:99], v[48:51]
    v_cvt_pk_bf16_f32 v32, v0, v1
    v_cvt_pk_bf16_f32 v33, v2, v3
    v_mfma_f32_16x16x32_bf16 v[12:15], v[148:151], v[100:103], v[12:15]
    v_exp_f32 v4, v4
    v_mfma_f32_16x16x32_bf16 v[12:15], v[152:155], v[104:107], v[12:15]
    v_exp_f32 v5, v5
    v_mfma_f32_16x16x32_bf16 v[12:15], v[156:159], v[108:111], v[12:15]
    s_waitcnt lgkmcnt(14)
    v_exp_f32 v6, v6
    v_mfma_f32_16x16x32_bf16 a[0:3], v[160:163], v[36:39], a[0:3]
    s_waitcnt lgkmcnt(0)
    v_exp_f32 v7, v7
    v_mfma_f32_16x16x32_bf16 a[4:7], v[164:167], v[36:39], a[4:7]
    v_cvt_pk_bf16_f32 v34, v4, v5
    v_cvt_pk_bf16_f32 v35, v6, v7
    v_mfma_f32_16x16x32_bf16 a[8:11], v[168:171], v[36:39], a[8:11]
    v_exp_f32 v8, v8
    v_mfma_f32_16x16x32_bf16 a[12:15], v[172:175], v[36:39], a[12:15]
    v_exp_f32 v9, v9
    v_mfma_f32_16x16x32_bf16 a[16:19], v[176:179], v[36:39], a[16:19]
    v_exp_f32 v10, v10
    v_mfma_f32_16x16x32_bf16 a[20:23], v[180:183], v[36:39], a[20:23]
    v_exp_f32 v11, v11
    v_mfma_f32_16x16x32_bf16 a[24:27], v[184:187], v[36:39], a[24:27]
    v_exp_f32 v12, v12
    v_mfma_f32_16x16x32_bf16 a[28:31], v[188:191], v[36:39], a[28:31]
    v_exp_f32 v13, v13
    v_mfma_f32_16x16x32_bf16 a[240:243], a[252:255], v[36:39], a[240:243]
    v_cvt_pk_bf16_f32 v36, v8, v9
    v_cvt_pk_bf16_f32 v37, v10, v11
    v_mfma_f32_16x16x32_bf16 v[0:3], v[128:131], v[112:115], v[52:55]
    v_exp_f32 v14, v14
    v_mfma_f32_16x16x32_bf16 v[0:3], v[132:135], v[116:119], v[0:3]
    v_exp_f32 v15, v15
    v_mfma_f32_16x16x32_bf16 v[0:3], v[136:139], v[120:123], v[0:3]
    v_cvt_pk_bf16_f32 v38, v12, v13
    v_cvt_pk_bf16_f32 v39, v14, v15
    v_mfma_f32_16x16x32_bf16 v[0:3], v[140:143], v[124:127], v[0:3]
    s_barrier
    v_mfma_f32_16x16x32_bf16 v[4:7], v[144:147], v[112:115], v[52:55]
    v_mfma_f32_16x16x32_bf16 v[4:7], v[148:151], v[116:119], v[4:7]
    v_mfma_f32_16x16x32_bf16 v[4:7], v[152:155], v[120:123], v[4:7]
    s_add_u32 m0, s47, 0x8400
    v_exp_f32 v0, v0
    v_mfma_f32_16x16x32_bf16 v[4:7], v[156:159], v[124:127], v[4:7]
    buffer_load_dwordx4 v245, s[20:23], s44 offen nt lds
    v_mfma_f32_16x16x32_bf16 a[32:35], v[160:163], v[32:35], a[32:35]
    v_exp_f32 v1, v1
    v_mfma_f32_16x16x32_bf16 a[36:39], v[164:167], v[32:35], a[36:39]
    s_add_u32 m0, s47, 0x8420
    v_exp_f32 v2, v2
    v_mfma_f32_16x16x32_bf16 a[40:43], v[168:171], v[32:35], a[40:43]
    buffer_load_dwordx4 v245, s[20:23], s44 offen offset:1024 nt lds
    v_mfma_f32_16x16x32_bf16 a[44:47], v[172:175], v[32:35], a[44:47]
    v_exp_f32 v3, v3
    v_mfma_f32_16x16x32_bf16 a[48:51], v[176:179], v[32:35], a[48:51]
    v_exp_f32 v4, v4
    v_mfma_f32_16x16x32_bf16 a[52:55], v[180:183], v[32:35], a[52:55]
    v_exp_f32 v5, v5
    v_mfma_f32_16x16x32_bf16 a[56:59], v[184:187], v[32:35], a[56:59]
    s_add_u32 m0, s47, 0x8440
    v_exp_f32 v6, v6
    v_mfma_f32_16x16x32_bf16 a[60:63], v[188:191], v[32:35], a[60:63]
    buffer_load_dwordx4 v245, s[20:23], s44 offen offset:2048 nt lds
    v_mfma_f32_16x16x32_bf16 a[244:247], a[252:255], v[32:35], a[244:247]
    v_cvt_pk_bf16_f32 v32, v0, v1
    v_cvt_pk_bf16_f32 v33, v2, v3
    v_mfma_f32_16x16x32_bf16 v[8:11], v[128:131], v[192:195], v[56:59]
    v_exp_f32 v7, v7
    v_mfma_f32_16x16x32_bf16 v[8:11], v[132:135], v[196:199], v[8:11]
    s_add_u32 m0, s47, 0x8460
    v_cvt_pk_bf16_f32 v34, v4, v5
    v_cvt_pk_bf16_f32 v35, v6, v7
    v_mfma_f32_16x16x32_bf16 v[8:11], v[136:139], v[200:203], v[8:11]
    buffer_load_dwordx4 v245, s[20:23], s44 offen offset:3072 nt lds
    v_mfma_f32_16x16x32_bf16 v[8:11], v[140:143], v[204:207], v[8:11]
    v_mfma_f32_16x16x32_bf16 v[12:15], v[144:147], v[192:195], v[56:59]
    v_mfma_f32_16x16x32_bf16 v[12:15], v[148:151], v[196:199], v[12:15]
    v_mfma_f32_16x16x32_bf16 v[12:15], v[152:155], v[200:203], v[12:15]
    s_add_u32 m0, s47, 0x9480
    v_exp_f32 v8, v8
    v_mfma_f32_16x16x32_bf16 v[12:15], v[156:159], v[204:207], v[12:15]
    buffer_load_dwordx4 v245, s[20:23], s45 offen nt lds
    v_mfma_f32_16x16x32_bf16 a[64:67], v[160:163], v[36:39], a[64:67]
    v_exp_f32 v9, v9
    v_mfma_f32_16x16x32_bf16 a[68:71], v[164:167], v[36:39], a[68:71]
    v_exp_f32 v10, v10
    v_mfma_f32_16x16x32_bf16 a[72:75], v[168:171], v[36:39], a[72:75]
    s_add_u32 m0, s47, 0x94a0
    v_exp_f32 v11, v11
    v_mfma_f32_16x16x32_bf16 a[76:79], v[172:175], v[36:39], a[76:79]
    buffer_load_dwordx4 v245, s[20:23], s45 offen offset:1024 nt lds
    v_mfma_f32_16x16x32_bf16 a[80:83], v[176:179], v[36:39], a[80:83]
    v_exp_f32 v12, v12
    v_mfma_f32_16x16x32_bf16 a[84:87], v[180:183], v[36:39], a[84:87]
    v_exp_f32 v13, v13
    v_mfma_f32_16x16x32_bf16 a[88:91], v[184:187], v[36:39], a[88:91]
    v_exp_f32 v14, v14
    v_mfma_f32_16x16x32_bf16 a[92:95], v[188:191], v[36:39], a[92:95]
    s_add_u32 m0, s47, 0x94c0
    v_exp_f32 v15, v15
    v_mfma_f32_16x16x32_bf16 a[248:251], a[252:255], v[36:39], a[248:251]
    buffer_load_dwordx4 v245, s[20:23], s45 offen offset:2048 nt lds
    v_mfma_f32_16x16x32_bf16 v[0:3], v[128:131], v[208:211], v[60:63]
    v_cvt_pk_bf16_f32 v36, v8, v9
    v_cvt_pk_bf16_f32 v37, v10, v11
    v_mfma_f32_16x16x32_bf16 v[0:3], v[132:135], v[212:215], v[0:3]
    v_cvt_pk_bf16_f32 v38, v12, v13
    v_cvt_pk_bf16_f32 v39, v14, v15
    v_mfma_f32_16x16x32_bf16 v[0:3], v[136:139], v[216:219], v[0:3]
    s_add_u32 m0, s47, 0x94e0
    v_mfma_f32_16x16x32_bf16 v[0:3], v[140:143], v[220:223], v[0:3]
    buffer_load_dwordx4 v245, s[20:23], s45 offen offset:3072 nt lds
    v_mfma_f32_16x16x32_bf16 v[4:7], v[144:147], v[208:211], v[60:63]
    v_mfma_f32_16x16x32_bf16 v[4:7], v[148:151], v[212:215], v[4:7]
    v_mfma_f32_16x16x32_bf16 v[4:7], v[152:155], v[216:219], v[4:7]
    s_add_u32 s44, s44, 8192
    v_exp_f32 v0, v0
    v_mfma_f32_16x16x32_bf16 v[4:7], v[156:159], v[220:223], v[4:7]
    s_and_b32 s44, s44, 0x1ffff
    v_exp_f32 v1, v1
    v_mfma_f32_16x16x32_bf16 a[96:99], v[160:163], v[32:35], a[96:99]
    s_xor_b32 s45, s44, 4096
    v_exp_f32 v2, v2
    v_mfma_f32_16x16x32_bf16 a[100:103], v[164:167], v[32:35], a[100:103]
    v_exp_f32 v3, v3
    v_mfma_f32_16x16x32_bf16 a[104:107], v[168:171], v[32:35], a[104:107]
    v_exp_f32 v4, v4
    v_mfma_f32_16x16x32_bf16 a[108:111], v[172:175], v[32:35], a[108:111]
    v_exp_f32 v5, v5
    v_mfma_f32_16x16x32_bf16 a[112:115], v[176:179], v[32:35], a[112:115]
    v_exp_f32 v6, v6
    v_mfma_f32_16x16x32_bf16 a[116:119], v[180:183], v[32:35], a[116:119]
    v_exp_f32 v7, v7
    v_mfma_f32_16x16x32_bf16 a[120:123], v[184:187], v[32:35], a[120:123]
    v_mfma_f32_16x16x32_bf16 a[124:127], v[188:191], v[32:35], a[124:127]
    v_mfma_f32_16x16x32_bf16 a[224:227], a[252:255], v[32:35], a[224:227]
    v_cvt_pk_bf16_f32 v32, v0, v1
    v_cvt_pk_bf16_f32 v33, v2, v3
    v_mfma_f32_16x16x32_bf16 v[8:11], v[128:131], v[16:19], v[224:227]
    s_waitcnt vmcnt(24)
    ds_read_b128 v[128:131], v240 offset:0
    v_cvt_pk_bf16_f32 v34, v4, v5
    v_mfma_f32_16x16x32_bf16 v[8:11], v[132:135], v[20:23], v[8:11]
    ds_read_b128 v[132:135], v240 offset:16
    v_cvt_pk_bf16_f32 v35, v6, v7
    v_mfma_f32_16x16x32_bf16 v[8:11], v[136:139], v[24:27], v[8:11]
    ds_read_b128 v[136:139], v240 offset:32
    v_mfma_f32_16x16x32_bf16 v[8:11], v[140:143], v[28:31], v[8:11]
    ds_read_b128 v[140:143], v240 offset:48
    v_mfma_f32_16x16x32_bf16 v[12:15], v[144:147], v[16:19], v[224:227]
    ds_read_b128 v[144:147], v240 offset:4160
    v_mfma_f32_16x16x32_bf16 v[12:15], v[148:151], v[20:23], v[12:15]
    ds_read_b128 v[148:151], v240 offset:4176
    v_mfma_f32_16x16x32_bf16 v[12:15], v[152:155], v[24:27], v[12:15]
    ds_read_b128 v[152:155], v240 offset:4192
    v_mfma_f32_16x16x32_bf16 v[12:15], v[156:159], v[28:31], v[12:15]
    ds_read_b128 v[156:159], v240 offset:4208
    v_mfma_f32_16x16x32_bf16 a[128:131], v[160:163], v[36:39], a[128:131]
    v_exp_f32 v8, v8
    v_mfma_f32_16x16x32_bf16 a[132:135], v[164:167], v[36:39], a[132:135]
    v_exp_f32 v9, v9
    v_mfma_f32_16x16x32_bf16 a[136:139], v[168:171], v[36:39], a[136:139]
    v_exp_f32 v10, v10
    v_mfma_f32_16x16x32_bf16 a[140:143], v[172:175], v[36:39], a[140:143]
    v_exp_f32 v11, v11
    v_mfma_f32_16x16x32_bf16 a[144:147], v[176:179], v[36:39], a[144:147]
    v_exp_f32 v12, v12
    v_mfma_f32_16x16x32_bf16 a[148:151], v[180:183], v[36:39], a[148:151]
    s_cmp_eq_u32 s39, 1
    s_cselect_b32 s18, 0, s18
    v_mfma_f32_16x16x32_bf16 a[152:155], v[184:187], v[36:39], a[152:155]
    v_exp_f32 v13, v13
    v_mfma_f32_16x16x32_bf16 a[156:159], v[188:191], v[36:39], a[156:159]
    v_exp_f32 v14, v14
    v_mfma_f32_16x16x32_bf16 a[228:231], a[252:255], v[36:39], a[228:231]
    s_waitcnt lgkmcnt(0)
    v_cvt_pk_bf16_f32 v36, v8, v9
    v_cvt_pk_bf16_f32 v37, v10, v11
    v_mfma_f32_16x16x32_bf16 v[0:3], v[128:131], v[64:67], v[40:43]
    s_add_u32 m0, s46, 0
    v_exp_f32 v15, v15
    v_mfma_f32_16x16x32_bf16 v[0:3], v[132:135], v[68:71], v[0:3]
    buffer_load_dwordx4 v245, s[16:19], s42 offen nt lds
    v_mfma_f32_16x16x32_bf16 v[0:3], v[136:139], v[72:75], v[0:3]
    s_add_u32 m0, s46, 16
    v_cvt_pk_bf16_f32 v38, v12, v13
    v_cvt_pk_bf16_f32 v39, v14, v15
    v_mfma_f32_16x16x32_bf16 v[0:3], v[140:143], v[76:79], v[0:3]
    buffer_load_dwordx4 v245, s[16:19], s42 offen offset:1024 nt lds
    v_mfma_f32_16x16x32_bf16 v[4:7], v[144:147], v[64:67], v[40:43]
    v_mfma_f32_16x16x32_bf16 v[4:7], v[148:151], v[68:71], v[4:7]
    s_add_u32 m0, s46, 32
    v_mfma_f32_16x16x32_bf16 v[4:7], v[152:155], v[72:75], v[4:7]
    buffer_load_dwordx4 v245, s[16:19], s42 offen offset:2048 nt lds
    v_mfma_f32_16x16x32_bf16 v[4:7], v[156:159], v[76:79], v[4:7]
    v_exp_f32 v0, v0
    v_mfma_f32_16x16x32_bf16 a[160:163], v[160:163], v[32:35], a[160:163]
    v_exp_f32 v1, v1
    v_mfma_f32_16x16x32_bf16 a[164:167], v[164:167], v[32:35], a[164:167]
    s_add_u32 m0, s46, 48
    v_exp_f32 v2, v2
    v_mfma_f32_16x16x32_bf16 a[168:171], v[168:171], v[32:35], a[168:171]
    buffer_load_dwordx4 v245, s[16:19], s42 offen offset:3072 nt lds
    v_mfma_f32_16x16x32_bf16 a[172:175], v[172:175], v[32:35], a[172:175]
    v_exp_f32 v3, v3
    v_mfma_f32_16x16x32_bf16 a[176:179], v[176:179], v[32:35], a[176:179]
    s_add_u32 m0, s46, 0x1040
    v_exp_f32 v4, v4
    v_mfma_f32_16x16x32_bf16 a[180:183], v[180:183], v[32:35], a[180:183]
    buffer_load_dwordx4 v245, s[16:19], s43 offen nt lds
    v_mfma_f32_16x16x32_bf16 a[184:187], v[184:187], v[32:35], a[184:187]
    v_exp_f32 v5, v5
    v_mfma_f32_16x16x32_bf16 a[188:191], v[188:191], v[32:35], a[188:191]
    s_add_u32 m0, s46, 0x1050
    v_exp_f32 v6, v6
    v_mfma_f32_16x16x32_bf16 a[232:235], a[252:255], v[32:35], a[232:235]
    buffer_load_dwordx4 v245, s[16:19], s43 offen offset:1024 nt lds
    v_mfma_f32_16x16x32_bf16 v[8:11], v[128:131], v[80:83], v[44:47]
    v_cvt_pk_bf16_f32 v32, v0, v1
    v_cvt_pk_bf16_f32 v33, v2, v3
    v_mfma_f32_16x16x32_bf16 v[8:11], v[132:135], v[84:87], v[8:11]
    v_exp_f32 v7, v7
    v_mfma_f32_16x16x32_bf16 v[8:11], v[136:139], v[88:91], v[8:11]
    s_add_u32 m0, s46, 0x1060
    v_cvt_pk_bf16_f32 v34, v4, v5
    v_cvt_pk_bf16_f32 v35, v6, v7
    v_mfma_f32_16x16x32_bf16 v[8:11], v[140:143], v[92:95], v[8:11]
    buffer_load_dwordx4 v245, s[16:19], s43 offen offset:2048 nt lds
    v_mfma_f32_16x16x32_bf16 v[12:15], v[144:147], v[80:83], v[44:47]
    v_mfma_f32_16x16x32_bf16 v[12:15], v[148:151], v[84:87], v[12:15]
    s_add_u32 m0, s46, 0x1070
    v_mfma_f32_16x16x32_bf16 v[12:15], v[152:155], v[88:91], v[12:15]
    buffer_load_dwordx4 v245, s[16:19], s43 offen offset:3072 nt lds
    v_mfma_f32_16x16x32_bf16 v[12:15], v[156:159], v[92:95], v[12:15]
    s_add_u32 s42, s42, 8192
    v_exp_f32 v8, v8
    v_mfma_f32_16x16x32_bf16 a[192:195], v[160:163], v[36:39], a[192:195]
    s_waitcnt vmcnt(24)
    ds_read_b64_tr_b16 v[160:161], v241 offset:0
    ds_read_b64_tr_b16 v[162:163], v241 offset:4224
    v_mfma_f32_16x16x32_bf16 a[196:199], v[164:167], v[36:39], a[196:199]
    s_and_b32 s42, s42, 0x1ffff
    ds_read_b64_tr_b16 v[164:165], v241 offset:32
    ds_read_b64_tr_b16 v[166:167], v241 offset:4256
    v_mfma_f32_16x16x32_bf16 a[200:203], v[168:171], v[36:39], a[200:203]
    s_xor_b32 s43, s42, 4096
    ds_read_b64_tr_b16 v[168:169], v242 offset:0
    ds_read_b64_tr_b16 v[170:171], v242 offset:4224
    v_mfma_f32_16x16x32_bf16 a[204:207], v[172:175], v[36:39], a[204:207]
    s_nop 0
    ds_read_b64_tr_b16 v[172:173], v242 offset:32
    ds_read_b64_tr_b16 v[174:175], v242 offset:4256
    v_mfma_f32_16x16x32_bf16 a[208:211], v[176:179], v[36:39], a[208:211]
    s_nop 0
    ds_read_b64_tr_b16 v[176:177], v243 offset:0
    ds_read_b64_tr_b16 v[178:179], v243 offset:4224
    v_mfma_f32_16x16x32_bf16 a[212:215], v[180:183], v[36:39], a[212:215]
    s_nop 0
    ds_read_b64_tr_b16 v[180:181], v243 offset:32
    ds_read_b64_tr_b16 v[182:183], v243 offset:4256
    v_mfma_f32_16x16x32_bf16 a[216:219], v[184:187], v[36:39], a[216:219]
    s_nop 0
    ds_read_b64_tr_b16 v[184:185], v244 offset:0
    ds_read_b64_tr_b16 v[186:187], v244 offset:4224
    v_mfma_f32_16x16x32_bf16 a[220:223], v[188:191], v[36:39], a[220:223]
    s_nop 0
    ds_read_b64_tr_b16 v[188:189], v244 offset:32
    ds_read_b64_tr_b16 v[190:191], v244 offset:4256
    v_mfma_f32_16x16x32_bf16 a[236:239], a[252:255], v[36:39], a[236:239]
    v_exp_f32 v9, v9
    v_mfma_f32_16x16x32_bf16 v[0:3], v[128:131], v[96:99], v[48:51]
    v_exp_f32 v10, v10
    v_mfma_f32_16x16x32_bf16 v[0:3], v[132:135], v[100:103], v[0:3]
    v_exp_f32 v11, v11
    v_mfma_f32_16x16x32_bf16 v[0:3], v[136:139], v[104:107], v[0:3]
    v_cvt_pk_bf16_f32 v36, v8, v9
    v_cvt_pk_bf16_f32 v37, v10, v11
    v_mfma_f32_16x16x32_bf16 v[0:3], v[140:143], v[108:111], v[0:3]
    v_exp_f32 v12, v12
    v_mfma_f32_16x16x32_bf16 v[4:7], v[144:147], v[96:99], v[48:51]
    v_exp_f32 v13, v13
    v_mfma_f32_16x16x32_bf16 v[4:7], v[148:151], v[100:103], v[4:7]
    s_cmp_eq_u32 s39, 1
    s_cselect_b32 s22, 0, s22
    v_mfma_f32_16x16x32_bf16 v[4:7], v[152:155], v[104:107], v[4:7]
    v_exp_f32 v14, v14
    v_mfma_f32_16x16x32_bf16 v[4:7], v[156:159], v[108:111], v[4:7]
    s_waitcnt lgkmcnt(0)
    v_exp_f32 v15, v15
    v_mfma_f32_16x16x32_bf16 a[0:3], v[160:163], v[32:35], a[0:3]
    v_cvt_pk_bf16_f32 v38, v12, v13
    v_cvt_pk_bf16_f32 v39, v14, v15
    v_mfma_f32_16x16x32_bf16 a[4:7], v[164:167], v[32:35], a[4:7]
    v_exp_f32 v0, v0
    v_mfma_f32_16x16x32_bf16 a[8:11], v[168:171], v[32:35], a[8:11]
    v_exp_f32 v1, v1
    v_mfma_f32_16x16x32_bf16 a[12:15], v[172:175], v[32:35], a[12:15]
    v_exp_f32 v2, v2
    v_mfma_f32_16x16x32_bf16 a[16:19], v[176:179], v[32:35], a[16:19]
    v_exp_f32 v3, v3
    v_mfma_f32_16x16x32_bf16 a[20:23], v[180:183], v[32:35], a[20:23]
    v_exp_f32 v4, v4
    v_mfma_f32_16x16x32_bf16 a[24:27], v[184:187], v[32:35], a[24:27]
    v_exp_f32 v5, v5
    v_mfma_f32_16x16x32_bf16 a[28:31], v[188:191], v[32:35], a[28:31]
    v_exp_f32 v6, v6
    v_mfma_f32_16x16x32_bf16 a[240:243], a[252:255], v[32:35], a[240:243]
    v_cvt_pk_bf16_f32 v32, v0, v1
    v_cvt_pk_bf16_f32 v33, v2, v3
    v_mfma_f32_16x16x32_bf16 v[8:11], v[128:131], v[112:115], v[52:55]
    v_exp_f32 v7, v7
    v_mfma_f32_16x16x32_bf16 v[8:11], v[132:135], v[116:119], v[8:11]
    v_cvt_pk_bf16_f32 v34, v4, v5
    v_cvt_pk_bf16_f32 v35, v6, v7
    v_mfma_f32_16x16x32_bf16 v[8:11], v[136:139], v[120:123], v[8:11]
    v_mfma_f32_16x16x32_bf16 v[8:11], v[140:143], v[124:127], v[8:11]
    s_barrier
    v_mfma_f32_16x16x32_bf16 v[12:15], v[144:147], v[112:115], v[52:55]
    v_mfma_f32_16x16x32_bf16 v[12:15], v[148:151], v[116:119], v[12:15]
    v_mfma_f32_16x16x32_bf16 v[12:15], v[152:155], v[120:123], v[12:15]
    s_add_u32 m0, s47, 0
    v_exp_f32 v8, v8
    v_mfma_f32_16x16x32_bf16 v[12:15], v[156:159], v[124:127], v[12:15]
    buffer_load_dwordx4 v245, s[20:23], s44 offen nt lds
    v_mfma_f32_16x16x32_bf16 a[32:35], v[160:163], v[36:39], a[32:35]
    v_exp_f32 v9, v9
    v_mfma_f32_16x16x32_bf16 a[36:39], v[164:167], v[36:39], a[36:39]
    s_add_u32 m0, s47, 32
    v_exp_f32 v10, v10
    v_mfma_f32_16x16x32_bf16 a[40:43], v[168:171], v[36:39], a[40:43]
    buffer_load_dwordx4 v245, s[20:23], s44 offen offset:1024 nt lds
    v_mfma_f32_16x16x32_bf16 a[44:47], v[172:175], v[36:39], a[44:47]
    v_exp_f32 v11, v11
    v_mfma_f32_16x16x32_bf16 a[48:51], v[176:179], v[36:39], a[48:51]
    v_exp_f32 v12, v12
    v_mfma_f32_16x16x32_bf16 a[52:55], v[180:183], v[36:39], a[52:55]
    v_exp_f32 v13, v13
    v_mfma_f32_16x16x32_bf16 a[56:59], v[184:187], v[36:39], a[56:59]
    s_add_u32 m0, s47, 64
    v_exp_f32 v14, v14
    v_mfma_f32_16x16x32_bf16 a[60:63], v[188:191], v[36:39], a[60:63]
    buffer_load_dwordx4 v245, s[20:23], s44 offen offset:2048 nt lds
    v_mfma_f32_16x16x32_bf16 a[244:247], a[252:255], v[36:39], a[244:247]
    v_cvt_pk_bf16_f32 v36, v8, v9
    v_cvt_pk_bf16_f32 v37, v10, v11
    v_mfma_f32_16x16x32_bf16 v[0:3], v[128:131], v[192:195], v[56:59]
    v_exp_f32 v15, v15
    v_mfma_f32_16x16x32_bf16 v[0:3], v[132:135], v[196:199], v[0:3]
    s_add_u32 m0, s47, 0x60
    v_cvt_pk_bf16_f32 v38, v12, v13
    v_cvt_pk_bf16_f32 v39, v14, v15
    v_mfma_f32_16x16x32_bf16 v[0:3], v[136:139], v[200:203], v[0:3]
    buffer_load_dwordx4 v245, s[20:23], s44 offen offset:3072 nt lds
    v_mfma_f32_16x16x32_bf16 v[0:3], v[140:143], v[204:207], v[0:3]
    v_mfma_f32_16x16x32_bf16 v[4:7], v[144:147], v[192:195], v[56:59]
    v_mfma_f32_16x16x32_bf16 v[4:7], v[148:151], v[196:199], v[4:7]
    v_mfma_f32_16x16x32_bf16 v[4:7], v[152:155], v[200:203], v[4:7]
    s_add_u32 m0, s47, 0x1080
    v_exp_f32 v0, v0
    v_mfma_f32_16x16x32_bf16 v[4:7], v[156:159], v[204:207], v[4:7]
    buffer_load_dwordx4 v245, s[20:23], s45 offen nt lds
    v_mfma_f32_16x16x32_bf16 a[64:67], v[160:163], v[32:35], a[64:67]
    v_exp_f32 v1, v1
    v_mfma_f32_16x16x32_bf16 a[68:71], v[164:167], v[32:35], a[68:71]
    v_exp_f32 v2, v2
    v_mfma_f32_16x16x32_bf16 a[72:75], v[168:171], v[32:35], a[72:75]
    s_add_u32 m0, s47, 0x10a0
    v_exp_f32 v3, v3
    v_mfma_f32_16x16x32_bf16 a[76:79], v[172:175], v[32:35], a[76:79]
    buffer_load_dwordx4 v245, s[20:23], s45 offen offset:1024 nt lds
    v_mfma_f32_16x16x32_bf16 a[80:83], v[176:179], v[32:35], a[80:83]
    v_exp_f32 v4, v4
    v_mfma_f32_16x16x32_bf16 a[84:87], v[180:183], v[32:35], a[84:87]
    v_exp_f32 v5, v5
    v_mfma_f32_16x16x32_bf16 a[88:91], v[184:187], v[32:35], a[88:91]
    v_exp_f32 v6, v6
    v_mfma_f32_16x16x32_bf16 a[92:95], v[188:191], v[32:35], a[92:95]
    s_add_u32 m0, s47, 0x10c0
    v_exp_f32 v7, v7
    v_mfma_f32_16x16x32_bf16 a[248:251], a[252:255], v[32:35], a[248:251]
    buffer_load_dwordx4 v245, s[20:23], s45 offen offset:2048 nt lds
    v_mfma_f32_16x16x32_bf16 v[8:11], v[128:131], v[208:211], v[60:63]
    v_cvt_pk_bf16_f32 v32, v0, v1
    v_cvt_pk_bf16_f32 v33, v2, v3
    v_mfma_f32_16x16x32_bf16 v[8:11], v[132:135], v[212:215], v[8:11]
    v_cvt_pk_bf16_f32 v34, v4, v5
    v_cvt_pk_bf16_f32 v35, v6, v7
    v_mfma_f32_16x16x32_bf16 v[8:11], v[136:139], v[216:219], v[8:11]
    s_add_u32 m0, s47, 0x10e0
    v_mfma_f32_16x16x32_bf16 v[8:11], v[140:143], v[220:223], v[8:11]
    buffer_load_dwordx4 v245, s[20:23], s45 offen offset:3072 nt lds
    v_mfma_f32_16x16x32_bf16 v[12:15], v[144:147], v[208:211], v[60:63]
    v_mfma_f32_16x16x32_bf16 v[12:15], v[148:151], v[212:215], v[12:15]
    v_mfma_f32_16x16x32_bf16 v[12:15], v[152:155], v[216:219], v[12:15]
    s_add_u32 s44, s44, 8192
    v_exp_f32 v8, v8
    v_mfma_f32_16x16x32_bf16 v[12:15], v[156:159], v[220:223], v[12:15]
    s_and_b32 s44, s44, 0x1ffff
    v_exp_f32 v9, v9
    v_mfma_f32_16x16x32_bf16 a[96:99], v[160:163], v[36:39], a[96:99]
    s_xor_b32 s45, s44, 4096
    v_exp_f32 v10, v10
    v_mfma_f32_16x16x32_bf16 a[100:103], v[164:167], v[36:39], a[100:103]
    v_exp_f32 v11, v11
    v_mfma_f32_16x16x32_bf16 a[104:107], v[168:171], v[36:39], a[104:107]
    v_exp_f32 v12, v12
    v_mfma_f32_16x16x32_bf16 a[108:111], v[172:175], v[36:39], a[108:111]
    v_exp_f32 v13, v13
    v_mfma_f32_16x16x32_bf16 a[112:115], v[176:179], v[36:39], a[112:115]
    v_exp_f32 v14, v14
    v_mfma_f32_16x16x32_bf16 a[116:119], v[180:183], v[36:39], a[116:119]
    v_exp_f32 v15, v15
    v_mfma_f32_16x16x32_bf16 a[120:123], v[184:187], v[36:39], a[120:123]
    v_mfma_f32_16x16x32_bf16 a[124:127], v[188:191], v[36:39], a[124:127]
    v_mfma_f32_16x16x32_bf16 a[224:227], a[252:255], v[36:39], a[224:227]
    v_cvt_pk_bf16_f32 v36, v8, v9
    v_cvt_pk_bf16_f32 v37, v10, v11
    v_mfma_f32_16x16x32_bf16 v[0:3], v[128:131], v[16:19], v[224:227]
    s_waitcnt vmcnt(24)
    ds_read_b128 v[128:131], v240 offset:33280
    v_cvt_pk_bf16_f32 v38, v12, v13
    v_mfma_f32_16x16x32_bf16 v[0:3], v[132:135], v[20:23], v[0:3]
    ds_read_b128 v[132:135], v240 offset:33296
    v_cvt_pk_bf16_f32 v39, v14, v15
    v_mfma_f32_16x16x32_bf16 v[0:3], v[136:139], v[24:27], v[0:3]
    ds_read_b128 v[136:139], v240 offset:33312
    v_mfma_f32_16x16x32_bf16 v[0:3], v[140:143], v[28:31], v[0:3]
    ds_read_b128 v[140:143], v240 offset:33328
    v_mfma_f32_16x16x32_bf16 v[4:7], v[144:147], v[16:19], v[224:227]
    ds_read_b128 v[144:147], v240 offset:37440
    v_mfma_f32_16x16x32_bf16 v[4:7], v[148:151], v[20:23], v[4:7]
    ds_read_b128 v[148:151], v240 offset:37456
    v_mfma_f32_16x16x32_bf16 v[4:7], v[152:155], v[24:27], v[4:7]
    ds_read_b128 v[152:155], v240 offset:37472
    v_mfma_f32_16x16x32_bf16 v[4:7], v[156:159], v[28:31], v[4:7]
    ds_read_b128 v[156:159], v240 offset:37488
    v_mfma_f32_16x16x32_bf16 a[128:131], v[160:163], v[32:35], a[128:131]
    v_exp_f32 v0, v0
    v_mfma_f32_16x16x32_bf16 a[132:135], v[164:167], v[32:35], a[132:135]
    v_exp_f32 v1, v1
    v_mfma_f32_16x16x32_bf16 a[136:139], v[168:171], v[32:35], a[136:139]
    v_exp_f32 v2, v2
    v_mfma_f32_16x16x32_bf16 a[140:143], v[172:175], v[32:35], a[140:143]
    v_exp_f32 v3, v3
    v_mfma_f32_16x16x32_bf16 a[144:147], v[176:179], v[32:35], a[144:147]
    v_exp_f32 v4, v4
    v_mfma_f32_16x16x32_bf16 a[148:151], v[180:183], v[32:35], a[148:151]
    v_exp_f32 v5, v5
    v_mfma_f32_16x16x32_bf16 a[152:155], v[184:187], v[32:35], a[152:155]
    v_exp_f32 v6, v6
    v_mfma_f32_16x16x32_bf16 a[156:159], v[188:191], v[32:35], a[156:159]
    v_exp_f32 v7, v7
    v_mfma_f32_16x16x32_bf16 a[228:231], a[252:255], v[32:35], a[228:231]
    s_waitcnt lgkmcnt(0)
    v_cvt_pk_bf16_f32 v32, v0, v1
    v_cvt_pk_bf16_f32 v33, v2, v3
    v_mfma_f32_16x16x32_bf16 v[8:11], v[128:131], v[64:67], v[40:43]
    s_add_u32 m0, s46, 0x8200
    v_cvt_pk_bf16_f32 v34, v4, v5
    v_cvt_pk_bf16_f32 v35, v6, v7
    v_mfma_f32_16x16x32_bf16 v[8:11], v[132:135], v[68:71], v[8:11]
    buffer_load_dwordx4 v245, s[16:19], s42 offen nt lds
    v_mfma_f32_16x16x32_bf16 v[8:11], v[136:139], v[72:75], v[8:11]
    s_add_u32 m0, s46, 0x8210
    v_mfma_f32_16x16x32_bf16 v[8:11], v[140:143], v[76:79], v[8:11]
    buffer_load_dwordx4 v245, s[16:19], s42 offen offset:1024 nt lds
    v_mfma_f32_16x16x32_bf16 v[12:15], v[144:147], v[64:67], v[40:43]
    v_mfma_f32_16x16x32_bf16 v[12:15], v[148:151], v[68:71], v[12:15]
    s_add_u32 m0, s46, 0x8220
    v_mfma_f32_16x16x32_bf16 v[12:15], v[152:155], v[72:75], v[12:15]
    buffer_load_dwordx4 v245, s[16:19], s42 offen offset:2048 nt lds
    v_mfma_f32_16x16x32_bf16 v[12:15], v[156:159], v[76:79], v[12:15]
    v_exp_f32 v8, v8
    v_mfma_f32_16x16x32_bf16 a[160:163], v[160:163], v[36:39], a[160:163]
    v_exp_f32 v9, v9
    v_mfma_f32_16x16x32_bf16 a[164:167], v[164:167], v[36:39], a[164:167]
    s_add_u32 m0, s46, 0x8230
    v_exp_f32 v10, v10
    v_mfma_f32_16x16x32_bf16 a[168:171], v[168:171], v[36:39], a[168:171]
    buffer_load_dwordx4 v245, s[16:19], s42 offen offset:3072 nt lds
    v_mfma_f32_16x16x32_bf16 a[172:175], v[172:175], v[36:39], a[172:175]
    v_exp_f32 v11, v11
    v_mfma_f32_16x16x32_bf16 a[176:179], v[176:179], v[36:39], a[176:179]
    s_add_u32 m0, s46, 0x9240
    v_exp_f32 v12, v12
    v_mfma_f32_16x16x32_bf16 a[180:183], v[180:183], v[36:39], a[180:183]
    buffer_load_dwordx4 v245, s[16:19], s43 offen nt lds
    v_mfma_f32_16x16x32_bf16 a[184:187], v[184:187], v[36:39], a[184:187]
    v_exp_f32 v13, v13
    v_mfma_f32_16x16x32_bf16 a[188:191], v[188:191], v[36:39], a[188:191]
    s_add_u32 m0, s46, 0x9250
    v_exp_f32 v14, v14
    v_mfma_f32_16x16x32_bf16 a[232:235], a[252:255], v[36:39], a[232:235]
    buffer_load_dwordx4 v245, s[16:19], s43 offen offset:1024 nt lds
    v_mfma_f32_16x16x32_bf16 v[0:3], v[128:131], v[80:83], v[44:47]
    s_sub_u32 s39, s39, 1
    v_exp_f32 v15, v15
    v_mfma_f32_16x16x32_bf16 v[0:3], v[132:135], v[84:87], v[0:3]
    v_cvt_pk_bf16_f32 v36, v8, v9
    v_cvt_pk_bf16_f32 v37, v10, v11
    v_mfma_f32_16x16x32_bf16 v[0:3], v[136:139], v[88:91], v[0:3]
    s_add_u32 m0, s46, 0x9260
    v_cvt_pk_bf16_f32 v38, v12, v13
    v_cvt_pk_bf16_f32 v39, v14, v15
    v_mfma_f32_16x16x32_bf16 v[0:3], v[140:143], v[92:95], v[0:3]
    buffer_load_dwordx4 v245, s[16:19], s43 offen offset:2048 nt lds
    v_mfma_f32_16x16x32_bf16 v[4:7], v[144:147], v[80:83], v[44:47]
    v_mfma_f32_16x16x32_bf16 v[4:7], v[148:151], v[84:87], v[4:7]
    s_add_u32 m0, s46, 0x9270
    v_mfma_f32_16x16x32_bf16 v[4:7], v[152:155], v[88:91], v[4:7]
    buffer_load_dwordx4 v245, s[16:19], s43 offen offset:3072 nt lds
    v_mfma_f32_16x16x32_bf16 v[4:7], v[156:159], v[92:95], v[4:7]
    s_add_u32 s42, s42, 8192
    v_mfma_f32_16x16x32_bf16 a[192:195], v[160:163], v[32:35], a[192:195]
    s_waitcnt vmcnt(24)
    ds_read_b64_tr_b16 v[160:161], v241 offset:33792
    ds_read_b64_tr_b16 v[162:163], v241 offset:38016
    v_mfma_f32_16x16x32_bf16 a[196:199], v[164:167], v[32:35], a[196:199]
    s_and_b32 s42, s42, 0x1ffff
    ds_read_b64_tr_b16 v[164:165], v241 offset:33824
    ds_read_b64_tr_b16 v[166:167], v241 offset:38048
    v_mfma_f32_16x16x32_bf16 a[200:203], v[168:171], v[32:35], a[200:203]
    s_xor_b32 s43, s42, 4096
    ds_read_b64_tr_b16 v[168:169], v242 offset:33792
    ds_read_b64_tr_b16 v[170:171], v242 offset:38016
    v_mfma_f32_16x16x32_bf16 a[204:207], v[172:175], v[32:35], a[204:207]
    s_nop 0
    ds_read_b64_tr_b16 v[172:173], v242 offset:33824
    ds_read_b64_tr_b16 v[174:175], v242 offset:38048
    v_mfma_f32_16x16x32_bf16 a[208:211], v[176:179], v[32:35], a[208:211]
    s_nop 0
    ds_read_b64_tr_b16 v[176:177], v243 offset:33792
    ds_read_b64_tr_b16 v[178:179], v243 offset:38016
    v_mfma_f32_16x16x32_bf16 a[212:215], v[180:183], v[32:35], a[212:215]
    s_nop 0
    ds_read_b64_tr_b16 v[180:181], v243 offset:33824
    ds_read_b64_tr_b16 v[182:183], v243 offset:38048
    v_mfma_f32_16x16x32_bf16 a[216:219], v[184:187], v[32:35], a[216:219]
    s_nop 0
    ds_read_b64_tr_b16 v[184:185], v244 offset:33792
    ds_read_b64_tr_b16 v[186:187], v244 offset:38016
    v_mfma_f32_16x16x32_bf16 a[220:223], v[188:191], v[32:35], a[220:223]
    s_nop 0
    ds_read_b64_tr_b16 v[188:189], v244 offset:33824
    ds_read_b64_tr_b16 v[190:191], v244 offset:38048
    v_mfma_f32_16x16x32_bf16 a[236:239], a[252:255], v[32:35], a[236:239]
    s_cmp_gt_u32 s39, 1
    s_cbranch_scc1 L_att
    s_cmp_eq_u32 s39, 0
    s_cbranch_scc1 L_exit
    buffer_load_dword v238, v234, s[60:63], s80 offen
    buffer_load_dword v236, v235, s[4:7], s64 offen
    s_branch L_att
    L_exit:
L_s2a:
    v_mfma_f32_16x16x32_bf16 v[8:11], v[128:131], v[96:99], v[48:51]
    s_mul_i32 s71, s32, 12288
    v_exp_f32 v0, v0
    v_mfma_f32_16x16x32_bf16 v[8:11], v[132:135], v[100:103], v[8:11]
    s_add_u32 s71, s71, 114688
    v_exp_f32 v1, v1
    v_mfma_f32_16x16x32_bf16 v[8:11], v[136:139], v[104:107], v[8:11]
    buffer_load_dwordx2 v[42:43], off, s[76:79], 0
    v_mfma_f32_16x16x32_bf16 v[8:11], v[140:143], v[108:111], v[8:11]
    s_mov_b32 s40, 0x2000
    v_exp_f32 v2, v2
    v_mfma_f32_16x16x32_bf16 v[12:15], v[144:147], v[96:99], v[48:51]
    s_lshl_b32 s3, s32, 13
    v_exp_f32 v3, v3
    v_mfma_f32_16x16x32_bf16 v[12:15], v[148:151], v[100:103], v[12:15]
    s_add_u32 s3, s3, 81920
    v_cvt_pk_bf16_f32 v32, v0, v1
    v_cvt_pk_bf16_f32 v33, v2, v3
    v_mfma_f32_16x16x32_bf16 v[12:15], v[152:155], v[104:107], v[12:15]
    v_exp_f32 v4, v4
    v_mfma_f32_16x16x32_bf16 v[12:15], v[156:159], v[108:111], v[12:15]
    s_waitcnt lgkmcnt(0)
    v_exp_f32 v5, v5
    v_mfma_f32_16x16x32_bf16 a[0:3], v[160:163], v[36:39], a[0:3]
    v_exp_f32 v6, v6
    v_mfma_f32_16x16x32_bf16 a[4:7], v[164:167], v[36:39], a[4:7]
    v_exp_f32 v7, v7
    v_mfma_f32_16x16x32_bf16 a[8:11], v[168:171], v[36:39], a[8:11]
    s_waitcnt vmcnt(1)
    s_barrier
    v_mfma_f32_16x16x32_bf16 a[12:15], v[172:175], v[36:39], a[12:15]
    v_cvt_pk_bf16_f32 v34, v4, v5
    v_cvt_pk_bf16_f32 v35, v6, v7
    v_mfma_f32_16x16x32_bf16 a[16:19], v[176:179], v[36:39], a[16:19]
    v_exp_f32 v8, v8
    v_mfma_f32_16x16x32_bf16 a[20:23], v[180:183], v[36:39], a[20:23]
    v_exp_f32 v9, v9
    v_mfma_f32_16x16x32_bf16 a[24:27], v[184:187], v[36:39], a[24:27]
    s_add_u32 s50, s64, 0
    v_exp_f32 v10, v10
    v_mfma_f32_16x16x32_bf16 a[28:31], v[188:191], v[36:39], a[28:31]
    s_add_u32 m0, s71, 0
    v_exp_f32 v11, v11
    v_mfma_f32_16x16x32_bf16 a[240:243], a[252:255], v[36:39], a[240:243]
    buffer_load_dwordx4 v250, s[24:27], s50 offen lds
    v_mfma_f32_16x16x32_bf16 v[0:3], v[128:131], v[112:115], v[52:55]
    s_add_u32 m0, s71, 0x400
    v_cvt_pk_bf16_f32 v36, v8, v9
    v_cvt_pk_bf16_f32 v37, v10, v11
    v_mfma_f32_16x16x32_bf16 v[0:3], v[132:135], v[116:119], v[0:3]
    buffer_load_dwordx4 v248, s[24:27], s50 offen lds
    v_mfma_f32_16x16x32_bf16 v[0:3], v[136:139], v[120:123], v[0:3]
    s_add_u32 s50, s64, 0x8000
    v_exp_f32 v12, v12
    v_mfma_f32_16x16x32_bf16 v[0:3], v[140:143], v[124:127], v[0:3]
    s_add_u32 m0, s71, 0x800
    v_exp_f32 v13, v13
    v_mfma_f32_16x16x32_bf16 v[4:7], v[144:147], v[112:115], v[52:55]
    buffer_load_dwordx4 v250, s[24:27], s50 offen lds
    v_mfma_f32_16x16x32_bf16 v[4:7], v[148:151], v[116:119], v[4:7]
    s_add_u32 m0, s71, 0xc00
    v_exp_f32 v14, v14
    v_mfma_f32_16x16x32_bf16 v[4:7], v[152:155], v[120:123], v[4:7]
    buffer_load_dwordx4 v248, s[24:27], s50 offen lds
    v_mfma_f32_16x16x32_bf16 v[4:7], v[156:159], v[124:127], v[4:7]
    s_add_u32 s50, s64, 0x10000
    v_exp_f32 v15, v15
    v_mfma_f32_16x16x32_bf16 a[32:35], v[160:163], v[32:35], a[32:35]
    s_add_u32 m0, s71, 0x1000
    v_cvt_pk_bf16_f32 v38, v12, v13
    v_cvt_pk_bf16_f32 v39, v14, v15
    v_mfma_f32_16x16x32_bf16 a[36:39], v[164:167], v[32:35], a[36:39]
    buffer_load_dwordx4 v250, s[24:27], s50 offen lds
    v_mfma_f32_16x16x32_bf16 a[40:43], v[168:171], v[32:35], a[40:43]
    s_add_u32 m0, s71, 0x1400
    v_exp_f32 v0, v0
    v_mfma_f32_16x16x32_bf16 a[44:47], v[172:175], v[32:35], a[44:47]
    buffer_load_dwordx4 v248, s[24:27], s50 offen lds
    v_mfma_f32_16x16x32_bf16 a[48:51], v[176:179], v[32:35], a[48:51]
    s_add_u32 s50, s64, 0x18000
    v_exp_f32 v1, v1
    v_mfma_f32_16x16x32_bf16 a[52:55], v[180:183], v[32:35], a[52:55]
    s_add_u32 m0, s71, 0x1800
    v_exp_f32 v2, v2
    v_mfma_f32_16x16x32_bf16 a[56:59], v[184:187], v[32:35], a[56:59]
    buffer_load_dwordx4 v250, s[24:27], s50 offen lds
    v_mfma_f32_16x16x32_bf16 a[60:63], v[188:191], v[32:35], a[60:63]
    s_add_u32 m0, s71, 0x1c00
    v_exp_f32 v3, v3
    v_mfma_f32_16x16x32_bf16 a[244:247], a[252:255], v[32:35], a[244:247]
    buffer_load_dwordx4 v248, s[24:27], s50 offen lds
    v_mfma_f32_16x16x32_bf16 v[8:11], v[128:131], v[192:195], v[56:59]
    s_add_u32 s50, s64, 0x20000
    v_cvt_pk_bf16_f32 v32, v0, v1
    v_cvt_pk_bf16_f32 v33, v2, v3
    v_mfma_f32_16x16x32_bf16 v[8:11], v[132:135], v[196:199], v[8:11]
    s_add_u32 m0, s71, 0x2000
    v_exp_f32 v4, v4
    v_mfma_f32_16x16x32_bf16 v[8:11], v[136:139], v[200:203], v[8:11]
    buffer_load_dwordx4 v250, s[24:27], s50 offen lds
    v_mfma_f32_16x16x32_bf16 v[8:11], v[140:143], v[204:207], v[8:11]
    s_add_u32 m0, s71, 0x2400
    v_exp_f32 v5, v5
    v_mfma_f32_16x16x32_bf16 v[12:15], v[144:147], v[192:195], v[56:59]
    buffer_load_dwordx4 v248, s[24:27], s50 offen lds
    v_mfma_f32_16x16x32_bf16 v[12:15], v[148:151], v[196:199], v[12:15]
    s_add_u32 s50, s64, 0x28000
    v_exp_f32 v6, v6
    v_mfma_f32_16x16x32_bf16 v[12:15], v[152:155], v[200:203], v[12:15]
    s_add_u32 m0, s71, 0x2800
    v_exp_f32 v7, v7
    v_mfma_f32_16x16x32_bf16 v[12:15], v[156:159], v[204:207], v[12:15]
    buffer_load_dwordx4 v250, s[24:27], s50 offen lds
    v_mfma_f32_16x16x32_bf16 a[64:67], v[160:163], v[36:39], a[64:67]
    s_add_u32 m0, s71, 0x2c00
    v_cvt_pk_bf16_f32 v34, v4, v5
    v_cvt_pk_bf16_f32 v35, v6, v7
    v_mfma_f32_16x16x32_bf16 a[68:71], v[164:167], v[36:39], a[68:71]
    buffer_load_dwordx4 v248, s[24:27], s50 offen lds
    v_mfma_f32_16x16x32_bf16 a[72:75], v[168:171], v[36:39], a[72:75]
    v_exp_f32 v8, v8
    v_mfma_f32_16x16x32_bf16 a[76:79], v[172:175], v[36:39], a[76:79]
    v_exp_f32 v9, v9
    v_mfma_f32_16x16x32_bf16 a[80:83], v[176:179], v[36:39], a[80:83]
    buffer_load_dword v40, v239, s[4:7], 0 offen
    v_mfma_f32_16x16x32_bf16 a[84:87], v[180:183], v[36:39], a[84:87]
    buffer_load_dword v41, v239, s[4:7], s40 offen
    v_mfma_f32_16x16x32_bf16 a[88:91], v[184:187], v[36:39], a[88:91]
    v_exp_f32 v10, v10
    v_mfma_f32_16x16x32_bf16 a[92:95], v[188:191], v[36:39], a[92:95]
    v_exp_f32 v11, v11
    v_mfma_f32_16x16x32_bf16 a[248:251], a[252:255], v[36:39], a[248:251]
    v_cvt_pk_bf16_f32 v36, v8, v9
    v_cvt_pk_bf16_f32 v37, v10, v11
    v_mfma_f32_16x16x32_bf16 v[0:3], v[128:131], v[208:211], v[60:63]
    v_exp_f32 v12, v12
    v_mfma_f32_16x16x32_bf16 v[0:3], v[132:135], v[212:215], v[0:3]
    v_exp_f32 v13, v13
    v_mfma_f32_16x16x32_bf16 v[0:3], v[136:139], v[216:219], v[0:3]
    v_exp_f32 v14, v14
    v_mfma_f32_16x16x32_bf16 v[0:3], v[140:143], v[220:223], v[0:3]
    v_exp_f32 v15, v15
    v_mfma_f32_16x16x32_bf16 v[4:7], v[144:147], v[208:211], v[60:63]
    v_cvt_pk_bf16_f32 v38, v12, v13
    v_cvt_pk_bf16_f32 v39, v14, v15
    v_mfma_f32_16x16x32_bf16 v[4:7], v[148:151], v[212:215], v[4:7]
    v_accvgpr_read_b32 v232, a240
    v_cmp_nlt_f32 s[82:83], v232, s51
    v_mfma_f32_16x16x32_bf16 v[4:7], v[152:155], v[216:219], v[4:7]
    v_exp_f32 v0, v0
    v_mfma_f32_16x16x32_bf16 v[4:7], v[156:159], v[220:223], v[4:7]
    s_or_b64 s[56:57], s[56:57], s[82:83]
    v_exp_f32 v1, v1
    v_mfma_f32_16x16x32_bf16 a[96:99], v[160:163], v[32:35], a[96:99]
    v_exp_f32 v2, v2
    v_mfma_f32_16x16x32_bf16 a[100:103], v[164:167], v[32:35], a[100:103]
    v_exp_f32 v3, v3
    v_mfma_f32_16x16x32_bf16 a[104:107], v[168:171], v[32:35], a[104:107]
    v_exp_f32 v4, v4
    v_mfma_f32_16x16x32_bf16 a[108:111], v[172:175], v[32:35], a[108:111]
    v_exp_f32 v5, v5
    v_mfma_f32_16x16x32_bf16 a[112:115], v[176:179], v[32:35], a[112:115]
    v_exp_f32 v6, v6
    v_mfma_f32_16x16x32_bf16 a[116:119], v[180:183], v[32:35], a[116:119]
    v_exp_f32 v7, v7
    v_mfma_f32_16x16x32_bf16 a[120:123], v[184:187], v[32:35], a[120:123]
    v_accvgpr_read_b32 v233, a244
    v_cmp_nlt_f32 s[82:83], v233, s51
    v_mfma_f32_16x16x32_bf16 a[124:127], v[188:191], v[32:35], a[124:127]
    v_accvgpr_read_b32 v234, a248
    v_accvgpr_read_b32 v64, a0
    v_mfma_f32_16x16x32_bf16 a[224:227], a[252:255], v[32:35], a[224:227]
    s_or_b64 s[56:57], s[56:57], s[82:83]
    v_cvt_pk_bf16_f32 v32, v0, v1
    v_cvt_pk_bf16_f32 v33, v2, v3
    v_mfma_f32_16x16x32_bf16 v[8:11], v[128:131], v[16:19], v[224:227]
    v_cvt_pk_bf16_f32 v34, v4, v5
    v_cvt_pk_bf16_f32 v35, v6, v7
    v_mfma_f32_16x16x32_bf16 v[8:11], v[132:135], v[20:23], v[8:11]
    v_cmp_nlt_f32 s[82:83], v234, s51
    v_accvgpr_read_b32 v65, a1
    v_mfma_f32_16x16x32_bf16 v[8:11], v[136:139], v[24:27], v[8:11]
    v_accvgpr_read_b32 v235, a224
    v_accvgpr_read_b32 v66, a2
    v_mfma_f32_16x16x32_bf16 v[8:11], v[140:143], v[28:31], v[8:11]
    s_or_b64 s[56:57], s[56:57], s[82:83]
    v_cmp_nlt_f32 s[82:83], v235, s51
    v_accvgpr_read_b32 v67, a3
    v_mfma_f32_16x16x32_bf16 v[12:15], v[144:147], v[16:19], v[224:227]
    v_rcp_f32 v232, v232
    v_mfma_f32_16x16x32_bf16 v[12:15], v[148:151], v[20:23], v[12:15]
    s_or_b64 s[56:57], s[56:57], s[82:83]
    v_accvgpr_read_b32 v68, a4
    v_accvgpr_read_b32 v69, a5
    v_mfma_f32_16x16x32_bf16 v[12:15], v[152:155], v[24:27], v[12:15]
    v_exp_f32 v8, v8
    v_mfma_f32_16x16x32_bf16 v[12:15], v[156:159], v[28:31], v[12:15]
    v_exp_f32 v9, v9
    v_mfma_f32_16x16x32_bf16 a[128:131], v[160:163], v[36:39], a[128:131]
    v_exp_f32 v10, v10
    v_mfma_f32_16x16x32_bf16 a[132:135], v[164:167], v[36:39], a[132:135]
    v_exp_f32 v11, v11
    v_mfma_f32_16x16x32_bf16 a[136:139], v[168:171], v[36:39], a[136:139]
    v_exp_f32 v12, v12
    v_mfma_f32_16x16x32_bf16 a[140:143], v[172:175], v[36:39], a[140:143]
    v_exp_f32 v13, v13
    v_mfma_f32_16x16x32_bf16 a[144:147], v[176:179], v[36:39], a[144:147]
    v_exp_f32 v14, v14
    v_mfma_f32_16x16x32_bf16 a[148:151], v[180:183], v[36:39], a[148:151]
    v_exp_f32 v15, v15
    v_mfma_f32_16x16x32_bf16 a[152:155], v[184:187], v[36:39], a[152:155]
    v_accvgpr_read_b32 v70, a6
    v_accvgpr_read_b32 v71, a7
    v_mfma_f32_16x16x32_bf16 a[156:159], v[188:191], v[36:39], a[156:159]
    v_mul_f32 v64, v64, v232
    v_mul_f32 v65, v65, v232
    v_mfma_f32_16x16x32_bf16 a[228:231], a[252:255], v[36:39], a[228:231]
    v_cvt_pk_bf16_f32 v36, v8, v9
    v_cvt_pk_bf16_f32 v37, v10, v11
    v_mfma_f32_16x16x32_bf16 a[160:163], v[160:163], v[32:35], a[160:163]
    v_cvt_pk_bf16_f32 v38, v12, v13
    v_cvt_pk_bf16_f32 v39, v14, v15
    v_mfma_f32_16x16x32_bf16 a[164:167], v[164:167], v[32:35], a[164:167]
    v_mul_f32 v66, v66, v232
    v_mul_f32 v67, v67, v232
    v_mfma_f32_16x16x32_bf16 a[168:171], v[168:171], v[32:35], a[168:171]
    v_accvgpr_read_b32 v236, a228
    v_cmp_nlt_f32 s[82:83], v236, s51
    v_mfma_f32_16x16x32_bf16 a[172:175], v[172:175], v[32:35], a[172:175]
    v_mul_f32 v68, v68, v232
    v_mul_f32 v69, v69, v232
    v_mfma_f32_16x16x32_bf16 a[176:179], v[176:179], v[32:35], a[176:179]
    s_or_b64 s[56:57], s[56:57], s[82:83]
    v_mul_f32 v70, v70, v232
    v_mul_f32 v71, v71, v232
    v_mfma_f32_16x16x32_bf16 a[180:183], v[180:183], v[32:35], a[180:183]
    v_cvt_pk_bf16_f32 v80, v64, v65
    v_cvt_pk_bf16_f32 v81, v66, v67
    v_mfma_f32_16x16x32_bf16 a[184:187], v[184:187], v[32:35], a[184:187]
    v_cvt_pk_bf16_f32 v82, v68, v69
    v_cvt_pk_bf16_f32 v83, v70, v71
    v_mfma_f32_16x16x32_bf16 a[188:191], v[188:191], v[32:35], a[188:191]
    v_accvgpr_read_b32 v72, a8
    v_accvgpr_read_b32 v73, a9
    v_mfma_f32_16x16x32_bf16 a[232:235], a[252:255], v[32:35], a[232:235]
    v_accvgpr_read_b32 v74, a10
    v_accvgpr_read_b32 v75, a11
    v_mfma_f32_16x16x32_bf16 a[192:195], v[160:163], v[36:39], a[192:195]
    v_accvgpr_read_b32 v76, a12
    v_accvgpr_read_b32 v77, a13
    v_mfma_f32_16x16x32_bf16 a[196:199], v[164:167], v[36:39], a[196:199]
    v_accvgpr_read_b32 v78, a14
    v_accvgpr_read_b32 v79, a15
    v_mfma_f32_16x16x32_bf16 a[200:203], v[168:171], v[36:39], a[200:203]
    v_accvgpr_read_b32 v237, a232
    v_cmp_nlt_f32 s[82:83], v237, s51
    v_mfma_f32_16x16x32_bf16 a[204:207], v[172:175], v[36:39], a[204:207]
    v_mul_f32 v72, v72, v232
    v_mul_f32 v73, v73, v232
    v_mfma_f32_16x16x32_bf16 a[208:211], v[176:179], v[36:39], a[208:211]
    s_or_b64 s[56:57], s[56:57], s[82:83]
    v_mul_f32 v74, v74, v232
    v_mul_f32 v75, v75, v232
    v_mfma_f32_16x16x32_bf16 a[212:215], v[180:183], v[36:39], a[212:215]
    v_mul_f32 v76, v76, v232
    v_mul_f32 v77, v77, v232
    v_mfma_f32_16x16x32_bf16 a[216:219], v[184:187], v[36:39], a[216:219]
    v_mul_f32 v78, v78, v232
    v_mul_f32 v79, v79, v232
    v_mfma_f32_16x16x32_bf16 a[220:223], v[188:191], v[36:39], a[220:223]
    v_cvt_pk_bf16_f32 v84, v72, v73
    v_cvt_pk_bf16_f32 v85, v74, v75
    v_cvt_pk_bf16_f32 v86, v76, v77
    v_cvt_pk_bf16_f32 v87, v78, v79
    v_mfma_f32_16x16x32_bf16 a[236:239], a[252:255], v[36:39], a[236:239]
    s_waitcnt vmcnt(10)
    ds_read_b64_tr_b16 v[96:97], v252 offset:0
    ds_read_b64_tr_b16 v[98:99], v252 offset:1024
    ds_read_b64_tr_b16 v[100:101], v253 offset:0
    ds_read_b64_tr_b16 v[102:103], v253 offset:1024
    ds_read_b64_tr_b16 v[104:105], v252 offset:2048
    ds_read_b64_tr_b16 v[106:107], v252 offset:3072
    ds_read_b64_tr_b16 v[108:109], v253 offset:2048
    ds_read_b64_tr_b16 v[110:111], v253 offset:3072
    ds_write_b128 v246, v[80:83] offset:0
    ds_write_b128 v246, v[84:87] offset:7168
    v_accvgpr_read_b32 v238, a236
    v_cmp_nlt_f32 s[82:83], v238, s51
    v_rcp_f32 v233, v233
    v_rcp_f32 v234, v234
    v_rcp_f32 v235, v235
    v_rcp_f32 v236, v236
    v_rcp_f32 v237, v237
    s_or_b64 s[56:57], s[56:57], s[82:83]
    v_rcp_f32 v238, v238
    v_accvgpr_read_b32 v64, a16
    v_accvgpr_read_b32 v65, a17
    v_accvgpr_read_b32 v66, a18
    v_accvgpr_read_b32 v67, a19
    v_accvgpr_read_b32 v68, a20
    v_accvgpr_read_b32 v69, a21
    v_accvgpr_read_b32 v70, a22
    v_accvgpr_read_b32 v71, a23
    v_pk_mul_f32 v[64:65], v[64:65], v[232:233] op_sel:[0,0] op_sel_hi:[1,0]
    v_pk_mul_f32 v[66:67], v[66:67], v[232:233] op_sel:[0,0] op_sel_hi:[1,0]
    v_pk_mul_f32 v[68:69], v[68:69], v[232:233] op_sel:[0,0] op_sel_hi:[1,0]
    v_pk_mul_f32 v[70:71], v[70:71], v[232:233] op_sel:[0,0] op_sel_hi:[1,0]
    v_accvgpr_read_b32 v72, a24
    v_accvgpr_read_b32 v73, a25
    v_accvgpr_read_b32 v74, a26
    v_accvgpr_read_b32 v75, a27
    v_cvt_pk_bf16_f32 v88, v64, v65
    v_cvt_pk_bf16_f32 v89, v66, v67
    v_cvt_pk_bf16_f32 v90, v68, v69
    v_cvt_pk_bf16_f32 v91, v70, v71
    v_accvgpr_read_b32 v76, a28
    v_accvgpr_read_b32 v77, a29
    v_accvgpr_read_b32 v78, a30
    v_accvgpr_read_b32 v79, a31
    ds_write_b128 v246, v[88:91] offset:14336
    v_pk_mul_f32 v[72:73], v[72:73], v[232:233] op_sel:[0,0] op_sel_hi:[1,0]
    v_pk_mul_f32 v[74:75], v[74:75], v[232:233] op_sel:[0,0] op_sel_hi:[1,0]
    v_pk_mul_f32 v[76:77], v[76:77], v[232:233] op_sel:[0,0] op_sel_hi:[1,0]
    v_pk_mul_f32 v[78:79], v[78:79], v[232:233] op_sel:[0,0] op_sel_hi:[1,0]
    v_accvgpr_read_b32 v64, a32
    v_accvgpr_read_b32 v65, a33
    v_accvgpr_read_b32 v66, a34
    v_accvgpr_read_b32 v67, a35
    v_cvt_pk_bf16_f32 v92, v72, v73
    v_cvt_pk_bf16_f32 v93, v74, v75
    v_cvt_pk_bf16_f32 v94, v76, v77
    v_cvt_pk_bf16_f32 v95, v78, v79
    v_accvgpr_read_b32 v68, a36
    v_accvgpr_read_b32 v69, a37
    v_accvgpr_read_b32 v70, a38
    v_accvgpr_read_b32 v71, a39
    ds_write_b128 v246, v[92:95] offset:21504
    v_pk_mul_f32 v[64:65], v[64:65], v[232:233] op_sel:[0,1] op_sel_hi:[1,1]
    v_pk_mul_f32 v[66:67], v[66:67], v[232:233] op_sel:[0,1] op_sel_hi:[1,1]
    v_pk_mul_f32 v[68:69], v[68:69], v[232:233] op_sel:[0,1] op_sel_hi:[1,1]
    v_pk_mul_f32 v[70:71], v[70:71], v[232:233] op_sel:[0,1] op_sel_hi:[1,1]
    v_accvgpr_read_b32 v72, a40
    v_accvgpr_read_b32 v73, a41
    v_accvgpr_read_b32 v74, a42
    v_accvgpr_read_b32 v75, a43
    v_cvt_pk_bf16_f32 v80, v64, v65
    v_cvt_pk_bf16_f32 v81, v66, v67
    v_cvt_pk_bf16_f32 v82, v68, v69
    v_cvt_pk_bf16_f32 v83, v70, v71
    v_accvgpr_read_b32 v76, a44
    v_accvgpr_read_b32 v77, a45
    v_accvgpr_read_b32 v78, a46
    v_accvgpr_read_b32 v79, a47
    ds_write_b128 v246, v[80:83] offset:1024
    v_pk_mul_f32 v[72:73], v[72:73], v[232:233] op_sel:[0,1] op_sel_hi:[1,1]
    v_pk_mul_f32 v[74:75], v[74:75], v[232:233] op_sel:[0,1] op_sel_hi:[1,1]
    v_pk_mul_f32 v[76:77], v[76:77], v[232:233] op_sel:[0,1] op_sel_hi:[1,1]
    v_pk_mul_f32 v[78:79], v[78:79], v[232:233] op_sel:[0,1] op_sel_hi:[1,1]
    v_accvgpr_read_b32 v64, a48
    v_accvgpr_read_b32 v65, a49
    v_accvgpr_read_b32 v66, a50
    v_accvgpr_read_b32 v67, a51
    v_cvt_pk_bf16_f32 v84, v72, v73
    v_cvt_pk_bf16_f32 v85, v74, v75
    v_cvt_pk_bf16_f32 v86, v76, v77
    v_cvt_pk_bf16_f32 v87, v78, v79
    v_accvgpr_read_b32 v68, a52
    v_accvgpr_read_b32 v69, a53
    v_accvgpr_read_b32 v70, a54
    v_accvgpr_read_b32 v71, a55
    ds_write_b128 v246, v[84:87] offset:8192
    v_pk_mul_f32 v[64:65], v[64:65], v[232:233] op_sel:[0,1] op_sel_hi:[1,1]
    v_pk_mul_f32 v[66:67], v[66:67], v[232:233] op_sel:[0,1] op_sel_hi:[1,1]
    v_pk_mul_f32 v[68:69], v[68:69], v[232:233] op_sel:[0,1] op_sel_hi:[1,1]
    v_pk_mul_f32 v[70:71], v[70:71], v[232:233] op_sel:[0,1] op_sel_hi:[1,1]
    v_accvgpr_read_b32 v72, a56
    v_accvgpr_read_b32 v73, a57
    v_accvgpr_read_b32 v74, a58
    v_accvgpr_read_b32 v75, a59
    v_cvt_pk_bf16_f32 v88, v64, v65
    v_cvt_pk_bf16_f32 v89, v66, v67
    v_cvt_pk_bf16_f32 v90, v68, v69
    v_cvt_pk_bf16_f32 v91, v70, v71
    v_accvgpr_read_b32 v76, a60
    v_accvgpr_read_b32 v77, a61
    v_accvgpr_read_b32 v78, a62
    v_accvgpr_read_b32 v79, a63
    ds_write_b128 v246, v[88:91] offset:15360
    v_pk_mul_f32 v[72:73], v[72:73], v[232:233] op_sel:[0,1] op_sel_hi:[1,1]
    v_pk_mul_f32 v[74:75], v[74:75], v[232:233] op_sel:[0,1] op_sel_hi:[1,1]
    v_pk_mul_f32 v[76:77], v[76:77], v[232:233] op_sel:[0,1] op_sel_hi:[1,1]
    v_pk_mul_f32 v[78:79], v[78:79], v[232:233] op_sel:[0,1] op_sel_hi:[1,1]
    v_accvgpr_read_b32 v64, a64
    v_accvgpr_read_b32 v65, a65
    v_accvgpr_read_b32 v66, a66
    v_accvgpr_read_b32 v67, a67
    v_cvt_pk_bf16_f32 v92, v72, v73
    v_cvt_pk_bf16_f32 v93, v74, v75
    v_cvt_pk_bf16_f32 v94, v76, v77
    v_cvt_pk_bf16_f32 v95, v78, v79
    v_accvgpr_read_b32 v68, a68
    v_accvgpr_read_b32 v69, a69
    v_accvgpr_read_b32 v70, a70
    v_accvgpr_read_b32 v71, a71
    ds_write_b128 v246, v[92:95] offset:22528
    v_pk_mul_f32 v[64:65], v[64:65], v[234:235] op_sel:[0,0] op_sel_hi:[1,0]
    v_pk_mul_f32 v[66:67], v[66:67], v[234:235] op_sel:[0,0] op_sel_hi:[1,0]
    v_pk_mul_f32 v[68:69], v[68:69], v[234:235] op_sel:[0,0] op_sel_hi:[1,0]
    v_pk_mul_f32 v[70:71], v[70:71], v[234:235] op_sel:[0,0] op_sel_hi:[1,0]
    v_accvgpr_read_b32 v72, a72
    v_accvgpr_read_b32 v73, a73
    v_accvgpr_read_b32 v74, a74
    v_accvgpr_read_b32 v75, a75
    v_cvt_pk_bf16_f32 v80, v64, v65
    v_cvt_pk_bf16_f32 v81, v66, v67
    v_cvt_pk_bf16_f32 v82, v68, v69
    v_cvt_pk_bf16_f32 v83, v70, v71
    v_accvgpr_read_b32 v76, a76
    v_accvgpr_read_b32 v77, a77
    v_accvgpr_read_b32 v78, a78
    v_accvgpr_read_b32 v79, a79
    ds_write_b128 v246, v[80:83] offset:2048
    v_pk_mul_f32 v[72:73], v[72:73], v[234:235] op_sel:[0,0] op_sel_hi:[1,0]
    v_pk_mul_f32 v[74:75], v[74:75], v[234:235] op_sel:[0,0] op_sel_hi:[1,0]
    v_pk_mul_f32 v[76:77], v[76:77], v[234:235] op_sel:[0,0] op_sel_hi:[1,0]
    v_pk_mul_f32 v[78:79], v[78:79], v[234:235] op_sel:[0,0] op_sel_hi:[1,0]
    v_accvgpr_read_b32 v64, a80
    v_accvgpr_read_b32 v65, a81
    v_accvgpr_read_b32 v66, a82
    v_accvgpr_read_b32 v67, a83
    v_cvt_pk_bf16_f32 v84, v72, v73
    v_cvt_pk_bf16_f32 v85, v74, v75
    v_cvt_pk_bf16_f32 v86, v76, v77
    v_cvt_pk_bf16_f32 v87, v78, v79
    v_accvgpr_read_b32 v68, a84
    v_accvgpr_read_b32 v69, a85
    v_accvgpr_read_b32 v70, a86
    v_accvgpr_read_b32 v71, a87
    ds_write_b128 v246, v[84:87] offset:9216
    v_pk_mul_f32 v[64:65], v[64:65], v[234:235] op_sel:[0,0] op_sel_hi:[1,0]
    v_pk_mul_f32 v[66:67], v[66:67], v[234:235] op_sel:[0,0] op_sel_hi:[1,0]
    v_pk_mul_f32 v[68:69], v[68:69], v[234:235] op_sel:[0,0] op_sel_hi:[1,0]
    v_pk_mul_f32 v[70:71], v[70:71], v[234:235] op_sel:[0,0] op_sel_hi:[1,0]
    v_accvgpr_read_b32 v72, a88
    v_accvgpr_read_b32 v73, a89
    v_accvgpr_read_b32 v74, a90
    v_accvgpr_read_b32 v75, a91
    v_cvt_pk_bf16_f32 v88, v64, v65
    v_cvt_pk_bf16_f32 v89, v66, v67
    v_cvt_pk_bf16_f32 v90, v68, v69
    v_cvt_pk_bf16_f32 v91, v70, v71
    v_accvgpr_read_b32 v76, a92
    v_accvgpr_read_b32 v77, a93
    v_accvgpr_read_b32 v78, a94
    v_accvgpr_read_b32 v79, a95
    ds_write_b128 v246, v[88:91] offset:16384
    v_pk_mul_f32 v[72:73], v[72:73], v[234:235] op_sel:[0,0] op_sel_hi:[1,0]
    v_pk_mul_f32 v[74:75], v[74:75], v[234:235] op_sel:[0,0] op_sel_hi:[1,0]
    v_pk_mul_f32 v[76:77], v[76:77], v[234:235] op_sel:[0,0] op_sel_hi:[1,0]
    v_pk_mul_f32 v[78:79], v[78:79], v[234:235] op_sel:[0,0] op_sel_hi:[1,0]
    v_accvgpr_read_b32 v64, a96
    v_accvgpr_read_b32 v65, a97
    v_accvgpr_read_b32 v66, a98
    v_accvgpr_read_b32 v67, a99
    v_cvt_pk_bf16_f32 v92, v72, v73
    v_cvt_pk_bf16_f32 v93, v74, v75
    v_cvt_pk_bf16_f32 v94, v76, v77
    v_cvt_pk_bf16_f32 v95, v78, v79
    v_accvgpr_read_b32 v68, a100
    v_accvgpr_read_b32 v69, a101
    v_accvgpr_read_b32 v70, a102
    v_accvgpr_read_b32 v71, a103
    ds_write_b128 v246, v[92:95] offset:23552
    v_pk_mul_f32 v[64:65], v[64:65], v[234:235] op_sel:[0,1] op_sel_hi:[1,1]
    v_pk_mul_f32 v[66:67], v[66:67], v[234:235] op_sel:[0,1] op_sel_hi:[1,1]
    v_pk_mul_f32 v[68:69], v[68:69], v[234:235] op_sel:[0,1] op_sel_hi:[1,1]
    v_pk_mul_f32 v[70:71], v[70:71], v[234:235] op_sel:[0,1] op_sel_hi:[1,1]
    v_accvgpr_read_b32 v72, a104
    v_accvgpr_read_b32 v73, a105
    v_accvgpr_read_b32 v74, a106
    v_accvgpr_read_b32 v75, a107
    v_cvt_pk_bf16_f32 v80, v64, v65
    v_cvt_pk_bf16_f32 v81, v66, v67
    v_cvt_pk_bf16_f32 v82, v68, v69
    v_cvt_pk_bf16_f32 v83, v70, v71
    v_accvgpr_read_b32 v76, a108
    v_accvgpr_read_b32 v77, a109
    v_accvgpr_read_b32 v78, a110
    v_accvgpr_read_b32 v79, a111
    ds_write_b128 v246, v[80:83] offset:3072
    v_pk_mul_f32 v[72:73], v[72:73], v[234:235] op_sel:[0,1] op_sel_hi:[1,1]
    v_pk_mul_f32 v[74:75], v[74:75], v[234:235] op_sel:[0,1] op_sel_hi:[1,1]
    v_pk_mul_f32 v[76:77], v[76:77], v[234:235] op_sel:[0,1] op_sel_hi:[1,1]
    v_pk_mul_f32 v[78:79], v[78:79], v[234:235] op_sel:[0,1] op_sel_hi:[1,1]
    v_accvgpr_read_b32 v64, a112
    v_accvgpr_read_b32 v65, a113
    v_accvgpr_read_b32 v66, a114
    v_accvgpr_read_b32 v67, a115
    v_cvt_pk_bf16_f32 v84, v72, v73
    v_cvt_pk_bf16_f32 v85, v74, v75
    v_cvt_pk_bf16_f32 v86, v76, v77
    v_cvt_pk_bf16_f32 v87, v78, v79
    v_accvgpr_read_b32 v68, a116
    v_accvgpr_read_b32 v69, a117
    v_accvgpr_read_b32 v70, a118
    v_accvgpr_read_b32 v71, a119
    ds_write_b128 v246, v[84:87] offset:10240
    v_pk_mul_f32 v[64:65], v[64:65], v[234:235] op_sel:[0,1] op_sel_hi:[1,1]
    v_pk_mul_f32 v[66:67], v[66:67], v[234:235] op_sel:[0,1] op_sel_hi:[1,1]
    v_pk_mul_f32 v[68:69], v[68:69], v[234:235] op_sel:[0,1] op_sel_hi:[1,1]
    v_pk_mul_f32 v[70:71], v[70:71], v[234:235] op_sel:[0,1] op_sel_hi:[1,1]
    v_accvgpr_read_b32 v72, a120
    v_accvgpr_read_b32 v73, a121
    v_accvgpr_read_b32 v74, a122
    v_accvgpr_read_b32 v75, a123
    v_cvt_pk_bf16_f32 v88, v64, v65
    v_cvt_pk_bf16_f32 v89, v66, v67
    v_cvt_pk_bf16_f32 v90, v68, v69
    v_cvt_pk_bf16_f32 v91, v70, v71
    v_accvgpr_read_b32 v76, a124
    v_accvgpr_read_b32 v77, a125
    v_accvgpr_read_b32 v78, a126
    v_accvgpr_read_b32 v79, a127
    ds_write_b128 v246, v[88:91] offset:17408
    v_pk_mul_f32 v[72:73], v[72:73], v[234:235] op_sel:[0,1] op_sel_hi:[1,1]
    v_pk_mul_f32 v[74:75], v[74:75], v[234:235] op_sel:[0,1] op_sel_hi:[1,1]
    v_pk_mul_f32 v[76:77], v[76:77], v[234:235] op_sel:[0,1] op_sel_hi:[1,1]
    v_pk_mul_f32 v[78:79], v[78:79], v[234:235] op_sel:[0,1] op_sel_hi:[1,1]
    v_accvgpr_read_b32 v64, a128
    v_accvgpr_read_b32 v65, a129
    v_accvgpr_read_b32 v66, a130
    v_accvgpr_read_b32 v67, a131
    v_cvt_pk_bf16_f32 v92, v72, v73
    v_cvt_pk_bf16_f32 v93, v74, v75
    v_cvt_pk_bf16_f32 v94, v76, v77
    v_cvt_pk_bf16_f32 v95, v78, v79
    v_accvgpr_read_b32 v68, a132
    v_accvgpr_read_b32 v69, a133
    v_accvgpr_read_b32 v70, a134
    v_accvgpr_read_b32 v71, a135
    ds_write_b128 v246, v[92:95] offset:24576
    v_pk_mul_f32 v[64:65], v[64:65], v[236:237] op_sel:[0,0] op_sel_hi:[1,0]
    v_pk_mul_f32 v[66:67], v[66:67], v[236:237] op_sel:[0,0] op_sel_hi:[1,0]
    v_pk_mul_f32 v[68:69], v[68:69], v[236:237] op_sel:[0,0] op_sel_hi:[1,0]
    v_pk_mul_f32 v[70:71], v[70:71], v[236:237] op_sel:[0,0] op_sel_hi:[1,0]
    v_accvgpr_read_b32 v72, a136
    v_accvgpr_read_b32 v73, a137
    v_accvgpr_read_b32 v74, a138
    v_accvgpr_read_b32 v75, a139
    v_cvt_pk_bf16_f32 v80, v64, v65
    v_cvt_pk_bf16_f32 v81, v66, v67
    v_cvt_pk_bf16_f32 v82, v68, v69
    v_cvt_pk_bf16_f32 v83, v70, v71
    v_accvgpr_read_b32 v76, a140
    v_accvgpr_read_b32 v77, a141
    v_accvgpr_read_b32 v78, a142
    v_accvgpr_read_b32 v79, a143
    ds_write_b128 v246, v[80:83] offset:4096
    v_pk_mul_f32 v[72:73], v[72:73], v[236:237] op_sel:[0,0] op_sel_hi:[1,0]
    v_pk_mul_f32 v[74:75], v[74:75], v[236:237] op_sel:[0,0] op_sel_hi:[1,0]
    v_pk_mul_f32 v[76:77], v[76:77], v[236:237] op_sel:[0,0] op_sel_hi:[1,0]
    v_pk_mul_f32 v[78:79], v[78:79], v[236:237] op_sel:[0,0] op_sel_hi:[1,0]
    v_accvgpr_read_b32 v64, a144
    v_accvgpr_read_b32 v65, a145
    v_accvgpr_read_b32 v66, a146
    v_accvgpr_read_b32 v67, a147
    v_cvt_pk_bf16_f32 v84, v72, v73
    v_cvt_pk_bf16_f32 v85, v74, v75
    v_cvt_pk_bf16_f32 v86, v76, v77
    v_cvt_pk_bf16_f32 v87, v78, v79
    v_accvgpr_read_b32 v68, a148
    v_accvgpr_read_b32 v69, a149
    v_accvgpr_read_b32 v70, a150
    v_accvgpr_read_b32 v71, a151
    ds_write_b128 v246, v[84:87] offset:11264
    v_pk_mul_f32 v[64:65], v[64:65], v[236:237] op_sel:[0,0] op_sel_hi:[1,0]
    v_pk_mul_f32 v[66:67], v[66:67], v[236:237] op_sel:[0,0] op_sel_hi:[1,0]
    v_pk_mul_f32 v[68:69], v[68:69], v[236:237] op_sel:[0,0] op_sel_hi:[1,0]
    v_pk_mul_f32 v[70:71], v[70:71], v[236:237] op_sel:[0,0] op_sel_hi:[1,0]
    v_accvgpr_read_b32 v72, a152
    v_accvgpr_read_b32 v73, a153
    v_accvgpr_read_b32 v74, a154
    v_accvgpr_read_b32 v75, a155
    v_cvt_pk_bf16_f32 v88, v64, v65
    v_cvt_pk_bf16_f32 v89, v66, v67
    v_cvt_pk_bf16_f32 v90, v68, v69
    v_cvt_pk_bf16_f32 v91, v70, v71
    v_accvgpr_read_b32 v76, a156
    v_accvgpr_read_b32 v77, a157
    v_accvgpr_read_b32 v78, a158
    v_accvgpr_read_b32 v79, a159
    ds_write_b128 v246, v[88:91] offset:18432
    v_pk_mul_f32 v[72:73], v[72:73], v[236:237] op_sel:[0,0] op_sel_hi:[1,0]
    v_pk_mul_f32 v[74:75], v[74:75], v[236:237] op_sel:[0,0] op_sel_hi:[1,0]
    v_pk_mul_f32 v[76:77], v[76:77], v[236:237] op_sel:[0,0] op_sel_hi:[1,0]
    v_pk_mul_f32 v[78:79], v[78:79], v[236:237] op_sel:[0,0] op_sel_hi:[1,0]
    v_accvgpr_read_b32 v64, a160
    v_accvgpr_read_b32 v65, a161
    v_accvgpr_read_b32 v66, a162
    v_accvgpr_read_b32 v67, a163
    v_cvt_pk_bf16_f32 v92, v72, v73
    v_cvt_pk_bf16_f32 v93, v74, v75
    v_cvt_pk_bf16_f32 v94, v76, v77
    v_cvt_pk_bf16_f32 v95, v78, v79
    v_accvgpr_read_b32 v68, a164
    v_accvgpr_read_b32 v69, a165
    v_accvgpr_read_b32 v70, a166
    v_accvgpr_read_b32 v71, a167
    ds_write_b128 v246, v[92:95] offset:25600
    v_pk_mul_f32 v[64:65], v[64:65], v[236:237] op_sel:[0,1] op_sel_hi:[1,1]
    v_pk_mul_f32 v[66:67], v[66:67], v[236:237] op_sel:[0,1] op_sel_hi:[1,1]
    v_pk_mul_f32 v[68:69], v[68:69], v[236:237] op_sel:[0,1] op_sel_hi:[1,1]
    v_pk_mul_f32 v[70:71], v[70:71], v[236:237] op_sel:[0,1] op_sel_hi:[1,1]
    v_accvgpr_read_b32 v72, a168
    v_accvgpr_read_b32 v73, a169
    v_accvgpr_read_b32 v74, a170
    v_accvgpr_read_b32 v75, a171
    v_cvt_pk_bf16_f32 v80, v64, v65
    v_cvt_pk_bf16_f32 v81, v66, v67
    v_cvt_pk_bf16_f32 v82, v68, v69
    v_cvt_pk_bf16_f32 v83, v70, v71
    v_accvgpr_read_b32 v76, a172
    v_accvgpr_read_b32 v77, a173
    v_accvgpr_read_b32 v78, a174
    v_accvgpr_read_b32 v79, a175
    ds_write_b128 v246, v[80:83] offset:5120
    v_pk_mul_f32 v[72:73], v[72:73], v[236:237] op_sel:[0,1] op_sel_hi:[1,1]
    v_pk_mul_f32 v[74:75], v[74:75], v[236:237] op_sel:[0,1] op_sel_hi:[1,1]
    v_pk_mul_f32 v[76:77], v[76:77], v[236:237] op_sel:[0,1] op_sel_hi:[1,1]
    v_pk_mul_f32 v[78:79], v[78:79], v[236:237] op_sel:[0,1] op_sel_hi:[1,1]
    v_accvgpr_read_b32 v64, a176
    v_accvgpr_read_b32 v65, a177
    v_accvgpr_read_b32 v66, a178
    v_accvgpr_read_b32 v67, a179
    v_cvt_pk_bf16_f32 v84, v72, v73
    v_cvt_pk_bf16_f32 v85, v74, v75
    v_cvt_pk_bf16_f32 v86, v76, v77
    v_cvt_pk_bf16_f32 v87, v78, v79
    v_accvgpr_read_b32 v68, a180
    v_accvgpr_read_b32 v69, a181
    v_accvgpr_read_b32 v70, a182
    v_accvgpr_read_b32 v71, a183
    ds_write_b128 v246, v[84:87] offset:12288
    v_pk_mul_f32 v[64:65], v[64:65], v[236:237] op_sel:[0,1] op_sel_hi:[1,1]
    v_pk_mul_f32 v[66:67], v[66:67], v[236:237] op_sel:[0,1] op_sel_hi:[1,1]
    v_pk_mul_f32 v[68:69], v[68:69], v[236:237] op_sel:[0,1] op_sel_hi:[1,1]
    v_pk_mul_f32 v[70:71], v[70:71], v[236:237] op_sel:[0,1] op_sel_hi:[1,1]
    v_accvgpr_read_b32 v72, a184
    v_accvgpr_read_b32 v73, a185
    v_accvgpr_read_b32 v74, a186
    v_accvgpr_read_b32 v75, a187
    v_cvt_pk_bf16_f32 v88, v64, v65
    v_cvt_pk_bf16_f32 v89, v66, v67
    v_cvt_pk_bf16_f32 v90, v68, v69
    v_cvt_pk_bf16_f32 v91, v70, v71
    v_accvgpr_read_b32 v76, a188
    v_accvgpr_read_b32 v77, a189
    v_accvgpr_read_b32 v78, a190
    v_accvgpr_read_b32 v79, a191
    ds_write_b128 v246, v[88:91] offset:19456
    v_pk_mul_f32 v[72:73], v[72:73], v[236:237] op_sel:[0,1] op_sel_hi:[1,1]
    v_pk_mul_f32 v[74:75], v[74:75], v[236:237] op_sel:[0,1] op_sel_hi:[1,1]
    v_pk_mul_f32 v[76:77], v[76:77], v[236:237] op_sel:[0,1] op_sel_hi:[1,1]
    v_pk_mul_f32 v[78:79], v[78:79], v[236:237] op_sel:[0,1] op_sel_hi:[1,1]
    v_accvgpr_read_b32 v64, a192
    v_accvgpr_read_b32 v65, a193
    v_accvgpr_read_b32 v66, a194
    v_accvgpr_read_b32 v67, a195
    v_cvt_pk_bf16_f32 v92, v72, v73
    v_cvt_pk_bf16_f32 v93, v74, v75
    v_cvt_pk_bf16_f32 v94, v76, v77
    v_cvt_pk_bf16_f32 v95, v78, v79
    v_accvgpr_read_b32 v68, a196
    v_accvgpr_read_b32 v69, a197
    v_accvgpr_read_b32 v70, a198
    v_accvgpr_read_b32 v71, a199
    ds_write_b128 v246, v[92:95] offset:26624
    v_pk_mul_f32 v[64:65], v[64:65], v[238:239] op_sel:[0,0] op_sel_hi:[1,0]
    v_pk_mul_f32 v[66:67], v[66:67], v[238:239] op_sel:[0,0] op_sel_hi:[1,0]
    v_pk_mul_f32 v[68:69], v[68:69], v[238:239] op_sel:[0,0] op_sel_hi:[1,0]
    v_pk_mul_f32 v[70:71], v[70:71], v[238:239] op_sel:[0,0] op_sel_hi:[1,0]
    v_accvgpr_read_b32 v72, a200
    v_accvgpr_read_b32 v73, a201
    v_accvgpr_read_b32 v74, a202
    v_accvgpr_read_b32 v75, a203
    v_cvt_pk_bf16_f32 v80, v64, v65
    v_cvt_pk_bf16_f32 v81, v66, v67
    v_cvt_pk_bf16_f32 v82, v68, v69
    v_cvt_pk_bf16_f32 v83, v70, v71
    v_accvgpr_read_b32 v76, a204
    v_accvgpr_read_b32 v77, a205
    v_accvgpr_read_b32 v78, a206
    v_accvgpr_read_b32 v79, a207
    ds_write_b128 v246, v[80:83] offset:6144
    v_pk_mul_f32 v[72:73], v[72:73], v[238:239] op_sel:[0,0] op_sel_hi:[1,0]
    v_pk_mul_f32 v[74:75], v[74:75], v[238:239] op_sel:[0,0] op_sel_hi:[1,0]
    v_pk_mul_f32 v[76:77], v[76:77], v[238:239] op_sel:[0,0] op_sel_hi:[1,0]
    v_pk_mul_f32 v[78:79], v[78:79], v[238:239] op_sel:[0,0] op_sel_hi:[1,0]
    v_accvgpr_read_b32 v64, a208
    v_accvgpr_read_b32 v65, a209
    v_accvgpr_read_b32 v66, a210
    v_accvgpr_read_b32 v67, a211
    v_cvt_pk_bf16_f32 v84, v72, v73
    v_cvt_pk_bf16_f32 v85, v74, v75
    v_cvt_pk_bf16_f32 v86, v76, v77
    v_cvt_pk_bf16_f32 v87, v78, v79
    v_accvgpr_read_b32 v68, a212
    v_accvgpr_read_b32 v69, a213
    v_accvgpr_read_b32 v70, a214
    v_accvgpr_read_b32 v71, a215
    ds_write_b128 v246, v[84:87] offset:13312
    v_pk_mul_f32 v[64:65], v[64:65], v[238:239] op_sel:[0,0] op_sel_hi:[1,0]
    v_pk_mul_f32 v[66:67], v[66:67], v[238:239] op_sel:[0,0] op_sel_hi:[1,0]
    v_pk_mul_f32 v[68:69], v[68:69], v[238:239] op_sel:[0,0] op_sel_hi:[1,0]
    v_pk_mul_f32 v[70:71], v[70:71], v[238:239] op_sel:[0,0] op_sel_hi:[1,0]
    v_accvgpr_read_b32 v72, a216
    v_accvgpr_read_b32 v73, a217
    v_accvgpr_read_b32 v74, a218
    v_accvgpr_read_b32 v75, a219
    v_cvt_pk_bf16_f32 v88, v64, v65
    v_cvt_pk_bf16_f32 v89, v66, v67
    v_cvt_pk_bf16_f32 v90, v68, v69
    v_cvt_pk_bf16_f32 v91, v70, v71
    v_accvgpr_read_b32 v76, a220
    v_accvgpr_read_b32 v77, a221
    v_accvgpr_read_b32 v78, a222
    v_accvgpr_read_b32 v79, a223
    ds_write_b128 v246, v[88:91] offset:20480
    v_pk_mul_f32 v[72:73], v[72:73], v[238:239] op_sel:[0,0] op_sel_hi:[1,0]
    v_pk_mul_f32 v[74:75], v[74:75], v[238:239] op_sel:[0,0] op_sel_hi:[1,0]
    v_pk_mul_f32 v[76:77], v[76:77], v[238:239] op_sel:[0,0] op_sel_hi:[1,0]
    v_pk_mul_f32 v[78:79], v[78:79], v[238:239] op_sel:[0,0] op_sel_hi:[1,0]
    v_cvt_pk_bf16_f32 v92, v72, v73
    v_cvt_pk_bf16_f32 v93, v74, v75
    v_cvt_pk_bf16_f32 v94, v76, v77
    v_cvt_pk_bf16_f32 v95, v78, v79
    ds_write_b128 v246, v[92:95] offset:27648
    s_cmp_lg_u64 s[56:57], 0
    s_cbranch_scc1 L_slow
L_join:
    v_cmp_eq_u32 vcc, 0, v42
    v_mov_b32 v240, v42
    v_mov_b32 v241, v43
    s_nop 3
    s_cbranch_vccnz L_npoll
L_nok:
    s_waitcnt lgkmcnt(0)
    s_barrier
    ds_read_b128 v[156:159], v251 offset:0
    ds_read_b128 v[228:231], v251 offset:1024
    ds_read_b128 v[224:227], v251 offset:2048
    ds_read_b128 v[220:223], v251 offset:3072
    ds_read_b128 v[188:191], v251 offset:4096
    ds_read_b128 v[184:187], v251 offset:5120
    ds_read_b128 v[180:183], v251 offset:6144
    s_waitcnt lgkmcnt(6)
    v_mfma_f32_16x16x32_bf16 a[0:3], v[96:99], v[156:159], 0
    s_waitcnt vmcnt(6) lgkmcnt(5)
    ds_read_b128 v[176:179], v251 offset:7168
    ds_read_b64_tr_b16 v[112:113], v252 offset:4096
    v_mfma_f32_16x16x32_bf16 a[32:35], v[96:99], v[228:231], 0
    s_waitcnt lgkmcnt(6)
    ds_read_b64_tr_b16 v[114:115], v252 offset:5120
    v_mfma_f32_16x16x32_bf16 a[64:67], v[96:99], v[224:227], 0
    s_waitcnt lgkmcnt(6)
    ds_read_b128 v[172:175], v251 offset:8192
    ds_read_b64_tr_b16 v[116:117], v253 offset:4096
    v_mfma_f32_16x16x32_bf16 a[96:99], v[96:99], v[220:223], 0
    s_waitcnt lgkmcnt(7)
    ds_read_b64_tr_b16 v[118:119], v253 offset:5120
    v_mfma_f32_16x16x32_bf16 a[128:131], v[96:99], v[188:191], 0
    s_waitcnt lgkmcnt(7)
    s_add_u32 s50, s64, 0x30000
    s_add_u32 m0, s71, 0
    v_mfma_f32_16x16x32_bf16 a[160:163], v[96:99], v[184:187], 0
    s_waitcnt lgkmcnt(6)
    buffer_load_dwordx4 v250, s[24:27], s50 offen lds
    v_mfma_f32_16x16x32_bf16 a[192:195], v[96:99], v[180:183], 0
    s_add_u32 m0, s71, 0x400
    ds_read_b128 v[168:171], v251 offset:9216
    ds_read_b128 v[164:167], v251 offset:10240
    v_mfma_f32_16x16x32_bf16 a[4:7], v[100:103], v[156:159], 0
    buffer_load_dwordx4 v248, s[24:27], s50 offen lds
    v_mfma_f32_16x16x32_bf16 a[36:39], v[100:103], v[228:231], 0
    s_add_u32 s50, s64, 0x38000
    ds_read_b128 v[160:163], v251 offset:11264
    ds_read_b64_tr_b16 v[120:121], v252 offset:6144
    v_mfma_f32_16x16x32_bf16 a[68:71], v[100:103], v[224:227], 0
    s_add_u32 m0, s71, 0x800
    ds_read_b64_tr_b16 v[122:123], v252 offset:7168
    ds_read_b64_tr_b16 v[124:125], v253 offset:6144
    v_mfma_f32_16x16x32_bf16 a[100:103], v[100:103], v[220:223], 0
    buffer_load_dwordx4 v250, s[24:27], s50 offen lds
    v_mfma_f32_16x16x32_bf16 a[132:135], v[100:103], v[188:191], 0
    s_add_u32 m0, s71, 0xc00
    ds_read_b128 v[60:63], v251 offset:12288
    ds_read_b64_tr_b16 v[126:127], v253 offset:7168
    v_mfma_f32_16x16x32_bf16 a[164:167], v[100:103], v[184:187], 0
    s_mul_i32 s46, s64, 896
    ds_read_b128 v[56:59], v251 offset:13312
    v_mfma_f32_16x16x32_bf16 a[196:199], v[100:103], v[180:183], 0
    s_waitcnt lgkmcnt(9)
    buffer_load_dwordx4 v248, s[24:27], s50 offen lds
    v_mfma_f32_16x16x32_bf16 a[0:3], v[104:107], v[176:179], a[0:3]
    s_add_u32 s46, s46, 0
    ds_read_b128 v[52:55], v251 offset:14336
    v_mfma_f32_16x16x32_bf16 a[32:35], v[104:107], v[172:175], a[32:35]
    s_waitcnt lgkmcnt(8)
    v_mfma_f32_16x16x32_bf16 a[64:67], v[104:107], v[168:171], a[64:67]
    ds_read_b128 v[48:51], v251 offset:15360
    v_mfma_f32_16x16x32_bf16 a[96:99], v[104:107], v[164:167], a[96:99]
    s_waitcnt lgkmcnt(7)
    v_mfma_f32_16x16x32_bf16 a[128:131], v[104:107], v[160:163], a[128:131]
    s_waitcnt lgkmcnt(4)
    ds_read_b128 v[44:47], v251 offset:16384
    v_mfma_f32_16x16x32_bf16 a[160:163], v[104:107], v[60:63], a[160:163]
    s_waitcnt lgkmcnt(3)
    s_add_u32 s50, s64, 0x40000
    s_add_u32 m0, s71, 0x1000
    v_mfma_f32_16x16x32_bf16 a[192:195], v[104:107], v[56:59], a[192:195]
    buffer_load_dwordx4 v250, s[24:27], s50 offen lds
    v_mfma_f32_16x16x32_bf16 a[4:7], v[108:111], v[176:179], a[4:7]
    s_waitcnt vmcnt(5)
    ds_read_b128 v[40:43], v251 offset:17408
    s_add_u32 m0, s71, 0x1400
    v_mfma_f32_16x16x32_bf16 a[36:39], v[108:111], v[172:175], a[36:39]
    buffer_load_dwordx4 v248, s[24:27], s50 offen lds
    v_mfma_f32_16x16x32_bf16 a[68:71], v[108:111], v[168:171], a[68:71]
    s_add_u32 s50, s64, 0x48000
    ds_read_b128 v[36:39], v251 offset:18432
    v_mfma_f32_16x16x32_bf16 a[100:103], v[108:111], v[164:167], a[100:103]
    s_add_u32 m0, s71, 0x1800
    ds_read_b128 v[32:35], v251 offset:19456
    v_mfma_f32_16x16x32_bf16 a[132:135], v[108:111], v[160:163], a[132:135]
    buffer_load_dwordx4 v250, s[24:27], s50 offen lds
    v_mfma_f32_16x16x32_bf16 a[164:167], v[108:111], v[60:63], a[164:167]
    s_add_u32 m0, s71, 0x1c00
    ds_read_b128 v[28:31], v251 offset:20480
    v_mfma_f32_16x16x32_bf16 a[196:199], v[108:111], v[56:59], a[196:199]
    s_waitcnt lgkmcnt(4)
    buffer_load_dwordx4 v248, s[24:27], s50 offen lds
    v_mfma_f32_16x16x32_bf16 a[0:3], v[112:115], v[52:55], a[0:3]
    s_mov_b32 s49, 0x4000000
    ds_read_b128 v[24:27], v251 offset:21504
    ds_read_b64_tr_b16 v[96:97], v252 offset:8192
    v_mfma_f32_16x16x32_bf16 a[32:35], v[112:115], v[48:51], a[32:35]
    s_mov_b32 s48, 0
    ds_read_b64_tr_b16 v[98:99], v252 offset:9216
    v_mfma_f32_16x16x32_bf16 a[64:67], v[112:115], v[44:47], a[64:67]
    s_waitcnt lgkmcnt(6)
    ds_read_b128 v[20:23], v251 offset:22528
    ds_read_b64_tr_b16 v[100:101], v253 offset:8192
    v_mfma_f32_16x16x32_bf16 a[96:99], v[112:115], v[40:43], a[96:99]
    s_waitcnt lgkmcnt(7)
    ds_read_b64_tr_b16 v[102:103], v253 offset:9216
    v_mfma_f32_16x16x32_bf16 a[128:131], v[112:115], v[36:39], a[128:131]
    s_waitcnt lgkmcnt(7)
    ds_read_b128 v[16:19], v251 offset:23552
    ds_read_b64_tr_b16 v[104:105], v252 offset:10240
    v_mfma_f32_16x16x32_bf16 a[160:163], v[112:115], v[32:35], a[160:163]
    s_waitcnt lgkmcnt(8)
    ds_read_b64_tr_b16 v[106:107], v252 offset:11264
    v_mfma_f32_16x16x32_bf16 a[192:195], v[112:115], v[28:31], a[192:195]
    s_sub_u32 s52, s3, s71
    ds_read_b128 v[12:15], v251 offset:24576
    v_add_u32 v244, s52, v252
    v_mfma_f32_16x16x32_bf16 a[4:7], v[116:119], v[52:55], a[4:7]
    s_nop 0
    ds_read_b64_tr_b16 v[108:109], v253 offset:10240
    ds_read_b64_tr_b16 v[110:111], v253 offset:11264
    v_mfma_f32_16x16x32_bf16 a[36:39], v[116:119], v[48:51], a[36:39]
    ds_read_b128 v[8:11], v251 offset:25600
    v_add_u32 v245, s52, v253
    v_mfma_f32_16x16x32_bf16 a[68:71], v[116:119], v[44:47], a[68:71]
    v_mfma_f32_16x16x32_bf16 a[100:103], v[116:119], v[40:43], a[100:103]
    ds_read_b128 v[4:7], v251 offset:26624
    v_mfma_f32_16x16x32_bf16 a[132:135], v[116:119], v[36:39], a[132:135]
    s_lshr_b32 s52, s58, 3
    v_mfma_f32_16x16x32_bf16 a[164:167], v[116:119], v[32:35], a[164:167]
    ds_read_b128 v[0:3], v251 offset:27648
    v_mfma_f32_16x16x32_bf16 a[196:199], v[116:119], v[28:31], a[196:199]
    s_waitcnt lgkmcnt(7)
    v_mfma_f32_16x16x32_bf16 a[0:3], v[120:123], v[24:27], a[0:3]
    s_lshl_b32 s53, s52, 14
    ds_read_b128 v[192:195], v251 offset:28672
    v_mfma_f32_16x16x32_bf16 a[32:35], v[120:123], v[20:23], a[32:35]
    v_mfma_f32_16x16x32_bf16 a[64:67], v[120:123], v[16:19], a[64:67]
    s_waitcnt lgkmcnt(4)
    ds_read_b128 v[196:199], v251 offset:29696
    v_mfma_f32_16x16x32_bf16 a[96:99], v[120:123], v[12:15], a[96:99]
    s_waitcnt lgkmcnt(4)
    v_mfma_f32_16x16x32_bf16 a[128:131], v[120:123], v[8:11], a[128:131]
    s_waitcnt lgkmcnt(3)
    ds_read_b128 v[200:203], v251 offset:30720
    v_mfma_f32_16x16x32_bf16 a[160:163], v[120:123], v[4:7], a[160:163]
    s_waitcnt lgkmcnt(3)
    s_add_u32 s50, s64, 0x50000
    s_add_u32 m0, s71, 0x2000
    v_mfma_f32_16x16x32_bf16 a[192:195], v[120:123], v[0:3], a[192:195]
    buffer_load_dwordx4 v250, s[24:27], s50 offen lds
    v_mfma_f32_16x16x32_bf16 a[4:7], v[124:127], v[24:27], a[4:7]
    s_lshl_b32 s54, s32, 10
    ds_read_b128 v[204:207], v251 offset:31744
    s_add_u32 m0, s71, 0x2400
    v_mfma_f32_16x16x32_bf16 a[36:39], v[124:127], v[20:23], a[36:39]
    buffer_load_dwordx4 v248, s[24:27], s50 offen lds
    v_mfma_f32_16x16x32_bf16 a[68:71], v[124:127], v[16:19], a[68:71]
    s_add_u32 s53, s53, s54
    ds_read_b128 v[208:211], v251 offset:32768
    v_mfma_f32_16x16x32_bf16 a[100:103], v[124:127], v[12:15], a[100:103]
    s_add_u32 s50, s64, 0x58000
    ds_read_b128 v[212:215], v251 offset:33792
    s_add_u32 m0, s71, 0x2800
    v_mfma_f32_16x16x32_bf16 a[132:135], v[124:127], v[8:11], a[132:135]
    buffer_load_dwordx4 v250, s[24:27], s50 offen lds
    v_mfma_f32_16x16x32_bf16 a[164:167], v[124:127], v[4:7], a[164:167]
    s_add_u32 m0, s71, 0x2c00
    ds_read_b128 v[216:219], v251 offset:34816
    v_mfma_f32_16x16x32_bf16 a[196:199], v[124:127], v[0:3], a[196:199]
    s_waitcnt lgkmcnt(4)
    buffer_load_dwordx4 v248, s[24:27], s50 offen lds
    s_add_u32 s53, s53, 0x2000000
    v_mfma_f32_16x16x32_bf16 a[0:3], v[96:99], v[192:195], a[0:3]
    s_waitcnt vmcnt(8)
    ds_read_b128 v[128:131], v251 offset:35840
    ds_read_b64_tr_b16 v[112:113], v252 offset:0
    v_mfma_f32_16x16x32_bf16 a[32:35], v[96:99], v[196:199], a[32:35]
    s_mov_b32 s22, 13312
    ds_read_b64_tr_b16 v[114:115], v252 offset:1024
    v_mfma_f32_16x16x32_bf16 a[64:67], v[96:99], v[200:203], a[64:67]
    s_waitcnt lgkmcnt(6)
    s_add_u32 s20, s84, s53
    s_addc_u32 s21, s85, 0
    v_mfma_f32_16x16x32_bf16 a[96:99], v[96:99], v[204:207], a[96:99]
    s_waitcnt lgkmcnt(5)
    ds_read_b128 v[132:135], v251 offset:36864
    ds_read_b64_tr_b16 v[116:117], v253 offset:0
    v_mfma_f32_16x16x32_bf16 a[128:131], v[96:99], v[208:211], a[128:131]
    s_waitcnt lgkmcnt(6)
    ds_read_b128 v[136:139], v251 offset:37888
    ds_read_b64_tr_b16 v[118:119], v253 offset:1024
    v_mfma_f32_16x16x32_bf16 a[160:163], v[96:99], v[212:215], a[160:163]
    s_waitcnt lgkmcnt(7)
    ds_read_b64_tr_b16 v[120:121], v252 offset:2048
    ds_read_b64_tr_b16 v[122:123], v252 offset:3072
    v_mfma_f32_16x16x32_bf16 a[192:195], v[96:99], v[216:219], a[192:195]
    s_mov_b32 s23, 0x20000
    ds_read_b128 v[140:143], v251 offset:38912
    ds_read_b64_tr_b16 v[124:125], v253 offset:2048
    v_mfma_f32_16x16x32_bf16 a[4:7], v[100:103], v[192:195], a[4:7]
    s_lshl_b32 s43, s67, 4
    ds_read_b64_tr_b16 v[126:127], v253 offset:3072
    v_mfma_f32_16x16x32_bf16 a[36:39], v[100:103], v[196:199], a[36:39]
    ds_read_b128 v[144:147], v251 offset:39936
    v_mfma_f32_16x16x32_bf16 a[68:71], v[100:103], v[200:203], a[68:71]
    v_mfma_f32_16x16x32_bf16 a[100:103], v[100:103], v[204:207], a[100:103]
    s_mul_i32 s53, s67, 896
    ds_read_b128 v[148:151], v251 offset:40960
    v_mfma_f32_16x16x32_bf16 a[132:135], v[100:103], v[208:211], a[132:135]
    v_mfma_f32_16x16x32_bf16 a[164:167], v[100:103], v[212:215], a[164:167]
    ds_read_b128 v[152:155], v251 offset:41984
    v_mfma_f32_16x16x32_bf16 a[196:199], v[100:103], v[216:219], a[196:199]
    s_waitcnt lgkmcnt(8)
    v_mfma_f32_16x16x32_bf16 a[0:3], v[104:107], v[128:131], a[0:3]
    ds_read_b128 v[192:195], v251 offset:43008
    v_mfma_f32_16x16x32_bf16 a[32:35], v[104:107], v[132:135], a[32:35]
    v_mfma_f32_16x16x32_bf16 a[64:67], v[104:107], v[136:139], a[64:67]
    s_waitcnt lgkmcnt(4)
    ds_read_b128 v[196:199], v251 offset:44032
    v_mfma_f32_16x16x32_bf16 a[96:99], v[104:107], v[140:143], a[96:99]
    s_waitcnt lgkmcnt(4)
    s_add_u32 s8, s28, s53
    s_addc_u32 s9, s29, 0
    v_mfma_f32_16x16x32_bf16 a[128:131], v[104:107], v[144:147], a[128:131]
    s_waitcnt lgkmcnt(3)
    ds_read_b128 v[200:203], v251 offset:45056
    v_mfma_f32_16x16x32_bf16 a[160:163], v[104:107], v[148:151], a[160:163]
    s_waitcnt lgkmcnt(3)
    s_add_u32 s50, s64, 0x60000
    s_add_u32 m0, s71, 0
    v_mfma_f32_16x16x32_bf16 a[192:195], v[104:107], v[152:155], a[192:195]
    s_mul_i32 s53, s70, 25600
    buffer_load_dwordx4 v250, s[24:27], s50 offen lds
    v_mfma_f32_16x16x32_bf16 a[4:7], v[108:111], v[128:131], a[4:7]
    s_add_u32 m0, s71, 0x400
    ds_read_b128 v[204:207], v251 offset:46080
    v_mfma_f32_16x16x32_bf16 a[36:39], v[108:111], v[132:135], a[36:39]
    buffer_load_dwordx4 v248, s[24:27], s50 offen lds
    v_mfma_f32_16x16x32_bf16 a[68:71], v[108:111], v[136:139], a[68:71]
    s_add_u32 s50, s64, 0x68000
    s_sub_u32 s8, s8, s53
    s_subb_u32 s9, s9, 0
    v_mfma_f32_16x16x32_bf16 a[100:103], v[108:111], v[140:143], a[100:103]
    s_add_u32 m0, s71, 0x800
    ds_read_b128 v[208:211], v251 offset:47104
    ds_read_b128 v[212:215], v251 offset:48128
    v_mfma_f32_16x16x32_bf16 a[132:135], v[108:111], v[144:147], a[132:135]
    buffer_load_dwordx4 v250, s[24:27], s50 offen lds
    v_mfma_f32_16x16x32_bf16 a[164:167], v[108:111], v[148:151], a[164:167]
    s_mov_b32 s10, 0x32000
    ds_read_b128 v[216:219], v251 offset:49152
    s_add_u32 m0, s71, 0xc00
    v_mfma_f32_16x16x32_bf16 a[196:199], v[108:111], v[152:155], a[196:199]
    s_waitcnt lgkmcnt(4)
    buffer_load_dwordx4 v248, s[24:27], s50 offen lds
    v_mfma_f32_16x16x32_bf16 a[0:3], v[112:115], v[192:195], a[0:3]
    s_waitcnt vmcnt(8)
    ds_read_b128 v[128:131], v251 offset:50176
    ds_read_b64_tr_b16 v[96:97], v252 offset:4096
    v_mfma_f32_16x16x32_bf16 a[32:35], v[112:115], v[196:199], a[32:35]
    s_mov_b32 s11, 0x20000
    ds_read_b64_tr_b16 v[98:99], v252 offset:5120
    v_mfma_f32_16x16x32_bf16 a[64:67], v[112:115], v[200:203], a[64:67]
    s_waitcnt lgkmcnt(6)
    ds_read_b128 v[132:135], v251 offset:51200
    ds_read_b64_tr_b16 v[100:101], v253 offset:4096
    v_mfma_f32_16x16x32_bf16 a[96:99], v[112:115], v[204:207], a[96:99]
    s_waitcnt lgkmcnt(7)
    ds_read_b64_tr_b16 v[102:103], v253 offset:5120
    v_mfma_f32_16x16x32_bf16 a[128:131], v[112:115], v[208:211], a[128:131]
    s_waitcnt lgkmcnt(7)
    ds_read_b128 v[136:139], v251 offset:52224
    s_and_b32 s53, s52, 15
    v_mfma_f32_16x16x32_bf16 a[160:163], v[112:115], v[212:215], a[160:163]
    s_waitcnt lgkmcnt(7)
    ds_read_b64_tr_b16 v[104:105], v252 offset:6144
    ds_read_b64_tr_b16 v[106:107], v252 offset:7168
    v_mfma_f32_16x16x32_bf16 a[192:195], v[112:115], v[216:219], a[192:195]
    s_mul_i32 s53, s53, 7
    ds_read_b128 v[140:143], v251 offset:53248
    ds_read_b64_tr_b16 v[108:109], v253 offset:6144
    v_mfma_f32_16x16x32_bf16 a[4:7], v[116:119], v[192:195], a[4:7]
    s_mul_i32 s54, s70, 3
    ds_read_b64_tr_b16 v[110:111], v253 offset:7168
    v_mfma_f32_16x16x32_bf16 a[36:39], v[116:119], v[196:199], a[36:39]
    ds_read_b128 v[144:147], v251 offset:54272
    v_mfma_f32_16x16x32_bf16 a[68:71], v[116:119], v[200:203], a[68:71]
    s_add_u32 s53, s53, s54
    v_mfma_f32_16x16x32_bf16 a[100:103], v[116:119], v[204:207], a[100:103]
    ds_read_b128 v[148:151], v251 offset:55296
    v_mfma_f32_16x16x32_bf16 a[132:135], v[116:119], v[208:211], a[132:135]
    v_mfma_f32_16x16x32_bf16 a[164:167], v[116:119], v[212:215], a[164:167]
    s_lshl_b32 s53, s53, 15
    ds_read_b128 v[152:155], v251 offset:56320
    v_mfma_f32_16x16x32_bf16 a[196:199], v[116:119], v[216:219], a[196:199]
    s_waitcnt lgkmcnt(8)
    v_mfma_f32_16x16x32_bf16 a[0:3], v[120:123], v[128:131], a[0:3]
    ds_read_b128 v[192:195], v254 offset:0
    v_mfma_f32_16x16x32_bf16 a[32:35], v[120:123], v[132:135], a[32:35]
    s_lshr_b32 s54, s52, 4
    v_mfma_f32_16x16x32_bf16 a[64:67], v[120:123], v[136:139], a[64:67]
    s_waitcnt lgkmcnt(4)
    ds_read_b128 v[196:199], v254 offset:1024
    v_mfma_f32_16x16x32_bf16 a[96:99], v[120:123], v[140:143], a[96:99]
    s_waitcnt lgkmcnt(4)
    v_mfma_f32_16x16x32_bf16 a[128:131], v[120:123], v[144:147], a[128:131]
    s_waitcnt lgkmcnt(3)
    ds_read_b128 v[200:203], v254 offset:2048
    v_mfma_f32_16x16x32_bf16 a[160:163], v[120:123], v[148:151], a[160:163]
    s_waitcnt lgkmcnt(3)
    s_add_u32 s50, s64, 0x70000
    s_add_u32 m0, s71, 0x1000
    v_mfma_f32_16x16x32_bf16 a[192:195], v[120:123], v[152:155], a[192:195]
    buffer_load_dwordx4 v250, s[24:27], s50 offen lds
    v_mfma_f32_16x16x32_bf16 a[4:7], v[124:127], v[128:131], a[4:7]
    s_add_u32 m0, s71, 0x1400
    ds_read_b128 v[204:207], v254 offset:3072
    v_mfma_f32_16x16x32_bf16 a[36:39], v[124:127], v[132:135], a[36:39]
    s_lshl_b32 s54, s54, 10
    buffer_load_dwordx4 v248, s[24:27], s50 offen lds
    v_mfma_f32_16x16x32_bf16 a[68:71], v[124:127], v[136:139], a[68:71]
    s_add_u32 s50, s64, 0x78000
    ds_read_b128 v[208:211], v254 offset:4096
    v_mfma_f32_16x16x32_bf16 a[100:103], v[124:127], v[140:143], a[100:103]
    s_add_u32 m0, s71, 0x1800
    ds_read_b128 v[212:215], v254 offset:5120
    v_mfma_f32_16x16x32_bf16 a[132:135], v[124:127], v[144:147], a[132:135]
    s_add_u32 s53, s53, s54
    buffer_load_dwordx4 v250, s[24:27], s50 offen lds
    v_mfma_f32_16x16x32_bf16 a[164:167], v[124:127], v[148:151], a[164:167]
    s_add_u32 m0, s71, 0x1c00
    ds_read_b128 v[216:219], v254 offset:6144
    v_mfma_f32_16x16x32_bf16 a[196:199], v[124:127], v[152:155], a[196:199]
    s_waitcnt lgkmcnt(4)
    buffer_load_dwordx4 v248, s[24:27], s50 offen lds
    v_mfma_f32_16x16x32_bf16 a[0:3], v[96:99], v[192:195], a[0:3]
    ds_read_b128 v[128:131], v254 offset:7168
    s_add_u32 s53, s53, s67
    v_mfma_f32_16x16x32_bf16 a[32:35], v[96:99], v[196:199], a[32:35]
    s_waitcnt vmcnt(8)
    ds_read_b64_tr_b16 v[112:113], v252 offset:8192
    ds_read_b64_tr_b16 v[114:115], v252 offset:9216
    v_mfma_f32_16x16x32_bf16 a[64:67], v[96:99], v[200:203], a[64:67]
    s_waitcnt lgkmcnt(6)
    ds_read_b128 v[132:135], v254 offset:8192
    ds_read_b64_tr_b16 v[116:117], v253 offset:8192
    v_mfma_f32_16x16x32_bf16 a[96:99], v[96:99], v[204:207], a[96:99]
    s_waitcnt lgkmcnt(7)
    ds_read_b64_tr_b16 v[118:119], v253 offset:9216
    s_lshl_b32 s54, s32, 6
    v_mfma_f32_16x16x32_bf16 a[128:131], v[96:99], v[208:211], a[128:131]
    s_waitcnt lgkmcnt(7)
    ds_read_b128 v[136:139], v254 offset:9216
    ds_read_b64_tr_b16 v[120:121], v252 offset:10240
    v_mfma_f32_16x16x32_bf16 a[160:163], v[96:99], v[212:215], a[160:163]
    s_waitcnt lgkmcnt(8)
    ds_read_b64_tr_b16 v[122:123], v252 offset:11264
    v_mfma_f32_16x16x32_bf16 a[192:195], v[96:99], v[216:219], a[192:195]
    s_add_u32 s53, s53, s54
    ds_read_b128 v[140:143], v254 offset:10240
    ds_read_b64_tr_b16 v[124:125], v253 offset:10240
    v_mfma_f32_16x16x32_bf16 a[4:7], v[100:103], v[192:195], a[4:7]
    ds_read_b64_tr_b16 v[126:127], v253 offset:11264
    v_mfma_f32_16x16x32_bf16 a[36:39], v[100:103], v[196:199], a[36:39]
    s_mov_b32 s18, 0x1f840
    ds_read_b128 v[144:147], v254 offset:11264
    v_mfma_f32_16x16x32_bf16 a[68:71], v[100:103], v[200:203], a[68:71]
    s_add_u32 s16, s34, s53
    s_addc_u32 s17, s35, 0
    v_mfma_f32_16x16x32_bf16 a[100:103], v[100:103], v[204:207], a[100:103]
    ds_read_b128 v[148:151], v254 offset:12288
    v_mfma_f32_16x16x32_bf16 a[132:135], v[100:103], v[208:211], a[132:135]
    s_mov_b32 s19, 0x20000
    v_mfma_f32_16x16x32_bf16 a[164:167], v[100:103], v[212:215], a[164:167]
    ds_read_b128 v[152:155], v254 offset:13312
    v_mfma_f32_16x16x32_bf16 a[196:199], v[100:103], v[216:219], a[196:199]
    s_waitcnt lgkmcnt(7)
    v_mfma_f32_16x16x32_bf16 a[0:3], v[104:107], v[128:131], a[0:3]
    s_lshl_b32 s47, s70, 24
    ds_read_b128 v[192:195], v254 offset:14336
    v_mfma_f32_16x16x32_bf16 a[32:35], v[104:107], v[132:135], a[32:35]
    v_mfma_f32_16x16x32_bf16 a[64:67], v[104:107], v[136:139], a[64:67]
    s_waitcnt lgkmcnt(4)
    ds_read_b128 v[196:199], v254 offset:15360
    v_mfma_f32_16x16x32_bf16 a[96:99], v[104:107], v[140:143], a[96:99]
    s_waitcnt lgkmcnt(4)
    v_add_u32 v247, s47, v251
    v_mfma_f32_16x16x32_bf16 a[128:131], v[104:107], v[144:147], a[128:131]
    s_waitcnt lgkmcnt(3)
    ds_read_b128 v[200:203], v254 offset:16384
    v_mfma_f32_16x16x32_bf16 a[160:163], v[104:107], v[148:151], a[160:163]
    s_waitcnt lgkmcnt(3)
    s_add_u32 s50, s65, 0
    s_add_u32 m0, s71, 0x2000
    v_mfma_f32_16x16x32_bf16 a[192:195], v[104:107], v[152:155], a[192:195]
    buffer_load_dwordx4 v250, s[24:27], s50 offen lds
    v_mfma_f32_16x16x32_bf16 a[4:7], v[108:111], v[128:131], a[4:7]
    s_add_u32 m0, s71, 0x2400
    ds_read_b128 v[204:207], v254 offset:17408
    v_xor_b32 v246, 0x1000000, v247
    v_mfma_f32_16x16x32_bf16 a[36:39], v[108:111], v[132:135], a[36:39]
    buffer_load_dwordx4 v248, s[24:27], s50 offen lds
    v_mfma_f32_16x16x32_bf16 a[68:71], v[108:111], v[136:139], a[68:71]
    s_add_u32 s50, s65, 0x8000
    ds_read_b128 v[208:211], v254 offset:18432
    v_mfma_f32_16x16x32_bf16 a[100:103], v[108:111], v[140:143], a[100:103]
    s_add_u32 m0, s71, 0x2800
    ds_read_b128 v[212:215], v254 offset:19456
    v_mfma_f32_16x16x32_bf16 a[132:135], v[108:111], v[144:147], a[132:135]
    buffer_load_dwordx4 v250, s[24:27], s50 offen lds
    v_mfma_f32_16x16x32_bf16 a[164:167], v[108:111], v[148:151], a[164:167]
    s_add_u32 m0, s71, 0x2c00
    ds_read_b128 v[216:219], v254 offset:20480
    v_lshrrev_b32 v249, 1, v251
    v_mfma_f32_16x16x32_bf16 a[196:199], v[108:111], v[152:155], a[196:199]
    s_waitcnt lgkmcnt(4)
    buffer_load_dwordx4 v248, s[24:27], s50 offen lds
    s_lshl_b32 s75, 64, s70
    v_mfma_f32_16x16x32_bf16 a[0:3], v[112:115], v[192:195], a[0:3]
    s_waitcnt vmcnt(8)
    ds_read_b128 a[16:19], v254 offset:21504
    ds_read_b64_tr_b16 v[96:97], v252 offset:0
    v_mfma_f32_16x16x32_bf16 a[32:35], v[112:115], v[196:199], a[32:35]
    s_mov_b32 s55, 128
    ds_read_b64_tr_b16 v[98:99], v252 offset:1024
    v_mfma_f32_16x16x32_bf16 a[64:67], v[112:115], v[200:203], a[64:67]
    s_waitcnt lgkmcnt(6)
    ds_read_b128 a[48:51], v254 offset:22528
    ds_read_b64_tr_b16 v[100:101], v253 offset:0
    v_mfma_f32_16x16x32_bf16 a[96:99], v[112:115], v[204:207], a[96:99]
    s_waitcnt lgkmcnt(7)
    ds_read_b64_tr_b16 v[102:103], v253 offset:1024
    v_mfma_f32_16x16x32_bf16 a[128:131], v[112:115], v[208:211], a[128:131]
    s_waitcnt lgkmcnt(7)
    ds_read_b128 a[80:83], v254 offset:23552
    v_writelane_b32 v249, s55, 4
    v_mfma_f32_16x16x32_bf16 a[160:163], v[112:115], v[212:215], a[160:163]
    s_waitcnt lgkmcnt(7)
    ds_read_b64_tr_b16 v[104:105], v252 offset:2048
    ds_read_b64_tr_b16 v[106:107], v252 offset:3072
    v_mfma_f32_16x16x32_bf16 a[192:195], v[112:115], v[216:219], a[192:195]
    s_nop 0
    ds_read_b128 a[112:115], v254 offset:24576
    ds_read_b64_tr_b16 v[108:109], v253 offset:2048
    v_mfma_f32_16x16x32_bf16 a[4:7], v[116:119], v[192:195], a[4:7]
    s_mov_b32 s55, 256
    ds_read_b64_tr_b16 v[110:111], v253 offset:3072
    v_mfma_f32_16x16x32_bf16 a[36:39], v[116:119], v[196:199], a[36:39]
    ds_read_b128 a[144:147], v254 offset:25600
    v_mfma_f32_16x16x32_bf16 a[68:71], v[116:119], v[200:203], a[68:71]
    v_mfma_f32_16x16x32_bf16 a[100:103], v[116:119], v[204:207], a[100:103]
    ds_read_b128 a[176:179], v254 offset:26624
    v_writelane_b32 v249, s55, 5
    v_mfma_f32_16x16x32_bf16 a[132:135], v[116:119], v[208:211], a[132:135]
    v_mfma_f32_16x16x32_bf16 a[164:167], v[116:119], v[212:215], a[164:167]
    ds_read_b128 a[208:211], v254 offset:27648
    v_mfma_f32_16x16x32_bf16 a[196:199], v[116:119], v[216:219], a[196:199]
    s_waitcnt lgkmcnt(8)
    v_mfma_f32_16x16x32_bf16 a[0:3], v[120:123], a[16:19], a[0:3]
    s_mov_b32 s55, 384
    ds_read_b128 a[20:23], v254 offset:28672
    v_mfma_f32_16x16x32_bf16 a[32:35], v[120:123], a[48:51], a[32:35]
    v_mfma_f32_16x16x32_bf16 a[64:67], v[120:123], a[80:83], a[64:67]
    s_waitcnt lgkmcnt(4)
    ds_read_b128 a[52:55], v254 offset:29696
    v_writelane_b32 v249, s55, 6
    v_mfma_f32_16x16x32_bf16 a[96:99], v[120:123], a[112:115], a[96:99]
    s_waitcnt lgkmcnt(4)
    v_mfma_f32_16x16x32_bf16 a[128:131], v[120:123], a[144:147], a[128:131]
    s_waitcnt lgkmcnt(3)
    ds_read_b128 a[84:87], v254 offset:30720
    v_mfma_f32_16x16x32_bf16 a[160:163], v[120:123], a[176:179], a[160:163]
    s_waitcnt lgkmcnt(3)
    s_add_u32 s50, s65, 0x10000
    s_add_u32 m0, s71, 0
    v_mfma_f32_16x16x32_bf16 a[192:195], v[120:123], a[208:211], a[192:195]
    buffer_load_dwordx4 v250, s[24:27], s50 offen lds
    v_mfma_f32_16x16x32_bf16 a[4:7], v[124:127], a[16:19], a[4:7]
    s_add_u32 m0, s71, 0x400
    ds_read_b128 a[116:119], v254 offset:31744
    v_mfma_f32_16x16x32_bf16 a[36:39], v[124:127], a[48:51], a[36:39]
    buffer_load_dwordx4 v248, s[24:27], s50 offen lds
    v_mfma_f32_16x16x32_bf16 a[68:71], v[124:127], a[80:83], a[68:71]
    s_mov_b32 s55, 512
    ds_read_b128 a[148:151], v254 offset:32768
    v_writelane_b32 v249, s55, 7
    v_mfma_f32_16x16x32_bf16 a[100:103], v[124:127], a[112:115], a[100:103]
    s_add_u32 s50, s65, 0x18000
    ds_read_b128 a[180:183], v254 offset:33792
    s_add_u32 m0, s71, 0x800
    v_mfma_f32_16x16x32_bf16 a[132:135], v[124:127], a[144:147], a[132:135]
    buffer_load_dwordx4 v250, s[24:27], s50 offen lds
    v_mfma_f32_16x16x32_bf16 a[164:167], v[124:127], a[176:179], a[164:167]
    s_add_u32 m0, s71, 0xc00
    ds_read_b128 a[212:215], v254 offset:34816
    v_and_b32 v255, 0xf0, v251
    v_mfma_f32_16x16x32_bf16 a[196:199], v[124:127], a[208:211], a[196:199]
    s_waitcnt lgkmcnt(4)
    buffer_load_dwordx4 v248, s[24:27], s50 offen lds
    v_mfma_f32_16x16x32_bf16 a[0:3], v[96:99], a[20:23], a[0:3]
    ds_read_b128 a[24:27], v254 offset:35840
    v_lshlrev_b32 v255, 7, v255
    v_mfma_f32_16x16x32_bf16 a[32:35], v[96:99], a[52:55], a[32:35]
    s_waitcnt vmcnt(8)
    ds_read_b64_tr_b16 v[112:113], v252 offset:4096
    ds_read_b64_tr_b16 v[114:115], v252 offset:5120
    v_mfma_f32_16x16x32_bf16 a[64:67], v[96:99], a[84:87], a[64:67]
    s_waitcnt lgkmcnt(6)
    ds_read_b128 a[56:59], v254 offset:36864
    ds_read_b64_tr_b16 v[116:117], v253 offset:4096
    v_mfma_f32_16x16x32_bf16 a[96:99], v[96:99], a[116:119], a[96:99]
    s_waitcnt lgkmcnt(7)
    ds_read_b64_tr_b16 v[118:119], v253 offset:5120
    v_bfe_u32 v242, v251, 8, 1
    v_mfma_f32_16x16x32_bf16 a[128:131], v[96:99], a[148:151], a[128:131]
    s_waitcnt lgkmcnt(7)
    ds_read_b128 a[88:91], v254 offset:37888
    ds_read_b64_tr_b16 v[120:121], v252 offset:6144
    v_mfma_f32_16x16x32_bf16 a[160:163], v[96:99], a[180:183], a[160:163]
    s_waitcnt lgkmcnt(8)
    ds_read_b64_tr_b16 v[122:123], v252 offset:7168
    v_mfma_f32_16x16x32_bf16 a[192:195], v[96:99], a[212:215], a[192:195]
    ds_read_b128 a[120:123], v254 offset:38912
    v_lshl_add_u32 v255, v242, 5, v255
    v_mfma_f32_16x16x32_bf16 a[4:7], v[100:103], a[20:23], a[4:7]
    s_nop 0
    ds_read_b64_tr_b16 v[124:125], v253 offset:6144
    ds_read_b64_tr_b16 v[126:127], v253 offset:7168
    v_mfma_f32_16x16x32_bf16 a[36:39], v[100:103], a[52:55], a[36:39]
    ds_read_b128 a[152:155], v254 offset:39936
    v_mfma_f32_16x16x32_bf16 a[68:71], v[100:103], a[84:87], a[68:71]
    v_bfe_u32 v242, v251, 9, 1
    v_mfma_f32_16x16x32_bf16 a[100:103], v[100:103], a[116:119], a[100:103]
    ds_read_b128 a[184:187], v254 offset:40960
    v_mfma_f32_16x16x32_bf16 a[132:135], v[100:103], a[148:151], a[132:135]
    v_mfma_f32_16x16x32_bf16 a[164:167], v[100:103], a[180:183], a[164:167]
    ds_read_b128 a[216:219], v254 offset:41984
    v_lshl_add_u32 v255, v242, 4, v255
    v_mfma_f32_16x16x32_bf16 a[196:199], v[100:103], a[212:215], a[196:199]
    s_waitcnt lgkmcnt(7)
    v_mfma_f32_16x16x32_bf16 a[0:3], v[104:107], a[24:27], a[0:3]
    ds_read_b128 a[28:31], v254 offset:43008
    v_mfma_f32_16x16x32_bf16 a[32:35], v[104:107], a[56:59], a[32:35]
    v_mfma_f32_16x16x32_bf16 a[64:67], v[104:107], a[88:91], a[64:67]
    s_waitcnt lgkmcnt(4)
    ds_read_b128 a[60:63], v254 offset:44032
    v_mfma_f32_16x16x32_bf16 a[96:99], v[104:107], a[120:123], a[96:99]
    s_waitcnt lgkmcnt(4)
    v_mfma_f32_16x16x32_bf16 a[128:131], v[104:107], a[152:155], a[128:131]
    s_waitcnt lgkmcnt(3)
    ds_read_b128 a[92:95], v254 offset:45056
    v_mfma_f32_16x16x32_bf16 a[160:163], v[104:107], a[184:187], a[160:163]
    s_waitcnt lgkmcnt(3)
    s_add_u32 s50, s65, 0x20000
    s_add_u32 m0, s71, 0x1000
    v_mfma_f32_16x16x32_bf16 a[192:195], v[104:107], a[216:219], a[192:195]
    buffer_load_dwordx4 v250, s[24:27], s50 offen lds
    v_mfma_f32_16x16x32_bf16 a[4:7], v[108:111], a[24:27], a[4:7]
    s_add_u32 m0, s71, 0x1400
    ds_read_b128 a[124:127], v254 offset:46080
    v_mfma_f32_16x16x32_bf16 a[36:39], v[108:111], a[56:59], a[36:39]
    buffer_load_dwordx4 v248, s[24:27], s50 offen lds
    v_mfma_f32_16x16x32_bf16 a[68:71], v[108:111], a[88:91], a[68:71]
    s_add_u32 s50, s65, 0x28000
    ds_read_b128 a[156:159], v254 offset:47104
    v_mfma_f32_16x16x32_bf16 a[100:103], v[108:111], a[120:123], a[100:103]
    s_add_u32 m0, s71, 0x1800
    ds_read_b128 a[188:191], v254 offset:48128
    v_mfma_f32_16x16x32_bf16 a[132:135], v[108:111], a[152:155], a[132:135]
    buffer_load_dwordx4 v250, s[24:27], s50 offen lds
    v_mfma_f32_16x16x32_bf16 a[164:167], v[108:111], a[184:187], a[164:167]
    s_add_u32 m0, s71, 0x1c00
    ds_read_b128 a[220:223], v254 offset:49152
    v_mfma_f32_16x16x32_bf16 a[196:199], v[108:111], a[216:219], a[196:199]
    s_waitcnt lgkmcnt(4)
    buffer_load_dwordx4 v248, s[24:27], s50 offen lds
    v_mfma_f32_16x16x32_bf16 a[0:3], v[112:115], a[28:31], a[0:3]
    s_waitcnt vmcnt(8)
    ds_read_b128 a[224:227], v254 offset:50176
    ds_read_b64_tr_b16 v[96:97], v252 offset:8192
    v_mfma_f32_16x16x32_bf16 a[32:35], v[112:115], a[60:63], a[32:35]
    ds_read_b64_tr_b16 v[98:99], v252 offset:9216
    v_mfma_f32_16x16x32_bf16 a[64:67], v[112:115], a[92:95], a[64:67]
    s_waitcnt lgkmcnt(6)
    ds_read_b128 a[228:231], v254 offset:51200
    ds_read_b64_tr_b16 v[100:101], v253 offset:8192
    v_mfma_f32_16x16x32_bf16 a[96:99], v[112:115], a[124:127], a[96:99]
    s_waitcnt lgkmcnt(7)
    ds_read_b64_tr_b16 v[102:103], v253 offset:9216
    v_mfma_f32_16x16x32_bf16 a[128:131], v[112:115], a[156:159], a[128:131]
    s_waitcnt lgkmcnt(7)
    ds_read_b128 a[232:235], v254 offset:52224
    ds_read_b64_tr_b16 v[104:105], v252 offset:10240
    v_mfma_f32_16x16x32_bf16 a[160:163], v[112:115], a[188:191], a[160:163]
    s_waitcnt lgkmcnt(8)
    ds_read_b64_tr_b16 v[106:107], v252 offset:11264
    v_mfma_f32_16x16x32_bf16 a[192:195], v[112:115], a[220:223], a[192:195]
    s_nop 0
    ds_read_b128 a[236:239], v254 offset:53248
    ds_read_b64_tr_b16 v[108:109], v253 offset:10240
    v_mfma_f32_16x16x32_bf16 a[4:7], v[116:119], a[28:31], a[4:7]
    ds_read_b64_tr_b16 v[110:111], v253 offset:11264
    v_mfma_f32_16x16x32_bf16 a[36:39], v[116:119], a[60:63], a[36:39]
    ds_read_b128 a[240:243], v254 offset:54272
    v_mfma_f32_16x16x32_bf16 a[68:71], v[116:119], a[92:95], a[68:71]
    v_mfma_f32_16x16x32_bf16 a[100:103], v[116:119], a[124:127], a[100:103]
    ds_read_b128 a[244:247], v254 offset:55296
    v_mfma_f32_16x16x32_bf16 a[132:135], v[116:119], a[156:159], a[132:135]
    v_mfma_f32_16x16x32_bf16 a[164:167], v[116:119], a[188:191], a[164:167]
    ds_read_b128 a[248:251], v254 offset:56320
    v_mfma_f32_16x16x32_bf16 a[196:199], v[116:119], a[220:223], a[196:199]
    s_waitcnt lgkmcnt(7)
    v_mfma_f32_16x16x32_bf16 a[0:3], v[120:123], a[224:227], a[0:3]
    v_mfma_f32_16x16x32_bf16 a[32:35], v[120:123], a[228:231], a[32:35]
    v_mfma_f32_16x16x32_bf16 a[64:67], v[120:123], a[232:235], a[64:67]
    s_waitcnt lgkmcnt(3)
    v_mfma_f32_16x16x32_bf16 a[96:99], v[120:123], a[236:239], a[96:99]
    s_waitcnt lgkmcnt(2)
    v_mfma_f32_16x16x32_bf16 a[128:131], v[120:123], a[240:243], a[128:131]
    s_waitcnt lgkmcnt(1)
    v_mfma_f32_16x16x32_bf16 a[160:163], v[120:123], a[244:247], a[160:163]
    s_waitcnt lgkmcnt(0)
    s_add_u32 s50, s65, 0x30000
    s_add_u32 m0, s71, 0x2000
    v_mfma_f32_16x16x32_bf16 a[192:195], v[120:123], a[248:251], a[192:195]
    buffer_load_dwordx4 v250, s[24:27], s50 offen lds
    v_mfma_f32_16x16x32_bf16 a[4:7], v[124:127], a[224:227], a[4:7]
    s_add_u32 m0, s71, 0x2400
    v_mfma_f32_16x16x32_bf16 a[36:39], v[124:127], a[228:231], a[36:39]
    buffer_load_dwordx4 v248, s[24:27], s50 offen lds
    v_mfma_f32_16x16x32_bf16 a[68:71], v[124:127], a[232:235], a[68:71]
    s_add_u32 s50, s65, 0x38000
    v_mfma_f32_16x16x32_bf16 a[100:103], v[124:127], a[236:239], a[100:103]
    s_add_u32 m0, s71, 0x2800
    v_mfma_f32_16x16x32_bf16 a[132:135], v[124:127], a[240:243], a[132:135]
    buffer_load_dwordx4 v250, s[24:27], s50 offen lds
    v_mfma_f32_16x16x32_bf16 a[164:167], v[124:127], a[244:247], a[164:167]
    s_add_u32 m0, s71, 0x2c00
    v_mfma_f32_16x16x32_bf16 a[196:199], v[124:127], a[248:251], a[196:199]
    buffer_load_dwordx4 v248, s[24:27], s50 offen lds
    v_mfma_f32_16x16x32_bf16 a[8:11], v[96:99], v[156:159], 0
    s_barrier
    v_mfma_f32_16x16x32_bf16 a[40:43], v[96:99], v[228:231], 0
    s_waitcnt vmcnt(8)
    ds_read_b64_tr_b16 v[112:113], v252 offset:0
    ds_read_b64_tr_b16 v[114:115], v252 offset:1024
    v_mfma_f32_16x16x32_bf16 a[72:75], v[96:99], v[224:227], 0
    s_add_u32 s50, s65, 0x40000
    v_accvgpr_read_b32 v64, a0
    v_accvgpr_read_b32 v65, a1
    v_mfma_f32_16x16x32_bf16 a[104:107], v[96:99], v[220:223], 0
    s_add_u32 m0, s3, 0
    v_accvgpr_read_b32 v66, a2
    v_accvgpr_read_b32 v67, a3
    v_mfma_f32_16x16x32_bf16 a[136:139], v[96:99], v[188:191], 0
    buffer_load_dwordx4 v250, s[24:27], s50 offen lds
    v_mfma_f32_16x16x32_bf16 a[168:171], v[96:99], v[184:187], 0
    s_add_u32 m0, s3, 0x400
    v_accvgpr_read_b32 v68, a4
    v_accvgpr_read_b32 v69, a5
    v_mfma_f32_16x16x32_bf16 a[200:203], v[96:99], v[180:183], 0
    buffer_load_dwordx4 v248, s[24:27], s50 offen lds
    v_mfma_f32_16x16x32_bf16 a[12:15], v[100:103], v[156:159], 0
    s_add_u32 s50, s65, 0x48000
    s_add_u32 m0, s3, 0x800
    v_accvgpr_read_b32 v70, a6
    v_mfma_f32_16x16x32_bf16 a[44:47], v[100:103], v[228:231], 0
    buffer_load_dwordx4 v250, s[24:27], s50 offen lds
    s_add_u32 m0, s3, 0xc00
    v_mfma_f32_16x16x32_bf16 a[76:79], v[100:103], v[224:227], 0
    buffer_load_dwordx4 v248, s[24:27], s50 offen lds
    v_mfma_f32_16x16x32_bf16 a[108:111], v[100:103], v[220:223], 0
    s_add_u32 s50, s65, 0x50000
    s_add_u32 m0, s3, 0x1000
    v_accvgpr_read_b32 v71, a7
    v_mfma_f32_16x16x32_bf16 a[140:143], v[100:103], v[188:191], 0
    buffer_load_dwordx4 v250, s[24:27], s50 offen lds
    s_add_u32 m0, s3, 0x1400
    v_mfma_f32_16x16x32_bf16 a[172:175], v[100:103], v[184:187], 0
    buffer_load_dwordx4 v248, s[24:27], s50 offen lds
    v_mfma_f32_16x16x32_bf16 a[204:207], v[100:103], v[180:183], 0
    s_add_u32 s50, s65, 0x58000
    s_add_u32 m0, s3, 0x1800
    v_cvt_pk_bf16_f32 v80, v64, v65
    v_mfma_f32_16x16x32_bf16 a[8:11], v[104:107], v[176:179], a[8:11]
    buffer_load_dwordx4 v250, s[24:27], s50 offen lds
    s_add_u32 m0, s3, 0x1c00
    v_mfma_f32_16x16x32_bf16 a[40:43], v[104:107], v[172:175], a[40:43]
    buffer_load_dwordx4 v248, s[24:27], s50 offen lds
    v_mfma_f32_16x16x32_bf16 a[72:75], v[104:107], v[168:171], a[72:75]
    s_bfe_u32 s80, s59, 0x40000
    v_cvt_pk_bf16_f32 v81, v66, v67
    v_cvt_pk_bf16_f32 v82, v68, v69
    v_mfma_f32_16x16x32_bf16 a[104:107], v[104:107], v[164:167], a[104:107]
    s_lshl_b32 s80, s80, 10
    ds_read_b64_tr_b16 v[116:117], v253 offset:0
    v_cvt_pk_bf16_f32 v83, v70, v71
    v_mfma_f32_16x16x32_bf16 a[136:139], v[104:107], v[160:163], a[136:139]
    s_add_u32 s80, s80, s46
    ds_read_b64_tr_b16 v[118:119], v253 offset:1024
    ds_read_b64_tr_b16 v[120:121], v252 offset:2048
    v_mfma_f32_16x16x32_bf16 a[168:171], v[104:107], v[60:63], a[168:171]
    buffer_store_dwordx4 v[80:83], v251, s[28:31], s80 offen sc1
    v_mfma_f32_16x16x32_bf16 a[200:203], v[104:107], v[56:59], a[200:203]
    s_nop 0
    ds_read_b64_tr_b16 v[122:123], v252 offset:3072
    ds_read_b64_tr_b16 v[124:125], v253 offset:2048
    v_mfma_f32_16x16x32_bf16 a[12:15], v[108:111], v[176:179], a[12:15]
    ds_read_b64_tr_b16 v[126:127], v253 offset:3072
    v_mfma_f32_16x16x32_bf16 a[44:47], v[108:111], v[172:175], a[44:47]
    v_mfma_f32_16x16x32_bf16 a[76:79], v[108:111], v[168:171], a[76:79]
    v_mfma_f32_16x16x32_bf16 a[108:111], v[108:111], v[164:167], a[108:111]
    v_mfma_f32_16x16x32_bf16 a[140:143], v[108:111], v[160:163], a[140:143]
    v_mfma_f32_16x16x32_bf16 a[172:175], v[108:111], v[60:63], a[172:175]
    v_mfma_f32_16x16x32_bf16 a[204:207], v[108:111], v[56:59], a[204:207]
    s_waitcnt lgkmcnt(3)
    v_mfma_f32_16x16x32_bf16 a[8:11], v[112:115], v[52:55], a[8:11]
    s_waitcnt vmcnt(13)
    ds_read_b64_tr_b16 v[96:97], v252 offset:4096
    v_accvgpr_read_b32 v72, a32
    v_mfma_f32_16x16x32_bf16 a[40:43], v[112:115], v[48:51], a[40:43]
    s_bfe_u32 s80, s59, 0x40004
    ds_read_b64_tr_b16 v[98:99], v252 offset:5120
    v_accvgpr_read_b32 v73, a33
    v_mfma_f32_16x16x32_bf16 a[72:75], v[112:115], v[44:47], a[72:75]
    s_add_u32 s50, s65, 0x60000
    ds_read_b64_tr_b16 v[100:101], v253 offset:4096
    v_accvgpr_read_b32 v74, a34
    v_mfma_f32_16x16x32_bf16 a[104:107], v[112:115], v[40:43], a[104:107]
    s_add_u32 m0, s71, 0
    ds_read_b64_tr_b16 v[102:103], v253 offset:5120
    v_accvgpr_read_b32 v75, a35
    v_mfma_f32_16x16x32_bf16 a[136:139], v[112:115], v[36:39], a[136:139]
    s_waitcnt lgkmcnt(4)
    buffer_load_dwordx4 v250, s[24:27], s50 offen lds
    v_mfma_f32_16x16x32_bf16 a[168:171], v[112:115], v[32:35], a[168:171]
    s_add_u32 m0, s71, 0x400
    ds_read_b64_tr_b16 v[104:105], v252 offset:6144
    ds_read_b64_tr_b16 v[106:107], v252 offset:7168
    v_mfma_f32_16x16x32_bf16 a[200:203], v[112:115], v[28:31], a[200:203]
    buffer_load_dwordx4 v248, s[24:27], s50 offen lds
    v_mfma_f32_16x16x32_bf16 a[12:15], v[116:119], v[52:55], a[12:15]
    s_add_u32 s50, s65, 0x68000
    ds_read_b64_tr_b16 v[108:109], v253 offset:6144
    ds_read_b64_tr_b16 v[110:111], v253 offset:7168
    v_mfma_f32_16x16x32_bf16 a[44:47], v[116:119], v[48:51], a[44:47]
    s_add_u32 m0, s71, 0x800
    v_accvgpr_read_b32 v76, a36
    v_accvgpr_read_b32 v77, a37
    v_mfma_f32_16x16x32_bf16 a[76:79], v[116:119], v[44:47], a[76:79]
    buffer_load_dwordx4 v250, s[24:27], s50 offen lds
    v_mfma_f32_16x16x32_bf16 a[108:111], v[116:119], v[40:43], a[108:111]
    s_add_u32 m0, s71, 0xc00
    v_accvgpr_read_b32 v78, a38
    v_accvgpr_read_b32 v79, a39
    v_mfma_f32_16x16x32_bf16 a[140:143], v[116:119], v[36:39], a[140:143]
    buffer_load_dwordx4 v248, s[24:27], s50 offen lds
    v_mfma_f32_16x16x32_bf16 a[172:175], v[116:119], v[32:35], a[172:175]
    s_lshl_b32 s80, s80, 10
    v_cvt_pk_bf16_f32 v84, v72, v73
    v_cvt_pk_bf16_f32 v85, v74, v75
    v_mfma_f32_16x16x32_bf16 a[204:207], v[116:119], v[28:31], a[204:207]
    s_add_u32 s80, s80, s46
    v_cvt_pk_bf16_f32 v86, v76, v77
    v_cvt_pk_bf16_f32 v87, v78, v79
    v_mfma_f32_16x16x32_bf16 a[8:11], v[120:123], v[24:27], a[8:11]
    ds_read_b128 v[128:131], v251 offset:28672
    v_mfma_f32_16x16x32_bf16 a[40:43], v[120:123], v[20:23], a[40:43]
    buffer_store_dwordx4 v[84:87], v251, s[28:31], s80 offen sc1
    v_mfma_f32_16x16x32_bf16 a[72:75], v[120:123], v[16:19], a[72:75]
    ds_read_b128 v[132:135], v251 offset:29696
    v_mfma_f32_16x16x32_bf16 a[104:107], v[120:123], v[12:15], a[104:107]
    s_add_u32 s50, s65, 0x70000
    v_mfma_f32_16x16x32_bf16 a[136:139], v[120:123], v[8:11], a[136:139]
    s_add_u32 m0, s71, 0x1000
    ds_read_b128 v[136:139], v251 offset:30720
    v_mfma_f32_16x16x32_bf16 a[168:171], v[120:123], v[4:7], a[168:171]
    s_waitcnt lgkmcnt(3)
    buffer_load_dwordx4 v250, s[24:27], s50 offen lds
    v_mfma_f32_16x16x32_bf16 a[200:203], v[120:123], v[0:3], a[200:203]
    s_add_u32 m0, s71, 0x1400
    ds_read_b128 v[140:143], v251 offset:31744
    v_mfma_f32_16x16x32_bf16 a[12:15], v[124:127], v[24:27], a[12:15]
    buffer_load_dwordx4 v248, s[24:27], s50 offen lds
    v_mfma_f32_16x16x32_bf16 a[44:47], v[124:127], v[20:23], a[44:47]
    s_add_u32 s50, s65, 0x78000
    ds_read_b128 v[144:147], v251 offset:32768
    v_mfma_f32_16x16x32_bf16 a[76:79], v[124:127], v[16:19], a[76:79]
    s_add_u32 m0, s71, 0x1800
    v_mfma_f32_16x16x32_bf16 a[108:111], v[124:127], v[12:15], a[108:111]
    buffer_load_dwordx4 v250, s[24:27], s50 offen lds
    v_mfma_f32_16x16x32_bf16 a[140:143], v[124:127], v[8:11], a[140:143]
    s_add_u32 m0, s71, 0x1c00
    ds_read_b128 v[148:151], v251 offset:33792
    v_mfma_f32_16x16x32_bf16 a[172:175], v[124:127], v[4:7], a[172:175]
    ds_read_b128 v[152:155], v251 offset:34816
    v_mfma_f32_16x16x32_bf16 a[204:207], v[124:127], v[0:3], a[204:207]
    s_waitcnt lgkmcnt(4)
    buffer_load_dwordx4 v248, s[24:27], s50 offen lds
    v_mfma_f32_16x16x32_bf16 a[8:11], v[96:99], v[128:131], a[8:11]
    s_waitcnt vmcnt(18)
    ds_read_b128 v[192:195], v251 offset:35840
    ds_read_b64_tr_b16 v[112:113], v252 offset:8192
    v_mfma_f32_16x16x32_bf16 a[40:43], v[96:99], v[132:135], a[40:43]
    s_bfe_u32 s80, s59, 0x40008
    ds_read_b64_tr_b16 v[114:115], v252 offset:9216
    v_accvgpr_read_b32 v64, a64
    v_mfma_f32_16x16x32_bf16 a[72:75], v[96:99], v[136:139], a[72:75]
    s_waitcnt lgkmcnt(6)
    ds_read_b128 v[196:199], v251 offset:36864
    ds_read_b64_tr_b16 v[116:117], v253 offset:8192
    v_mfma_f32_16x16x32_bf16 a[104:107], v[96:99], v[140:143], a[104:107]
    s_waitcnt lgkmcnt(7)
    ds_read_b64_tr_b16 v[118:119], v253 offset:9216
    v_accvgpr_read_b32 v65, a65
    v_mfma_f32_16x16x32_bf16 a[136:139], v[96:99], v[144:147], a[136:139]
    s_waitcnt lgkmcnt(7)
    ds_read_b128 v[200:203], v251 offset:37888
    ds_read_b64_tr_b16 v[120:121], v252 offset:10240
    v_mfma_f32_16x16x32_bf16 a[168:171], v[96:99], v[148:151], a[168:171]
    s_waitcnt lgkmcnt(8)
    ds_read_b64_tr_b16 v[122:123], v252 offset:11264
    v_accvgpr_read_b32 v66, a66
    v_mfma_f32_16x16x32_bf16 a[200:203], v[96:99], v[152:155], a[200:203]
    s_lshl_b32 s80, s80, 10
    ds_read_b128 v[204:207], v251 offset:38912
    ds_read_b64_tr_b16 v[124:125], v253 offset:10240
    v_mfma_f32_16x16x32_bf16 a[12:15], v[100:103], v[128:131], a[12:15]
    s_add_u32 s80, s80, s46
    ds_read_b64_tr_b16 v[126:127], v253 offset:11264
    v_accvgpr_read_b32 v67, a67
    v_mfma_f32_16x16x32_bf16 a[44:47], v[100:103], v[132:135], a[44:47]
    ds_read_b128 v[208:211], v251 offset:39936
    v_accvgpr_read_b32 v68, a68
    v_mfma_f32_16x16x32_bf16 a[76:79], v[100:103], v[136:139], a[76:79]
    v_accvgpr_read_b32 v69, a69
    v_accvgpr_read_b32 v70, a70
    v_mfma_f32_16x16x32_bf16 a[108:111], v[100:103], v[140:143], a[108:111]
    ds_read_b128 v[212:215], v251 offset:40960
    v_accvgpr_read_b32 v71, a71
    v_mfma_f32_16x16x32_bf16 a[140:143], v[100:103], v[144:147], a[140:143]
    v_cvt_pk_bf16_f32 v88, v64, v65
    v_cvt_pk_bf16_f32 v89, v66, v67
    v_mfma_f32_16x16x32_bf16 a[172:175], v[100:103], v[148:151], a[172:175]
    ds_read_b128 v[216:219], v251 offset:41984
    v_cvt_pk_bf16_f32 v90, v68, v69
    v_mfma_f32_16x16x32_bf16 a[204:207], v[100:103], v[152:155], a[204:207]
    s_waitcnt lgkmcnt(7)
    v_cvt_pk_bf16_f32 v91, v70, v71
    v_mfma_f32_16x16x32_bf16 a[8:11], v[104:107], v[192:195], a[8:11]
    ds_read_b128 v[128:131], v251 offset:43008
    v_mfma_f32_16x16x32_bf16 a[40:43], v[104:107], v[196:199], a[40:43]
    buffer_store_dwordx4 v[88:91], v251, s[28:31], s80 offen sc1
    v_mfma_f32_16x16x32_bf16 a[72:75], v[104:107], v[200:203], a[72:75]
    s_waitcnt lgkmcnt(4)
    ds_read_b128 v[132:135], v251 offset:44032
    v_mfma_f32_16x16x32_bf16 a[104:107], v[104:107], v[204:207], a[104:107]
    s_waitcnt lgkmcnt(4)
    v_mfma_f32_16x16x32_bf16 a[136:139], v[104:107], v[208:211], a[136:139]
    s_waitcnt lgkmcnt(3)
    ds_read_b128 v[136:139], v251 offset:45056
    v_mfma_f32_16x16x32_bf16 a[168:171], v[104:107], v[212:215], a[168:171]
    s_waitcnt lgkmcnt(3)
    s_add_u32 s50, s66, 0
    s_add_u32 m0, s71, 0x2000
    v_mfma_f32_16x16x32_bf16 a[200:203], v[104:107], v[216:219], a[200:203]
    buffer_load_dwordx4 v250, s[24:27], s50 offen lds
    v_mfma_f32_16x16x32_bf16 a[12:15], v[108:111], v[192:195], a[12:15]
    s_add_u32 m0, s71, 0x2400
    ds_read_b128 v[140:143], v251 offset:46080
    v_mfma_f32_16x16x32_bf16 a[44:47], v[108:111], v[196:199], a[44:47]
    buffer_load_dwordx4 v248, s[24:27], s50 offen lds
    v_mfma_f32_16x16x32_bf16 a[76:79], v[108:111], v[200:203], a[76:79]
    s_add_u32 s50, s66, 0x8000
    ds_read_b128 v[144:147], v251 offset:47104
    v_mfma_f32_16x16x32_bf16 a[108:111], v[108:111], v[204:207], a[108:111]
    s_add_u32 m0, s71, 0x2800
    ds_read_b128 v[148:151], v251 offset:48128
    v_mfma_f32_16x16x32_bf16 a[140:143], v[108:111], v[208:211], a[140:143]
    buffer_load_dwordx4 v250, s[24:27], s50 offen lds
    v_mfma_f32_16x16x32_bf16 a[172:175], v[108:111], v[212:215], a[172:175]
    s_add_u32 m0, s71, 0x2c00
    ds_read_b128 v[152:155], v251 offset:49152
    v_mfma_f32_16x16x32_bf16 a[204:207], v[108:111], v[216:219], a[204:207]
    s_waitcnt lgkmcnt(4)
    buffer_load_dwordx4 v248, s[24:27], s50 offen lds
    v_mfma_f32_16x16x32_bf16 a[8:11], v[112:115], v[128:131], a[8:11]
    s_waitcnt vmcnt(19)
    ds_read_b128 v[192:195], v251 offset:50176
    ds_read_b64_tr_b16 v[96:97], v244 offset:0
    v_mfma_f32_16x16x32_bf16 a[40:43], v[112:115], v[132:135], a[40:43]
    s_bfe_u32 s80, s59, 0x4000c
    ds_read_b64_tr_b16 v[98:99], v244 offset:1024
    v_accvgpr_read_b32 v72, a96
    v_mfma_f32_16x16x32_bf16 a[72:75], v[112:115], v[136:139], a[72:75]
    s_waitcnt lgkmcnt(6)
    ds_read_b128 v[196:199], v251 offset:51200
    ds_read_b64_tr_b16 v[100:101], v245 offset:0
    v_mfma_f32_16x16x32_bf16 a[104:107], v[112:115], v[140:143], a[104:107]
    s_waitcnt lgkmcnt(7)
    ds_read_b64_tr_b16 v[102:103], v245 offset:1024
    v_accvgpr_read_b32 v73, a97
    v_mfma_f32_16x16x32_bf16 a[136:139], v[112:115], v[144:147], a[136:139]
    s_waitcnt lgkmcnt(7)
    ds_read_b128 v[200:203], v251 offset:52224
    ds_read_b64_tr_b16 v[104:105], v244 offset:2048
    v_mfma_f32_16x16x32_bf16 a[168:171], v[112:115], v[148:151], a[168:171]
    s_waitcnt lgkmcnt(8)
    ds_read_b64_tr_b16 v[106:107], v244 offset:3072
    v_accvgpr_read_b32 v74, a98
    v_mfma_f32_16x16x32_bf16 a[200:203], v[112:115], v[152:155], a[200:203]
    s_lshl_b32 s80, s80, 10
    ds_read_b128 v[204:207], v251 offset:53248
    ds_read_b64_tr_b16 v[108:109], v245 offset:2048
    v_mfma_f32_16x16x32_bf16 a[12:15], v[116:119], v[128:131], a[12:15]
    s_add_u32 s80, s80, s46
    ds_read_b64_tr_b16 v[110:111], v245 offset:3072
    v_accvgpr_read_b32 v75, a99
    v_mfma_f32_16x16x32_bf16 a[44:47], v[116:119], v[132:135], a[44:47]
    ds_read_b128 v[208:211], v251 offset:54272
    v_accvgpr_read_b32 v76, a100
    v_mfma_f32_16x16x32_bf16 a[76:79], v[116:119], v[136:139], a[76:79]
    v_accvgpr_read_b32 v77, a101
    v_accvgpr_read_b32 v78, a102
    v_mfma_f32_16x16x32_bf16 a[108:111], v[116:119], v[140:143], a[108:111]
    ds_read_b128 v[212:215], v251 offset:55296
    v_accvgpr_read_b32 v79, a103
    v_mfma_f32_16x16x32_bf16 a[140:143], v[116:119], v[144:147], a[140:143]
    v_cvt_pk_bf16_f32 v92, v72, v73
    v_cvt_pk_bf16_f32 v93, v74, v75
    v_mfma_f32_16x16x32_bf16 a[172:175], v[116:119], v[148:151], a[172:175]
    ds_read_b128 v[216:219], v251 offset:56320
    v_cvt_pk_bf16_f32 v94, v76, v77
    v_mfma_f32_16x16x32_bf16 a[204:207], v[116:119], v[152:155], a[204:207]
    s_waitcnt lgkmcnt(7)
    v_cvt_pk_bf16_f32 v95, v78, v79
    v_mfma_f32_16x16x32_bf16 a[8:11], v[120:123], v[192:195], a[8:11]
    ds_read_b128 v[128:131], v254 offset:0
    v_mfma_f32_16x16x32_bf16 a[40:43], v[120:123], v[196:199], a[40:43]
    buffer_store_dwordx4 v[92:95], v251, s[28:31], s80 offen sc1
    v_mfma_f32_16x16x32_bf16 a[72:75], v[120:123], v[200:203], a[72:75]
    s_waitcnt lgkmcnt(4)
    ds_read_b128 v[132:135], v254 offset:1024
    v_mfma_f32_16x16x32_bf16 a[104:107], v[120:123], v[204:207], a[104:107]
    s_waitcnt lgkmcnt(4)
    v_mfma_f32_16x16x32_bf16 a[136:139], v[120:123], v[208:211], a[136:139]
    s_waitcnt lgkmcnt(3)
    ds_read_b128 v[136:139], v254 offset:2048
    v_mfma_f32_16x16x32_bf16 a[168:171], v[120:123], v[212:215], a[168:171]
    s_waitcnt lgkmcnt(3)
    s_add_u32 s50, s66, 0x10000
    s_add_u32 m0, s3, 0
    v_mfma_f32_16x16x32_bf16 a[200:203], v[120:123], v[216:219], a[200:203]
    buffer_load_dwordx4 v250, s[24:27], s50 offen lds
    v_mfma_f32_16x16x32_bf16 a[12:15], v[124:127], v[192:195], a[12:15]
    s_add_u32 m0, s3, 0x400
    ds_read_b128 v[140:143], v254 offset:3072
    v_mfma_f32_16x16x32_bf16 a[44:47], v[124:127], v[196:199], a[44:47]
    buffer_load_dwordx4 v248, s[24:27], s50 offen lds
    v_mfma_f32_16x16x32_bf16 a[76:79], v[124:127], v[200:203], a[76:79]
    s_add_u32 s50, s66, 0x18000
    ds_read_b128 v[144:147], v254 offset:4096
    v_mfma_f32_16x16x32_bf16 a[108:111], v[124:127], v[204:207], a[108:111]
    s_add_u32 m0, s3, 0x800
    ds_read_b128 v[148:151], v254 offset:5120
    v_mfma_f32_16x16x32_bf16 a[140:143], v[124:127], v[208:211], a[140:143]
    buffer_load_dwordx4 v250, s[24:27], s50 offen lds
    v_mfma_f32_16x16x32_bf16 a[172:175], v[124:127], v[212:215], a[172:175]
    s_add_u32 m0, s3, 0xc00
    ds_read_b128 v[152:155], v254 offset:6144
    v_mfma_f32_16x16x32_bf16 a[204:207], v[124:127], v[216:219], a[204:207]
    s_waitcnt lgkmcnt(4)
    buffer_load_dwordx4 v248, s[24:27], s50 offen lds
    v_mfma_f32_16x16x32_bf16 a[8:11], v[96:99], v[128:131], a[8:11]
    s_waitcnt vmcnt(20)
    ds_read_b128 v[192:195], v254 offset:7168
    ds_read_b64_tr_b16 v[112:113], v244 offset:4096
    v_mfma_f32_16x16x32_bf16 a[40:43], v[96:99], v[132:135], a[40:43]
    s_bfe_u32 s80, s59, 0x40010
    ds_read_b64_tr_b16 v[114:115], v244 offset:5120
    v_accvgpr_read_b32 v64, a128
    v_mfma_f32_16x16x32_bf16 a[72:75], v[96:99], v[136:139], a[72:75]
    s_waitcnt lgkmcnt(6)
    ds_read_b128 v[196:199], v254 offset:8192
    ds_read_b64_tr_b16 v[116:117], v245 offset:4096
    v_mfma_f32_16x16x32_bf16 a[104:107], v[96:99], v[140:143], a[104:107]
    s_waitcnt lgkmcnt(7)
    ds_read_b64_tr_b16 v[118:119], v245 offset:5120
    v_accvgpr_read_b32 v65, a129
    v_mfma_f32_16x16x32_bf16 a[136:139], v[96:99], v[144:147], a[136:139]
    s_waitcnt lgkmcnt(7)
    ds_read_b128 v[200:203], v254 offset:9216
    ds_read_b64_tr_b16 v[120:121], v244 offset:6144
    v_mfma_f32_16x16x32_bf16 a[168:171], v[96:99], v[148:151], a[168:171]
    s_waitcnt lgkmcnt(8)
    ds_read_b64_tr_b16 v[122:123], v244 offset:7168
    v_accvgpr_read_b32 v66, a130
    v_mfma_f32_16x16x32_bf16 a[200:203], v[96:99], v[152:155], a[200:203]
    s_lshl_b32 s80, s80, 10
    ds_read_b128 v[204:207], v254 offset:10240
    ds_read_b64_tr_b16 v[124:125], v245 offset:6144
    v_mfma_f32_16x16x32_bf16 a[12:15], v[100:103], v[128:131], a[12:15]
    s_add_u32 s80, s80, s46
    ds_read_b64_tr_b16 v[126:127], v245 offset:7168
    v_accvgpr_read_b32 v67, a131
    v_mfma_f32_16x16x32_bf16 a[44:47], v[100:103], v[132:135], a[44:47]
    ds_read_b128 v[208:211], v254 offset:11264
    v_accvgpr_read_b32 v68, a132
    v_mfma_f32_16x16x32_bf16 a[76:79], v[100:103], v[136:139], a[76:79]
    v_accvgpr_read_b32 v69, a133
    v_accvgpr_read_b32 v70, a134
    v_mfma_f32_16x16x32_bf16 a[108:111], v[100:103], v[140:143], a[108:111]
    ds_read_b128 v[212:215], v254 offset:12288
    v_accvgpr_read_b32 v71, a135
    v_mfma_f32_16x16x32_bf16 a[140:143], v[100:103], v[144:147], a[140:143]
    v_cvt_pk_bf16_f32 v80, v64, v65
    v_cvt_pk_bf16_f32 v81, v66, v67
    v_mfma_f32_16x16x32_bf16 a[172:175], v[100:103], v[148:151], a[172:175]
    ds_read_b128 v[216:219], v254 offset:13312
    v_cvt_pk_bf16_f32 v82, v68, v69
    v_mfma_f32_16x16x32_bf16 a[204:207], v[100:103], v[152:155], a[204:207]
    s_waitcnt lgkmcnt(7)
    v_cvt_pk_bf16_f32 v83, v70, v71
    v_lshrrev_b32 v238, 8, v251
    v_mfma_f32_16x16x32_bf16 a[8:11], v[104:107], v[192:195], a[8:11]
    ds_read_b128 v[128:131], v254 offset:14336
    v_bfe_u32 v239, v251, 6, 2
    v_mfma_f32_16x16x32_bf16 a[40:43], v[104:107], v[196:199], a[40:43]
    buffer_store_dwordx4 v[80:83], v251, s[28:31], s80 offen sc1
    v_mfma_f32_16x16x32_bf16 a[72:75], v[104:107], v[200:203], a[72:75]
    s_waitcnt lgkmcnt(4)
    ds_read_b128 v[132:135], v254 offset:15360
    v_cmp_eq_u32 vcc, v238, v239
    v_mfma_f32_16x16x32_bf16 a[104:107], v[104:107], v[204:207], a[104:107]
    s_waitcnt lgkmcnt(4)
    v_and_b32 v238, 16, v251
    v_mov_b32 v239, 0x3f80
    v_mfma_f32_16x16x32_bf16 a[136:139], v[104:107], v[208:211], a[136:139]
    s_waitcnt lgkmcnt(3)
    ds_read_b128 v[136:139], v254 offset:16384
    v_lshlrev_b32 v239, v238, v239
    v_mfma_f32_16x16x32_bf16 a[168:171], v[104:107], v[212:215], a[168:171]
    s_waitcnt lgkmcnt(3)
    s_add_u32 s50, s66, 0x20000
    s_add_u32 m0, s3, 0x1000
    v_mfma_f32_16x16x32_bf16 a[200:203], v[104:107], v[216:219], a[200:203]
    buffer_load_dwordx4 v250, s[24:27], s50 offen lds
    v_mfma_f32_16x16x32_bf16 a[12:15], v[108:111], v[192:195], a[12:15]
    s_add_u32 m0, s3, 0x1400
    ds_read_b128 v[140:143], v254 offset:17408
    v_cndmask_b32 v239, 0, v239, vcc
    v_mfma_f32_16x16x32_bf16 a[44:47], v[108:111], v[196:199], a[44:47]
    buffer_load_dwordx4 v248, s[24:27], s50 offen lds
    v_mfma_f32_16x16x32_bf16 a[76:79], v[108:111], v[200:203], a[76:79]
    s_add_u32 s50, s66, 0x28000
    ds_read_b128 v[144:147], v254 offset:18432
    v_and_b32 v238, 32, v251
    v_mfma_f32_16x16x32_bf16 a[108:111], v[108:111], v[204:207], a[108:111]
    s_add_u32 m0, s3, 0x1800
    ds_read_b128 v[148:151], v254 offset:19456
    v_cmp_eq_u32 vcc, 0, v238
    v_mfma_f32_16x16x32_bf16 a[140:143], v[108:111], v[208:211], a[140:143]
    buffer_load_dwordx4 v250, s[24:27], s50 offen lds
    v_mfma_f32_16x16x32_bf16 a[172:175], v[108:111], v[212:215], a[172:175]
    s_add_u32 m0, s3, 0x1c00
    ds_read_b128 v[152:155], v254 offset:20480
    v_cndmask_b32 v234, 0, v239, vcc
    v_mfma_f32_16x16x32_bf16 a[204:207], v[108:111], v[216:219], a[204:207]
    s_waitcnt lgkmcnt(4)
    buffer_load_dwordx4 v248, s[24:27], s50 offen lds
    v_mfma_f32_16x16x32_bf16 a[8:11], v[112:115], v[128:131], a[8:11]
    s_waitcnt vmcnt(20)
    ds_read_b64_tr_b16 v[96:97], v252 offset:0
    v_accvgpr_read_b32 v72, a160
    v_mfma_f32_16x16x32_bf16 a[40:43], v[112:115], v[132:135], a[40:43]
    s_bfe_u32 s80, s59, 0x40014
    ds_read_b64_tr_b16 v[98:99], v252 offset:1024
    v_accvgpr_read_b32 v73, a161
    v_mfma_f32_16x16x32_bf16 a[72:75], v[112:115], v[136:139], a[72:75]
    s_waitcnt lgkmcnt(5)
    ds_read_b64_tr_b16 v[100:101], v253 offset:0
    v_accvgpr_read_b32 v74, a162
    v_mfma_f32_16x16x32_bf16 a[104:107], v[112:115], v[140:143], a[104:107]
    s_waitcnt lgkmcnt(5)
    ds_read_b64_tr_b16 v[102:103], v253 offset:1024
    v_accvgpr_read_b32 v75, a163
    v_mfma_f32_16x16x32_bf16 a[136:139], v[112:115], v[144:147], a[136:139]
    s_waitcnt lgkmcnt(5)
    ds_read_b64_tr_b16 v[104:105], v252 offset:2048
    v_accvgpr_read_b32 v76, a164
    v_mfma_f32_16x16x32_bf16 a[168:171], v[112:115], v[148:151], a[168:171]
    s_waitcnt lgkmcnt(5)
    ds_read_b64_tr_b16 v[106:107], v252 offset:3072
    v_accvgpr_read_b32 v77, a165
    v_mfma_f32_16x16x32_bf16 a[200:203], v[112:115], v[152:155], a[200:203]
    s_lshl_b32 s80, s80, 10
    ds_read_b64_tr_b16 v[108:109], v253 offset:2048
    v_accvgpr_read_b32 v78, a166
    v_mfma_f32_16x16x32_bf16 a[12:15], v[116:119], v[128:131], a[12:15]
    s_add_u32 s80, s80, s46
    ds_read_b64_tr_b16 v[110:111], v253 offset:3072
    v_accvgpr_read_b32 v79, a167
    v_mfma_f32_16x16x32_bf16 a[44:47], v[116:119], v[132:135], a[44:47]
    v_cvt_pk_bf16_f32 v84, v72, v73
    v_cvt_pk_bf16_f32 v85, v74, v75
    v_mfma_f32_16x16x32_bf16 a[76:79], v[116:119], v[136:139], a[76:79]
    v_cvt_pk_bf16_f32 v86, v76, v77
    v_cvt_pk_bf16_f32 v87, v78, v79
    v_mfma_f32_16x16x32_bf16 a[108:111], v[116:119], v[140:143], a[108:111]
    buffer_store_dwordx4 v[84:87], v251, s[28:31], s80 offen sc1
    v_mfma_f32_16x16x32_bf16 a[140:143], v[116:119], v[144:147], a[140:143]
    v_cndmask_b32 v235, v239, 0, vcc
    v_mov_b32 v232, 0
    v_mfma_f32_16x16x32_bf16 a[172:175], v[116:119], v[148:151], a[172:175]
    v_mov_b32 v233, 0
    v_mov_b32 v236, 0
    v_mfma_f32_16x16x32_bf16 a[204:207], v[116:119], v[152:155], a[204:207]
    v_mov_b32 v237, 0
    v_mfma_f32_16x16x32_bf16 a[8:11], v[120:123], a[16:19], a[8:11]
    v_mfma_f32_16x16x32_bf16 a[40:43], v[120:123], a[48:51], a[40:43]
    v_mfma_f32_16x16x32_bf16 a[72:75], v[120:123], a[80:83], a[72:75]
    v_mfma_f32_16x16x32_bf16 a[104:107], v[120:123], a[112:115], a[104:107]
    s_add_u32 s50, s66, 0x30000
    v_mfma_f32_16x16x32_bf16 a[136:139], v[120:123], a[144:147], a[136:139]
    s_add_u32 m0, s71, 0
    v_mfma_f32_16x16x32_bf16 a[168:171], v[120:123], a[176:179], a[168:171]
    s_waitcnt lgkmcnt(0)
    buffer_load_dwordx4 v250, s[24:27], s50 offen lds
    v_mfma_f32_16x16x32_bf16 a[200:203], v[120:123], a[208:211], a[200:203]
    s_add_u32 m0, s71, 0x400
    v_mfma_f32_16x16x32_bf16 a[12:15], v[124:127], a[16:19], a[12:15]
    buffer_load_dwordx4 v248, s[24:27], s50 offen lds
    v_mfma_f32_16x16x32_bf16 a[44:47], v[124:127], a[48:51], a[44:47]
    s_add_u32 s50, s66, 0x38000
    v_mfma_f32_16x16x32_bf16 a[76:79], v[124:127], a[80:83], a[76:79]
    s_add_u32 m0, s71, 0x800
    v_mfma_f32_16x16x32_bf16 a[108:111], v[124:127], a[112:115], a[108:111]
    buffer_load_dwordx4 v250, s[24:27], s50 offen lds
    v_mfma_f32_16x16x32_bf16 a[140:143], v[124:127], a[144:147], a[140:143]
    s_add_u32 m0, s71, 0xc00
    v_mfma_f32_16x16x32_bf16 a[172:175], v[124:127], a[176:179], a[172:175]
    buffer_load_dwordx4 v248, s[24:27], s50 offen lds
    v_mfma_f32_16x16x32_bf16 a[204:207], v[124:127], a[208:211], a[204:207]
    v_mfma_f32_16x16x32_bf16 a[8:11], v[96:99], a[20:23], a[8:11]
    s_waitcnt vmcnt(20)
    ds_read_b64_tr_b16 v[112:113], v252 offset:4096
    v_accvgpr_read_b32 v64, a192
    v_mfma_f32_16x16x32_bf16 a[40:43], v[96:99], a[52:55], a[40:43]
    s_bfe_u32 s80, s59, 0x40018
    ds_read_b64_tr_b16 v[114:115], v252 offset:5120
    v_accvgpr_read_b32 v65, a193
    v_mfma_f32_16x16x32_bf16 a[72:75], v[96:99], a[84:87], a[72:75]
    s_lshl_b32 s80, s80, 10
    ds_read_b64_tr_b16 v[116:117], v253 offset:4096
    v_accvgpr_read_b32 v66, a194
    v_mfma_f32_16x16x32_bf16 a[104:107], v[96:99], a[116:119], a[104:107]
    s_add_u32 s80, s80, s46
    ds_read_b64_tr_b16 v[118:119], v253 offset:5120
    v_accvgpr_read_b32 v67, a195
    v_mfma_f32_16x16x32_bf16 a[136:139], v[96:99], a[148:151], a[136:139]
    s_mul_i32 s46, s65, 896
    ds_read_b64_tr_b16 v[120:121], v252 offset:6144
    v_accvgpr_read_b32 v68, a196
    v_mfma_f32_16x16x32_bf16 a[168:171], v[96:99], a[180:183], a[168:171]
    s_add_u32 s46, s46, 0xe000
    ds_read_b64_tr_b16 v[122:123], v252 offset:7168
    v_accvgpr_read_b32 v69, a197
    v_mfma_f32_16x16x32_bf16 a[200:203], v[96:99], a[212:215], a[200:203]
    ds_read_b64_tr_b16 v[124:125], v253 offset:6144
    v_accvgpr_read_b32 v70, a198
    v_mfma_f32_16x16x32_bf16 a[12:15], v[100:103], a[20:23], a[12:15]
    ds_read_b64_tr_b16 v[126:127], v253 offset:7168
    v_accvgpr_read_b32 v71, a199
    v_mfma_f32_16x16x32_bf16 a[44:47], v[100:103], a[52:55], a[44:47]
    v_cvt_pk_bf16_f32 v88, v64, v65
    v_cvt_pk_bf16_f32 v89, v66, v67
    v_mfma_f32_16x16x32_bf16 a[76:79], v[100:103], a[84:87], a[76:79]
    v_cvt_pk_bf16_f32 v90, v68, v69
    v_cvt_pk_bf16_f32 v91, v70, v71
    v_mfma_f32_16x16x32_bf16 a[108:111], v[100:103], a[116:119], a[108:111]
    buffer_store_dwordx4 v[88:91], v251, s[28:31], s80 offen sc1
    v_mfma_f32_16x16x32_bf16 a[140:143], v[100:103], a[148:151], a[140:143]
    v_mfma_f32_16x16x32_bf16 a[172:175], v[100:103], a[180:183], a[172:175]
    v_mfma_f32_16x16x32_bf16 a[204:207], v[100:103], a[212:215], a[204:207]
    v_mfma_f32_16x16x32_bf16 a[8:11], v[104:107], a[24:27], a[8:11]
    v_mfma_f32_16x16x32_bf16 a[40:43], v[104:107], a[56:59], a[40:43]
    v_mfma_f32_16x16x32_bf16 a[72:75], v[104:107], a[88:91], a[72:75]
    v_mfma_f32_16x16x32_bf16 a[104:107], v[104:107], a[120:123], a[104:107]
    s_add_u32 s50, s66, 0x40000
    v_mfma_f32_16x16x32_bf16 a[136:139], v[104:107], a[152:155], a[136:139]
    s_add_u32 m0, s71, 0x1000
    v_mfma_f32_16x16x32_bf16 a[168:171], v[104:107], a[184:187], a[168:171]
    s_waitcnt lgkmcnt(0)
    buffer_load_dwordx4 v250, s[24:27], s50 offen lds
    v_mfma_f32_16x16x32_bf16 a[200:203], v[104:107], a[216:219], a[200:203]
    s_add_u32 m0, s71, 0x1400
    v_mfma_f32_16x16x32_bf16 a[12:15], v[108:111], a[24:27], a[12:15]
    buffer_load_dwordx4 v248, s[24:27], s50 offen lds
    v_mfma_f32_16x16x32_bf16 a[44:47], v[108:111], a[56:59], a[44:47]
    s_add_u32 s50, s66, 0x48000
    v_mfma_f32_16x16x32_bf16 a[76:79], v[108:111], a[88:91], a[76:79]
    s_add_u32 m0, s71, 0x1800
    v_mfma_f32_16x16x32_bf16 a[108:111], v[108:111], a[120:123], a[108:111]
    buffer_load_dwordx4 v250, s[24:27], s50 offen lds
    v_mfma_f32_16x16x32_bf16 a[140:143], v[108:111], a[152:155], a[140:143]
    s_add_u32 m0, s71, 0x1c00
    v_mfma_f32_16x16x32_bf16 a[172:175], v[108:111], a[184:187], a[172:175]
    buffer_load_dwordx4 v248, s[24:27], s50 offen lds
    v_mfma_f32_16x16x32_bf16 a[204:207], v[108:111], a[216:219], a[204:207]
    v_mfma_f32_16x16x32_bf16 a[8:11], v[112:115], a[28:31], a[8:11]
    s_waitcnt vmcnt(20)
    ds_read_b64_tr_b16 v[96:97], v252 offset:8192
    v_mfma_f32_16x16x32_bf16 a[40:43], v[112:115], a[60:63], a[40:43]
    ds_read_b64_tr_b16 v[98:99], v252 offset:9216
    v_mfma_f32_16x16x32_bf16 a[72:75], v[112:115], a[92:95], a[72:75]
    ds_read_b64_tr_b16 v[100:101], v253 offset:8192
    v_mfma_f32_16x16x32_bf16 a[104:107], v[112:115], a[124:127], a[104:107]
    ds_read_b64_tr_b16 v[102:103], v253 offset:9216
    v_mfma_f32_16x16x32_bf16 a[136:139], v[112:115], a[156:159], a[136:139]
    ds_read_b64_tr_b16 v[104:105], v252 offset:10240
    v_mfma_f32_16x16x32_bf16 a[168:171], v[112:115], a[188:191], a[168:171]
    ds_read_b64_tr_b16 v[106:107], v252 offset:11264
    v_mfma_f32_16x16x32_bf16 a[200:203], v[112:115], a[220:223], a[200:203]
    ds_read_b64_tr_b16 v[108:109], v253 offset:10240
    v_mfma_f32_16x16x32_bf16 a[12:15], v[116:119], a[28:31], a[12:15]
    ds_read_b64_tr_b16 v[110:111], v253 offset:11264
    v_mfma_f32_16x16x32_bf16 a[44:47], v[116:119], a[60:63], a[44:47]
    v_mfma_f32_16x16x32_bf16 a[76:79], v[116:119], a[92:95], a[76:79]
    v_mfma_f32_16x16x32_bf16 a[108:111], v[116:119], a[124:127], a[108:111]
    v_mfma_f32_16x16x32_bf16 a[140:143], v[116:119], a[156:159], a[140:143]
    v_mfma_f32_16x16x32_bf16 a[172:175], v[116:119], a[188:191], a[172:175]
    v_mfma_f32_16x16x32_bf16 a[204:207], v[116:119], a[220:223], a[204:207]
    v_mfma_f32_16x16x32_bf16 a[8:11], v[120:123], a[224:227], a[8:11]
    v_mfma_f32_16x16x32_bf16 a[40:43], v[120:123], a[228:231], a[40:43]
    v_mfma_f32_16x16x32_bf16 a[72:75], v[120:123], a[232:235], a[72:75]
    v_mfma_f32_16x16x32_bf16 a[104:107], v[120:123], a[236:239], a[104:107]
    s_add_u32 s50, s66, 0x50000
    v_mfma_f32_16x16x32_bf16 a[136:139], v[120:123], a[240:243], a[136:139]
    s_add_u32 m0, s71, 0x2000
    v_mfma_f32_16x16x32_bf16 a[168:171], v[120:123], a[244:247], a[168:171]
    s_waitcnt lgkmcnt(0)
    buffer_load_dwordx4 v250, s[24:27], s50 offen lds
    v_mfma_f32_16x16x32_bf16 a[200:203], v[120:123], a[248:251], a[200:203]
    s_add_u32 m0, s71, 0x2400
    v_mfma_f32_16x16x32_bf16 a[12:15], v[124:127], a[224:227], a[12:15]
    buffer_load_dwordx4 v248, s[24:27], s50 offen lds
    v_mfma_f32_16x16x32_bf16 a[44:47], v[124:127], a[228:231], a[44:47]
    s_add_u32 s50, s66, 0x58000
    v_mfma_f32_16x16x32_bf16 a[76:79], v[124:127], a[232:235], a[76:79]
    s_add_u32 m0, s71, 0x2800
    v_mfma_f32_16x16x32_bf16 a[108:111], v[124:127], a[236:239], a[108:111]
    buffer_load_dwordx4 v250, s[24:27], s50 offen lds
    v_mfma_f32_16x16x32_bf16 a[140:143], v[124:127], a[240:243], a[140:143]
    s_add_u32 m0, s71, 0x2c00
    v_mfma_f32_16x16x32_bf16 a[172:175], v[124:127], a[244:247], a[172:175]
    buffer_load_dwordx4 v248, s[24:27], s50 offen lds
    v_mfma_f32_16x16x32_bf16 a[204:207], v[124:127], a[248:251], a[204:207]
    v_mfma_f32_16x16x32_bf16 a[0:3], v[96:99], v[156:159], 0
    s_waitcnt vmcnt(19)
    ds_read_b64_tr_b16 v[112:113], v244 offset:0
    v_accvgpr_read_b32 v72, a8
    v_mfma_f32_16x16x32_bf16 a[32:35], v[96:99], v[228:231], 0
    s_bfe_u32 s80, s59, 0x40000
    ds_read_b64_tr_b16 v[114:115], v244 offset:1024
    v_accvgpr_read_b32 v73, a9
    v_mfma_f32_16x16x32_bf16 a[64:67], v[96:99], v[224:227], 0
    s_lshl_b32 s80, s80, 10
    ds_read_b64_tr_b16 v[116:117], v245 offset:0
    v_accvgpr_read_b32 v74, a10
    v_mfma_f32_16x16x32_bf16 a[96:99], v[96:99], v[220:223], 0
    s_add_u32 s80, s80, s46
    ds_read_b64_tr_b16 v[118:119], v245 offset:1024
    v_accvgpr_read_b32 v75, a11
    v_mfma_f32_16x16x32_bf16 a[128:131], v[96:99], v[188:191], 0
    ds_read_b64_tr_b16 v[120:121], v244 offset:2048
    v_accvgpr_read_b32 v76, a12
    v_mfma_f32_16x16x32_bf16 a[160:163], v[96:99], v[184:187], 0
    ds_read_b64_tr_b16 v[122:123], v244 offset:3072
    v_accvgpr_read_b32 v77, a13
    v_mfma_f32_16x16x32_bf16 a[192:195], v[96:99], v[180:183], 0
    ds_read_b64_tr_b16 v[124:125], v245 offset:2048
    v_accvgpr_read_b32 v78, a14
    v_mfma_f32_16x16x32_bf16 a[4:7], v[100:103], v[156:159], 0
    ds_read_b64_tr_b16 v[126:127], v245 offset:3072
    v_accvgpr_read_b32 v79, a15
    v_mfma_f32_16x16x32_bf16 a[36:39], v[100:103], v[228:231], 0
    v_cvt_pk_bf16_f32 v92, v72, v73
    v_cvt_pk_bf16_f32 v93, v74, v75
    v_mfma_f32_16x16x32_bf16 a[68:71], v[100:103], v[224:227], 0
    v_cvt_pk_bf16_f32 v94, v76, v77
    v_cvt_pk_bf16_f32 v95, v78, v79
    v_mfma_f32_16x16x32_bf16 a[100:103], v[100:103], v[220:223], 0
    buffer_store_dwordx4 v[92:95], v251, s[28:31], s80 offen sc1
    v_mfma_f32_16x16x32_bf16 a[132:135], v[100:103], v[188:191], 0
    v_mfma_f32_16x16x32_bf16 a[164:167], v[100:103], v[184:187], 0
    v_mfma_f32_16x16x32_bf16 a[196:199], v[100:103], v[180:183], 0
    v_mfma_f32_16x16x32_bf16 a[0:3], v[104:107], v[176:179], a[0:3]
    v_mfma_f32_16x16x32_bf16 a[32:35], v[104:107], v[172:175], a[32:35]
    v_mfma_f32_16x16x32_bf16 a[64:67], v[104:107], v[168:171], a[64:67]
    v_mfma_f32_16x16x32_bf16 a[96:99], v[104:107], v[164:167], a[96:99]
    s_add_u32 s50, s66, 0x60000
    v_mfma_f32_16x16x32_bf16 a[128:131], v[104:107], v[160:163], a[128:131]
    s_add_u32 m0, s3, 0
    v_mfma_f32_16x16x32_bf16 a[160:163], v[104:107], v[60:63], a[160:163]
    s_waitcnt lgkmcnt(0)
    buffer_load_dwordx4 v250, s[24:27], s50 offen lds
    v_mfma_f32_16x16x32_bf16 a[192:195], v[104:107], v[56:59], a[192:195]
    s_add_u32 m0, s3, 0x400
    v_mfma_f32_16x16x32_bf16 a[4:7], v[108:111], v[176:179], a[4:7]
    buffer_load_dwordx4 v248, s[24:27], s50 offen lds
    v_mfma_f32_16x16x32_bf16 a[36:39], v[108:111], v[172:175], a[36:39]
    s_add_u32 s50, s66, 0x68000
    v_mfma_f32_16x16x32_bf16 a[68:71], v[108:111], v[168:171], a[68:71]
    s_add_u32 m0, s3, 0x800
    v_mfma_f32_16x16x32_bf16 a[100:103], v[108:111], v[164:167], a[100:103]
    buffer_load_dwordx4 v250, s[24:27], s50 offen lds
    v_mfma_f32_16x16x32_bf16 a[132:135], v[108:111], v[160:163], a[132:135]
    s_add_u32 m0, s3, 0xc00
    v_mfma_f32_16x16x32_bf16 a[164:167], v[108:111], v[60:63], a[164:167]
    buffer_load_dwordx4 v248, s[24:27], s50 offen lds
    v_mfma_f32_16x16x32_bf16 a[196:199], v[108:111], v[56:59], a[196:199]
    v_mfma_f32_16x16x32_bf16 a[0:3], v[112:115], v[52:55], a[0:3]
    s_waitcnt vmcnt(19)
    ds_read_b64_tr_b16 v[96:97], v244 offset:4096
    v_accvgpr_read_b32 v64, a40
    v_mfma_f32_16x16x32_bf16 a[32:35], v[112:115], v[48:51], a[32:35]
    s_bfe_u32 s80, s59, 0x40004
    ds_read_b64_tr_b16 v[98:99], v244 offset:5120
    v_accvgpr_read_b32 v65, a41
    v_mfma_f32_16x16x32_bf16 a[64:67], v[112:115], v[44:47], a[64:67]
    s_lshl_b32 s80, s80, 10
    ds_read_b64_tr_b16 v[100:101], v245 offset:4096
    v_accvgpr_read_b32 v66, a42
    v_mfma_f32_16x16x32_bf16 a[96:99], v[112:115], v[40:43], a[96:99]
    s_add_u32 s80, s80, s46
    ds_read_b64_tr_b16 v[102:103], v245 offset:5120
    v_accvgpr_read_b32 v67, a43
    v_mfma_f32_16x16x32_bf16 a[128:131], v[112:115], v[36:39], a[128:131]
    ds_read_b64_tr_b16 v[104:105], v244 offset:6144
    v_accvgpr_read_b32 v68, a44
    v_mfma_f32_16x16x32_bf16 a[160:163], v[112:115], v[32:35], a[160:163]
    ds_read_b64_tr_b16 v[106:107], v244 offset:7168
    v_accvgpr_read_b32 v69, a45
    v_mfma_f32_16x16x32_bf16 a[192:195], v[112:115], v[28:31], a[192:195]
    ds_read_b64_tr_b16 v[108:109], v245 offset:6144
    v_accvgpr_read_b32 v70, a46
    v_mfma_f32_16x16x32_bf16 a[4:7], v[116:119], v[52:55], a[4:7]
    ds_read_b64_tr_b16 v[110:111], v245 offset:7168
    v_accvgpr_read_b32 v71, a47
    v_mfma_f32_16x16x32_bf16 a[36:39], v[116:119], v[48:51], a[36:39]
    v_cvt_pk_bf16_f32 v80, v64, v65
    v_cvt_pk_bf16_f32 v81, v66, v67
    v_mfma_f32_16x16x32_bf16 a[68:71], v[116:119], v[44:47], a[68:71]
    v_cvt_pk_bf16_f32 v82, v68, v69
    v_cvt_pk_bf16_f32 v83, v70, v71
    v_mfma_f32_16x16x32_bf16 a[100:103], v[116:119], v[40:43], a[100:103]
    buffer_store_dwordx4 v[80:83], v251, s[28:31], s80 offen sc1
    v_mfma_f32_16x16x32_bf16 a[132:135], v[116:119], v[36:39], a[132:135]
    v_mfma_f32_16x16x32_bf16 a[164:167], v[116:119], v[32:35], a[164:167]
    v_mfma_f32_16x16x32_bf16 a[196:199], v[116:119], v[28:31], a[196:199]
    v_mfma_f32_16x16x32_bf16 a[0:3], v[120:123], v[24:27], a[0:3]
    ds_read_b128 v[192:195], v251 offset:28672
    v_mfma_f32_16x16x32_bf16 a[32:35], v[120:123], v[20:23], a[32:35]
    v_mfma_f32_16x16x32_bf16 a[64:67], v[120:123], v[16:19], a[64:67]
    ds_read_b128 v[196:199], v251 offset:29696
    v_mfma_f32_16x16x32_bf16 a[96:99], v[120:123], v[12:15], a[96:99]
    s_add_u32 s50, s66, 0x70000
    v_mfma_f32_16x16x32_bf16 a[128:131], v[120:123], v[8:11], a[128:131]
    s_add_u32 m0, s3, 0x1000
    ds_read_b128 v[200:203], v251 offset:30720
    v_mfma_f32_16x16x32_bf16 a[160:163], v[120:123], v[4:7], a[160:163]
    s_waitcnt lgkmcnt(3)
    buffer_load_dwordx4 v250, s[24:27], s50 offen lds
    v_mfma_f32_16x16x32_bf16 a[192:195], v[120:123], v[0:3], a[192:195]
    s_add_u32 m0, s3, 0x1400
    ds_read_b128 v[204:207], v251 offset:31744
    v_mfma_f32_16x16x32_bf16 a[4:7], v[124:127], v[24:27], a[4:7]
    buffer_load_dwordx4 v248, s[24:27], s50 offen lds
    v_mfma_f32_16x16x32_bf16 a[36:39], v[124:127], v[20:23], a[36:39]
    s_add_u32 s50, s66, 0x78000
    ds_read_b128 v[208:211], v251 offset:32768
    v_mfma_f32_16x16x32_bf16 a[68:71], v[124:127], v[16:19], a[68:71]
    s_add_u32 m0, s3, 0x1800
    v_mfma_f32_16x16x32_bf16 a[100:103], v[124:127], v[12:15], a[100:103]
    buffer_load_dwordx4 v250, s[24:27], s50 offen lds
    v_mfma_f32_16x16x32_bf16 a[132:135], v[124:127], v[8:11], a[132:135]
    s_add_u32 m0, s3, 0x1c00
    ds_read_b128 v[212:215], v251 offset:33792
    v_mfma_f32_16x16x32_bf16 a[164:167], v[124:127], v[4:7], a[164:167]
    ds_read_b128 v[216:219], v251 offset:34816
    v_mfma_f32_16x16x32_bf16 a[196:199], v[124:127], v[0:3], a[196:199]
    s_waitcnt lgkmcnt(4)
    buffer_load_dwordx4 v248, s[24:27], s50 offen lds
    v_mfma_f32_16x16x32_bf16 a[0:3], v[96:99], v[192:195], a[0:3]
    s_waitcnt vmcnt(19)
    ds_read_b128 v[128:131], v251 offset:35840
    ds_read_b64_tr_b16 v[112:113], v252 offset:0
    v_mfma_f32_16x16x32_bf16 a[32:35], v[96:99], v[196:199], a[32:35]
    s_bfe_u32 s80, s59, 0x40008
    ds_read_b64_tr_b16 v[114:115], v252 offset:1024
    v_accvgpr_read_b32 v72, a72
    v_mfma_f32_16x16x32_bf16 a[64:67], v[96:99], v[200:203], a[64:67]
    s_waitcnt lgkmcnt(6)
    ds_read_b128 v[132:135], v251 offset:36864
    ds_read_b64_tr_b16 v[116:117], v253 offset:0
    v_mfma_f32_16x16x32_bf16 a[96:99], v[96:99], v[204:207], a[96:99]
    s_waitcnt lgkmcnt(7)
    ds_read_b64_tr_b16 v[118:119], v253 offset:1024
    v_accvgpr_read_b32 v73, a73
    v_mfma_f32_16x16x32_bf16 a[128:131], v[96:99], v[208:211], a[128:131]
    s_waitcnt lgkmcnt(7)
    ds_read_b128 v[136:139], v251 offset:37888
    ds_read_b64_tr_b16 v[120:121], v252 offset:2048
    v_mfma_f32_16x16x32_bf16 a[160:163], v[96:99], v[212:215], a[160:163]
    s_waitcnt lgkmcnt(8)
    ds_read_b64_tr_b16 v[122:123], v252 offset:3072
    v_accvgpr_read_b32 v74, a74
    v_mfma_f32_16x16x32_bf16 a[192:195], v[96:99], v[216:219], a[192:195]
    s_lshl_b32 s80, s80, 10
    ds_read_b128 v[140:143], v251 offset:38912
    ds_read_b64_tr_b16 v[124:125], v253 offset:2048
    v_mfma_f32_16x16x32_bf16 a[4:7], v[100:103], v[192:195], a[4:7]
    s_add_u32 s80, s80, s46
    ds_read_b64_tr_b16 v[126:127], v253 offset:3072
    v_accvgpr_read_b32 v75, a75
    v_mfma_f32_16x16x32_bf16 a[36:39], v[100:103], v[196:199], a[36:39]
    ds_read_b128 v[144:147], v251 offset:39936
    v_accvgpr_read_b32 v76, a76
    v_mfma_f32_16x16x32_bf16 a[68:71], v[100:103], v[200:203], a[68:71]
    v_accvgpr_read_b32 v77, a77
    v_accvgpr_read_b32 v78, a78
    v_mfma_f32_16x16x32_bf16 a[100:103], v[100:103], v[204:207], a[100:103]
    ds_read_b128 v[148:151], v251 offset:40960
    v_accvgpr_read_b32 v79, a79
    v_mfma_f32_16x16x32_bf16 a[132:135], v[100:103], v[208:211], a[132:135]
    v_cvt_pk_bf16_f32 v84, v72, v73
    v_cvt_pk_bf16_f32 v85, v74, v75
    v_mfma_f32_16x16x32_bf16 a[164:167], v[100:103], v[212:215], a[164:167]
    ds_read_b128 v[152:155], v251 offset:41984
    v_cvt_pk_bf16_f32 v86, v76, v77
    v_mfma_f32_16x16x32_bf16 a[196:199], v[100:103], v[216:219], a[196:199]
    s_waitcnt lgkmcnt(7)
    v_cvt_pk_bf16_f32 v87, v78, v79
    v_mfma_f32_16x16x32_bf16 a[0:3], v[104:107], v[128:131], a[0:3]
    s_lshl_b32 s42, s64, 4
    ds_read_b128 v[192:195], v251 offset:43008
    v_mfma_f32_16x16x32_bf16 a[32:35], v[104:107], v[132:135], a[32:35]
    s_lshl3_add_u32 s42, s70, s42
    v_mfma_f32_16x16x32_bf16 a[64:67], v[104:107], v[136:139], a[64:67]
    s_waitcnt vmcnt(18) lgkmcnt(4)
    buffer_store_dwordx2 v[240:241], off, s[20:23], s42 sc1
    v_mfma_f32_16x16x32_bf16 a[96:99], v[104:107], v[140:143], a[96:99]
    s_waitcnt lgkmcnt(3)
    ds_read_b128 v[196:199], v251 offset:44032
    v_mfma_f32_16x16x32_bf16 a[128:131], v[104:107], v[144:147], a[128:131]
    s_waitcnt lgkmcnt(3)
    ds_read_b128 v[200:203], v251 offset:45056
    v_mfma_f32_16x16x32_bf16 a[160:163], v[104:107], v[148:151], a[160:163]
    s_waitcnt lgkmcnt(3)
    s_add_u32 s50, s67, 0
    s_add_u32 m0, s71, 0
    v_mfma_f32_16x16x32_bf16 a[192:195], v[104:107], v[152:155], a[192:195]
    buffer_load_dwordx4 v250, s[24:27], s50 offen lds
    v_mfma_f32_16x16x32_bf16 a[4:7], v[108:111], v[128:131], a[4:7]
    s_add_u32 m0, s71, 0x400
    ds_read_b128 v[204:207], v251 offset:46080
    v_mfma_f32_16x16x32_bf16 a[36:39], v[108:111], v[132:135], a[36:39]
    buffer_load_dwordx4 v248, s[24:27], s50 offen lds
    v_mfma_f32_16x16x32_bf16 a[68:71], v[108:111], v[136:139], a[68:71]
    s_add_u32 s50, s67, 0x8000
    ds_read_b128 v[208:211], v251 offset:47104
    v_mfma_f32_16x16x32_bf16 a[100:103], v[108:111], v[140:143], a[100:103]
    s_add_u32 m0, s71, 0x800
    ds_read_b128 v[212:215], v251 offset:48128
    v_mfma_f32_16x16x32_bf16 a[132:135], v[108:111], v[144:147], a[132:135]
    buffer_load_dwordx4 v250, s[24:27], s50 offen lds
    v_mfma_f32_16x16x32_bf16 a[164:167], v[108:111], v[148:151], a[164:167]
    s_add_u32 m0, s71, 0xc00
    ds_read_b128 v[216:219], v251 offset:49152
    v_mfma_f32_16x16x32_bf16 a[196:199], v[108:111], v[152:155], a[196:199]
    s_waitcnt lgkmcnt(4)
    buffer_load_dwordx4 v248, s[24:27], s50 offen lds
    buffer_store_dwordx4 v[84:87], v251, s[28:31], s80 offen sc1
    v_mfma_f32_16x16x32_bf16 a[0:3], v[112:115], v[192:195], a[0:3]
    s_waitcnt vmcnt(20)
    ds_read_b128 v[128:131], v251 offset:50176
    ds_read_b64_tr_b16 v[96:97], v252 offset:4096
    v_mfma_f32_16x16x32_bf16 a[32:35], v[112:115], v[196:199], a[32:35]
    s_bfe_u32 s80, s59, 0x4000c
    ds_read_b64_tr_b16 v[98:99], v252 offset:5120
    v_accvgpr_read_b32 v64, a104
    v_mfma_f32_16x16x32_bf16 a[64:67], v[112:115], v[200:203], a[64:67]
    s_waitcnt lgkmcnt(6)
    ds_read_b128 v[132:135], v251 offset:51200
    ds_read_b64_tr_b16 v[100:101], v253 offset:4096
    v_mfma_f32_16x16x32_bf16 a[96:99], v[112:115], v[204:207], a[96:99]
    s_waitcnt lgkmcnt(7)
    ds_read_b64_tr_b16 v[102:103], v253 offset:5120
    v_accvgpr_read_b32 v65, a105
    v_mfma_f32_16x16x32_bf16 a[128:131], v[112:115], v[208:211], a[128:131]
    s_waitcnt lgkmcnt(7)
    ds_read_b128 v[136:139], v251 offset:52224
    ds_read_b64_tr_b16 v[104:105], v252 offset:6144
    v_mfma_f32_16x16x32_bf16 a[160:163], v[112:115], v[212:215], a[160:163]
    s_waitcnt lgkmcnt(8)
    ds_read_b64_tr_b16 v[106:107], v252 offset:7168
    v_accvgpr_read_b32 v66, a106
    v_mfma_f32_16x16x32_bf16 a[192:195], v[112:115], v[216:219], a[192:195]
    s_lshl_b32 s80, s80, 10
    ds_read_b128 v[140:143], v251 offset:53248
    ds_read_b64_tr_b16 v[108:109], v253 offset:6144
    v_mfma_f32_16x16x32_bf16 a[4:7], v[116:119], v[192:195], a[4:7]
    s_add_u32 s80, s80, s46
    ds_read_b64_tr_b16 v[110:111], v253 offset:7168
    v_accvgpr_read_b32 v67, a107
    v_mfma_f32_16x16x32_bf16 a[36:39], v[116:119], v[196:199], a[36:39]
    ds_read_b128 v[144:147], v251 offset:54272
    v_accvgpr_read_b32 v68, a108
    v_mfma_f32_16x16x32_bf16 a[68:71], v[116:119], v[200:203], a[68:71]
    v_accvgpr_read_b32 v69, a109
    v_accvgpr_read_b32 v70, a110
    v_mfma_f32_16x16x32_bf16 a[100:103], v[116:119], v[204:207], a[100:103]
    ds_read_b128 v[148:151], v251 offset:55296
    v_accvgpr_read_b32 v71, a111
    v_mfma_f32_16x16x32_bf16 a[132:135], v[116:119], v[208:211], a[132:135]
    v_cvt_pk_bf16_f32 v88, v64, v65
    v_cvt_pk_bf16_f32 v89, v66, v67
    v_mfma_f32_16x16x32_bf16 a[164:167], v[116:119], v[212:215], a[164:167]
    ds_read_b128 v[152:155], v251 offset:56320
    v_cvt_pk_bf16_f32 v90, v68, v69
    v_mfma_f32_16x16x32_bf16 a[196:199], v[116:119], v[216:219], a[196:199]
    s_waitcnt lgkmcnt(7)
    v_cvt_pk_bf16_f32 v91, v70, v71
    v_mfma_f32_16x16x32_bf16 a[0:3], v[120:123], v[128:131], a[0:3]
    ds_read_b128 v[192:195], v254 offset:0
    v_mfma_f32_16x16x32_bf16 a[32:35], v[120:123], v[132:135], a[32:35]
    buffer_store_dwordx4 v[88:91], v251, s[28:31], s80 offen sc1
    v_mfma_f32_16x16x32_bf16 a[64:67], v[120:123], v[136:139], a[64:67]
    s_waitcnt lgkmcnt(4)
    ds_read_b128 v[196:199], v254 offset:1024
    v_mfma_f32_16x16x32_bf16 a[96:99], v[120:123], v[140:143], a[96:99]
    s_waitcnt lgkmcnt(4)
    v_mfma_f32_16x16x32_bf16 a[128:131], v[120:123], v[144:147], a[128:131]
    s_waitcnt lgkmcnt(3)
    ds_read_b128 v[200:203], v254 offset:2048
    v_mfma_f32_16x16x32_bf16 a[160:163], v[120:123], v[148:151], a[160:163]
    s_waitcnt lgkmcnt(3)
    s_add_u32 s50, s67, 0x10000
    s_add_u32 m0, s71, 0x1000
    v_mfma_f32_16x16x32_bf16 a[192:195], v[120:123], v[152:155], a[192:195]
    buffer_load_dwordx4 v250, s[24:27], s50 offen lds
    v_mfma_f32_16x16x32_bf16 a[4:7], v[124:127], v[128:131], a[4:7]
    s_add_u32 m0, s71, 0x1400
    ds_read_b128 v[204:207], v254 offset:3072
    v_mfma_f32_16x16x32_bf16 a[36:39], v[124:127], v[132:135], a[36:39]
    buffer_load_dwordx4 v248, s[24:27], s50 offen lds
    v_mfma_f32_16x16x32_bf16 a[68:71], v[124:127], v[136:139], a[68:71]
    s_add_u32 s50, s67, 0x18000
    ds_read_b128 v[208:211], v254 offset:4096
    v_mfma_f32_16x16x32_bf16 a[100:103], v[124:127], v[140:143], a[100:103]
    s_add_u32 m0, s71, 0x1800
    ds_read_b128 v[212:215], v254 offset:5120
    v_mfma_f32_16x16x32_bf16 a[132:135], v[124:127], v[144:147], a[132:135]
    buffer_load_dwordx4 v250, s[24:27], s50 offen lds
    v_mfma_f32_16x16x32_bf16 a[164:167], v[124:127], v[148:151], a[164:167]
    s_add_u32 m0, s71, 0x1c00
    ds_read_b128 v[216:219], v254 offset:6144
    v_mfma_f32_16x16x32_bf16 a[196:199], v[124:127], v[152:155], a[196:199]
    s_waitcnt lgkmcnt(4)
    buffer_load_dwordx4 v248, s[24:27], s50 offen lds
    v_mfma_f32_16x16x32_bf16 a[0:3], v[96:99], v[192:195], a[0:3]
    s_waitcnt vmcnt(21)
    ds_read_b128 v[128:131], v254 offset:7168
    ds_read_b64_tr_b16 v[112:113], v252 offset:8192
    v_mfma_f32_16x16x32_bf16 a[32:35], v[96:99], v[196:199], a[32:35]
    s_bfe_u32 s80, s59, 0x40010
    ds_read_b64_tr_b16 v[114:115], v252 offset:9216
    v_accvgpr_read_b32 v72, a136
    v_mfma_f32_16x16x32_bf16 a[64:67], v[96:99], v[200:203], a[64:67]
    s_waitcnt lgkmcnt(6)
    ds_read_b128 v[132:135], v254 offset:8192
    ds_read_b64_tr_b16 v[116:117], v253 offset:8192
    v_mfma_f32_16x16x32_bf16 a[96:99], v[96:99], v[204:207], a[96:99]
    s_waitcnt lgkmcnt(7)
    ds_read_b64_tr_b16 v[118:119], v253 offset:9216
    v_accvgpr_read_b32 v73, a137
    v_mfma_f32_16x16x32_bf16 a[128:131], v[96:99], v[208:211], a[128:131]
    s_waitcnt lgkmcnt(7)
    ds_read_b128 v[136:139], v254 offset:9216
    ds_read_b64_tr_b16 v[120:121], v252 offset:10240
    v_mfma_f32_16x16x32_bf16 a[160:163], v[96:99], v[212:215], a[160:163]
    s_waitcnt lgkmcnt(8)
    ds_read_b64_tr_b16 v[122:123], v252 offset:11264
    v_accvgpr_read_b32 v74, a138
    v_mfma_f32_16x16x32_bf16 a[192:195], v[96:99], v[216:219], a[192:195]
    s_lshl_b32 s80, s80, 10
    ds_read_b128 v[140:143], v254 offset:10240
    ds_read_b64_tr_b16 v[124:125], v253 offset:10240
    v_mfma_f32_16x16x32_bf16 a[4:7], v[100:103], v[192:195], a[4:7]
    s_add_u32 s80, s80, s46
    ds_read_b64_tr_b16 v[126:127], v253 offset:11264
    v_accvgpr_read_b32 v75, a139
    v_mfma_f32_16x16x32_bf16 a[36:39], v[100:103], v[196:199], a[36:39]
    ds_read_b128 v[144:147], v254 offset:11264
    v_accvgpr_read_b32 v76, a140
    v_mfma_f32_16x16x32_bf16 a[68:71], v[100:103], v[200:203], a[68:71]
    v_accvgpr_read_b32 v77, a141
    v_accvgpr_read_b32 v78, a142
    v_mfma_f32_16x16x32_bf16 a[100:103], v[100:103], v[204:207], a[100:103]
    ds_read_b128 v[148:151], v254 offset:12288
    v_accvgpr_read_b32 v79, a143
    v_mfma_f32_16x16x32_bf16 a[132:135], v[100:103], v[208:211], a[132:135]
    v_cvt_pk_bf16_f32 v92, v72, v73
    v_cvt_pk_bf16_f32 v93, v74, v75
    v_mfma_f32_16x16x32_bf16 a[164:167], v[100:103], v[212:215], a[164:167]
    ds_read_b128 v[152:155], v254 offset:13312
    v_cvt_pk_bf16_f32 v94, v76, v77
    v_mfma_f32_16x16x32_bf16 a[196:199], v[100:103], v[216:219], a[196:199]
    s_waitcnt lgkmcnt(7)
    v_cvt_pk_bf16_f32 v95, v78, v79
    v_mfma_f32_16x16x32_bf16 a[0:3], v[104:107], v[128:131], a[0:3]
    ds_read_b128 v[192:195], v254 offset:14336
    v_mfma_f32_16x16x32_bf16 a[32:35], v[104:107], v[132:135], a[32:35]
    buffer_store_dwordx4 v[92:95], v251, s[28:31], s80 offen sc1
    v_mfma_f32_16x16x32_bf16 a[64:67], v[104:107], v[136:139], a[64:67]
    s_waitcnt lgkmcnt(4)
    ds_read_b128 v[196:199], v254 offset:15360
    v_mfma_f32_16x16x32_bf16 a[96:99], v[104:107], v[140:143], a[96:99]
    s_waitcnt lgkmcnt(4)
    v_mfma_f32_16x16x32_bf16 a[128:131], v[104:107], v[144:147], a[128:131]
    s_waitcnt lgkmcnt(3)
    ds_read_b128 v[200:203], v254 offset:16384
    v_mfma_f32_16x16x32_bf16 a[160:163], v[104:107], v[148:151], a[160:163]
    s_waitcnt lgkmcnt(3)
    s_add_u32 s50, s67, 0x20000
    s_add_u32 m0, s71, 0x2000
    v_mfma_f32_16x16x32_bf16 a[192:195], v[104:107], v[152:155], a[192:195]
    buffer_load_dwordx4 v250, s[24:27], s50 offen lds
    v_mfma_f32_16x16x32_bf16 a[4:7], v[108:111], v[128:131], a[4:7]
    s_add_u32 m0, s71, 0x2400
    ds_read_b128 v[204:207], v254 offset:17408
    v_mfma_f32_16x16x32_bf16 a[36:39], v[108:111], v[132:135], a[36:39]
    buffer_load_dwordx4 v248, s[24:27], s50 offen lds
    v_mfma_f32_16x16x32_bf16 a[68:71], v[108:111], v[136:139], a[68:71]
    s_add_u32 s50, s67, 0x28000
    ds_read_b128 v[208:211], v254 offset:18432
    v_mfma_f32_16x16x32_bf16 a[100:103], v[108:111], v[140:143], a[100:103]
    s_add_u32 m0, s71, 0x2800
    ds_read_b128 v[212:215], v254 offset:19456
    v_mfma_f32_16x16x32_bf16 a[132:135], v[108:111], v[144:147], a[132:135]
    buffer_load_dwordx4 v250, s[24:27], s50 offen lds
    v_mfma_f32_16x16x32_bf16 a[164:167], v[108:111], v[148:151], a[164:167]
    s_add_u32 m0, s71, 0x2c00
    ds_read_b128 v[216:219], v254 offset:20480
    v_mfma_f32_16x16x32_bf16 a[196:199], v[108:111], v[152:155], a[196:199]
    s_waitcnt lgkmcnt(4)
    buffer_load_dwordx4 v248, s[24:27], s50 offen lds
    v_mfma_f32_16x16x32_bf16 a[0:3], v[112:115], v[192:195], a[0:3]
    s_waitcnt vmcnt(21)
    ds_read_b64_tr_b16 v[96:97], v244 offset:0
    v_accvgpr_read_b32 v64, a168
    v_mfma_f32_16x16x32_bf16 a[32:35], v[112:115], v[196:199], a[32:35]
    s_bfe_u32 s80, s59, 0x40014
    ds_read_b64_tr_b16 v[98:99], v244 offset:1024
    v_accvgpr_read_b32 v65, a169
    v_mfma_f32_16x16x32_bf16 a[64:67], v[112:115], v[200:203], a[64:67]
    s_waitcnt lgkmcnt(5)
    ds_read_b64_tr_b16 v[100:101], v245 offset:0
    v_accvgpr_read_b32 v66, a170
    v_mfma_f32_16x16x32_bf16 a[96:99], v[112:115], v[204:207], a[96:99]
    s_waitcnt lgkmcnt(5)
    ds_read_b64_tr_b16 v[102:103], v245 offset:1024
    v_accvgpr_read_b32 v67, a171
    v_mfma_f32_16x16x32_bf16 a[128:131], v[112:115], v[208:211], a[128:131]
    s_waitcnt lgkmcnt(5)
    ds_read_b64_tr_b16 v[104:105], v244 offset:2048
    v_accvgpr_read_b32 v68, a172
    v_mfma_f32_16x16x32_bf16 a[160:163], v[112:115], v[212:215], a[160:163]
    s_waitcnt lgkmcnt(5)
    ds_read_b64_tr_b16 v[106:107], v244 offset:3072
    v_accvgpr_read_b32 v69, a173
    v_mfma_f32_16x16x32_bf16 a[192:195], v[112:115], v[216:219], a[192:195]
    s_lshl_b32 s80, s80, 10
    ds_read_b64_tr_b16 v[108:109], v245 offset:2048
    v_accvgpr_read_b32 v70, a174
    v_mfma_f32_16x16x32_bf16 a[4:7], v[116:119], v[192:195], a[4:7]
    s_add_u32 s80, s80, s46
    ds_read_b64_tr_b16 v[110:111], v245 offset:3072
    v_accvgpr_read_b32 v71, a175
    v_mfma_f32_16x16x32_bf16 a[36:39], v[116:119], v[196:199], a[36:39]
    v_cvt_pk_bf16_f32 v80, v64, v65
    v_cvt_pk_bf16_f32 v81, v66, v67
    v_mfma_f32_16x16x32_bf16 a[68:71], v[116:119], v[200:203], a[68:71]
    v_cvt_pk_bf16_f32 v82, v68, v69
    v_cvt_pk_bf16_f32 v83, v70, v71
    v_mfma_f32_16x16x32_bf16 a[100:103], v[116:119], v[204:207], a[100:103]
    buffer_store_dwordx4 v[80:83], v251, s[28:31], s80 offen sc1
    v_mfma_f32_16x16x32_bf16 a[132:135], v[116:119], v[208:211], a[132:135]
    v_mfma_f32_16x16x32_bf16 a[164:167], v[116:119], v[212:215], a[164:167]
    v_mfma_f32_16x16x32_bf16 a[196:199], v[116:119], v[216:219], a[196:199]
    v_mfma_f32_16x16x32_bf16 a[0:3], v[120:123], a[16:19], a[0:3]
    v_mfma_f32_16x16x32_bf16 a[32:35], v[120:123], a[48:51], a[32:35]
    v_mfma_f32_16x16x32_bf16 a[64:67], v[120:123], a[80:83], a[64:67]
    v_mfma_f32_16x16x32_bf16 a[96:99], v[120:123], a[112:115], a[96:99]
    s_add_u32 s50, s67, 0x30000
    v_mfma_f32_16x16x32_bf16 a[128:131], v[120:123], a[144:147], a[128:131]
    s_add_u32 m0, s3, 0
    v_mfma_f32_16x16x32_bf16 a[160:163], v[120:123], a[176:179], a[160:163]
    s_waitcnt lgkmcnt(0)
    buffer_load_dwordx4 v250, s[24:27], s50 offen lds
    v_mfma_f32_16x16x32_bf16 a[192:195], v[120:123], a[208:211], a[192:195]
    s_add_u32 m0, s3, 0x400
    v_mfma_f32_16x16x32_bf16 a[4:7], v[124:127], a[16:19], a[4:7]
    buffer_load_dwordx4 v248, s[24:27], s50 offen lds
    v_mfma_f32_16x16x32_bf16 a[36:39], v[124:127], a[48:51], a[36:39]
    s_add_u32 s50, s67, 0x38000
    v_mfma_f32_16x16x32_bf16 a[68:71], v[124:127], a[80:83], a[68:71]
    s_add_u32 m0, s3, 0x800
    v_mfma_f32_16x16x32_bf16 a[100:103], v[124:127], a[112:115], a[100:103]
    buffer_load_dwordx4 v250, s[24:27], s50 offen lds
    v_mfma_f32_16x16x32_bf16 a[132:135], v[124:127], a[144:147], a[132:135]
    s_add_u32 m0, s3, 0xc00
    v_mfma_f32_16x16x32_bf16 a[164:167], v[124:127], a[176:179], a[164:167]
    buffer_load_dwordx4 v248, s[24:27], s50 offen lds
    v_mfma_f32_16x16x32_bf16 a[196:199], v[124:127], a[208:211], a[196:199]
    v_mfma_f32_16x16x32_bf16 a[0:3], v[96:99], a[20:23], a[0:3]
    s_waitcnt vmcnt(21)
    ds_read_b64_tr_b16 v[112:113], v244 offset:4096
    v_accvgpr_read_b32 v72, a200
    v_mfma_f32_16x16x32_bf16 a[32:35], v[96:99], a[52:55], a[32:35]
    s_bfe_u32 s80, s59, 0x40018
    ds_read_b64_tr_b16 v[114:115], v244 offset:5120
    v_accvgpr_read_b32 v73, a201
    v_mfma_f32_16x16x32_bf16 a[64:67], v[96:99], a[84:87], a[64:67]
    s_lshl_b32 s80, s80, 10
    ds_read_b64_tr_b16 v[116:117], v245 offset:4096
    v_accvgpr_read_b32 v74, a202
    v_mfma_f32_16x16x32_bf16 a[96:99], v[96:99], a[116:119], a[96:99]
    s_add_u32 s80, s80, s46
    ds_read_b64_tr_b16 v[118:119], v245 offset:5120
    v_accvgpr_read_b32 v75, a203
    v_mfma_f32_16x16x32_bf16 a[128:131], v[96:99], a[148:151], a[128:131]
    s_mul_i32 s46, s66, 896
    ds_read_b64_tr_b16 v[120:121], v244 offset:6144
    v_accvgpr_read_b32 v76, a204
    v_mfma_f32_16x16x32_bf16 a[160:163], v[96:99], a[180:183], a[160:163]
    s_add_u32 s46, s46, 0x1c000
    ds_read_b64_tr_b16 v[122:123], v244 offset:7168
    v_accvgpr_read_b32 v77, a205
    v_mfma_f32_16x16x32_bf16 a[192:195], v[96:99], a[212:215], a[192:195]
    ds_read_b64_tr_b16 v[124:125], v245 offset:6144
    v_accvgpr_read_b32 v78, a206
    v_mfma_f32_16x16x32_bf16 a[4:7], v[100:103], a[20:23], a[4:7]
    ds_read_b64_tr_b16 v[126:127], v245 offset:7168
    v_accvgpr_read_b32 v79, a207
    v_mfma_f32_16x16x32_bf16 a[36:39], v[100:103], a[52:55], a[36:39]
    v_cvt_pk_bf16_f32 v84, v72, v73
    v_cvt_pk_bf16_f32 v85, v74, v75
    v_mfma_f32_16x16x32_bf16 a[68:71], v[100:103], a[84:87], a[68:71]
    v_cvt_pk_bf16_f32 v86, v76, v77
    v_cvt_pk_bf16_f32 v87, v78, v79
    v_mfma_f32_16x16x32_bf16 a[100:103], v[100:103], a[116:119], a[100:103]
    buffer_store_dwordx4 v[84:87], v251, s[28:31], s80 offen sc1
    v_mfma_f32_16x16x32_bf16 a[132:135], v[100:103], a[148:151], a[132:135]
    v_mfma_f32_16x16x32_bf16 a[164:167], v[100:103], a[180:183], a[164:167]
    v_mfma_f32_16x16x32_bf16 a[196:199], v[100:103], a[212:215], a[196:199]
    v_mfma_f32_16x16x32_bf16 a[0:3], v[104:107], a[24:27], a[0:3]
    v_mfma_f32_16x16x32_bf16 a[32:35], v[104:107], a[56:59], a[32:35]
    v_mfma_f32_16x16x32_bf16 a[64:67], v[104:107], a[88:91], a[64:67]
    v_mfma_f32_16x16x32_bf16 a[96:99], v[104:107], a[120:123], a[96:99]
    s_add_u32 s50, s67, 0x40000
    v_mfma_f32_16x16x32_bf16 a[128:131], v[104:107], a[152:155], a[128:131]
    s_add_u32 m0, s3, 0x1000
    v_mfma_f32_16x16x32_bf16 a[160:163], v[104:107], a[184:187], a[160:163]
    s_waitcnt lgkmcnt(0)
    buffer_load_dwordx4 v250, s[24:27], s50 offen lds
    v_mfma_f32_16x16x32_bf16 a[192:195], v[104:107], a[216:219], a[192:195]
    s_add_u32 m0, s3, 0x1400
    v_mfma_f32_16x16x32_bf16 a[4:7], v[108:111], a[24:27], a[4:7]
    buffer_load_dwordx4 v248, s[24:27], s50 offen lds
    v_mfma_f32_16x16x32_bf16 a[36:39], v[108:111], a[56:59], a[36:39]
    s_add_u32 s50, s67, 0x48000
    v_mfma_f32_16x16x32_bf16 a[68:71], v[108:111], a[88:91], a[68:71]
    s_add_u32 m0, s3, 0x1800
    v_mfma_f32_16x16x32_bf16 a[100:103], v[108:111], a[120:123], a[100:103]
    buffer_load_dwordx4 v250, s[24:27], s50 offen lds
    v_mfma_f32_16x16x32_bf16 a[132:135], v[108:111], a[152:155], a[132:135]
    s_add_u32 m0, s3, 0x1c00
    v_mfma_f32_16x16x32_bf16 a[164:167], v[108:111], a[184:187], a[164:167]
    buffer_load_dwordx4 v248, s[24:27], s50 offen lds
    v_mfma_f32_16x16x32_bf16 a[196:199], v[108:111], a[216:219], a[196:199]
    v_mfma_f32_16x16x32_bf16 a[0:3], v[112:115], a[28:31], a[0:3]
    s_waitcnt vmcnt(21)
    ds_read_b64_tr_b16 v[96:97], v252 offset:0
    v_mfma_f32_16x16x32_bf16 a[32:35], v[112:115], a[60:63], a[32:35]
    ds_read_b64_tr_b16 v[98:99], v252 offset:1024
    v_mfma_f32_16x16x32_bf16 a[64:67], v[112:115], a[92:95], a[64:67]
    ds_read_b64_tr_b16 v[100:101], v253 offset:0
    v_mfma_f32_16x16x32_bf16 a[96:99], v[112:115], a[124:127], a[96:99]
    ds_read_b64_tr_b16 v[102:103], v253 offset:1024
    v_mfma_f32_16x16x32_bf16 a[128:131], v[112:115], a[156:159], a[128:131]
    ds_read_b64_tr_b16 v[104:105], v252 offset:2048
    v_mfma_f32_16x16x32_bf16 a[160:163], v[112:115], a[188:191], a[160:163]
    ds_read_b64_tr_b16 v[106:107], v252 offset:3072
    v_mfma_f32_16x16x32_bf16 a[192:195], v[112:115], a[220:223], a[192:195]
    ds_read_b64_tr_b16 v[108:109], v253 offset:2048
    v_mfma_f32_16x16x32_bf16 a[4:7], v[116:119], a[28:31], a[4:7]
    ds_read_b64_tr_b16 v[110:111], v253 offset:3072
    v_mfma_f32_16x16x32_bf16 a[36:39], v[116:119], a[60:63], a[36:39]
    v_mfma_f32_16x16x32_bf16 a[68:71], v[116:119], a[92:95], a[68:71]
    v_mfma_f32_16x16x32_bf16 a[100:103], v[116:119], a[124:127], a[100:103]
    v_mfma_f32_16x16x32_bf16 a[132:135], v[116:119], a[156:159], a[132:135]
    v_mfma_f32_16x16x32_bf16 a[164:167], v[116:119], a[188:191], a[164:167]
    v_mfma_f32_16x16x32_bf16 a[196:199], v[116:119], a[220:223], a[196:199]
    v_mfma_f32_16x16x32_bf16 a[0:3], v[120:123], a[224:227], a[0:3]
    v_mfma_f32_16x16x32_bf16 a[32:35], v[120:123], a[228:231], a[32:35]
    v_mfma_f32_16x16x32_bf16 a[64:67], v[120:123], a[232:235], a[64:67]
    v_mfma_f32_16x16x32_bf16 a[96:99], v[120:123], a[236:239], a[96:99]
    s_add_u32 s50, s67, 0x50000
    v_mfma_f32_16x16x32_bf16 a[128:131], v[120:123], a[240:243], a[128:131]
    s_add_u32 m0, s71, 0
    v_mfma_f32_16x16x32_bf16 a[160:163], v[120:123], a[244:247], a[160:163]
    s_waitcnt lgkmcnt(0)
    buffer_load_dwordx4 v250, s[24:27], s50 offen lds
    v_mfma_f32_16x16x32_bf16 a[192:195], v[120:123], a[248:251], a[192:195]
    s_add_u32 m0, s71, 0x400
    v_mfma_f32_16x16x32_bf16 a[4:7], v[124:127], a[224:227], a[4:7]
    buffer_load_dwordx4 v248, s[24:27], s50 offen lds
    v_mfma_f32_16x16x32_bf16 a[36:39], v[124:127], a[228:231], a[36:39]
    s_add_u32 s50, s67, 0x58000
    v_mfma_f32_16x16x32_bf16 a[68:71], v[124:127], a[232:235], a[68:71]
    s_add_u32 m0, s71, 0x800
    v_mfma_f32_16x16x32_bf16 a[100:103], v[124:127], a[236:239], a[100:103]
    buffer_load_dwordx4 v250, s[24:27], s50 offen lds
    v_mfma_f32_16x16x32_bf16 a[132:135], v[124:127], a[240:243], a[132:135]
    s_add_u32 m0, s71, 0xc00
    v_mfma_f32_16x16x32_bf16 a[164:167], v[124:127], a[244:247], a[164:167]
    buffer_load_dwordx4 v248, s[24:27], s50 offen lds
    v_mfma_f32_16x16x32_bf16 a[196:199], v[124:127], a[248:251], a[196:199]
    v_mfma_f32_16x16x32_bf16 a[8:11], v[96:99], v[156:159], 0
    s_waitcnt vmcnt(19)
    ds_read_b64_tr_b16 v[112:113], v252 offset:4096
    v_accvgpr_read_b32 v64, a0
    v_mfma_f32_16x16x32_bf16 a[40:43], v[96:99], v[228:231], 0
    s_bfe_u32 s80, s59, 0x40000
    ds_read_b64_tr_b16 v[114:115], v252 offset:5120
    v_accvgpr_read_b32 v65, a1
    v_mfma_f32_16x16x32_bf16 a[72:75], v[96:99], v[224:227], 0
    buffer_load_dwordx2 v[242:243], v249, s[20:23], s43 offen sc1
    v_mfma_f32_16x16x32_bf16 a[104:107], v[96:99], v[220:223], 0
    s_lshl_b32 s80, s80, 10
    ds_read_b64_tr_b16 v[116:117], v253 offset:4096
    ds_read_b64_tr_b16 v[118:119], v253 offset:5120
    v_mfma_f32_16x16x32_bf16 a[136:139], v[96:99], v[188:191], 0
    s_add_u32 s80, s80, s46
    ds_read_b64_tr_b16 v[120:121], v252 offset:6144
    v_accvgpr_read_b32 v66, a2
    v_mfma_f32_16x16x32_bf16 a[168:171], v[96:99], v[184:187], 0
    ds_read_b64_tr_b16 v[122:123], v252 offset:7168
    v_accvgpr_read_b32 v67, a3
    v_mfma_f32_16x16x32_bf16 a[200:203], v[96:99], v[180:183], 0
    ds_read_b64_tr_b16 v[124:125], v253 offset:6144
    v_accvgpr_read_b32 v68, a4
    v_mfma_f32_16x16x32_bf16 a[12:15], v[100:103], v[156:159], 0
    ds_read_b64_tr_b16 v[126:127], v253 offset:7168
    v_accvgpr_read_b32 v69, a5
    v_mfma_f32_16x16x32_bf16 a[44:47], v[100:103], v[228:231], 0
    v_accvgpr_read_b32 v70, a6
    v_accvgpr_read_b32 v71, a7
    v_mfma_f32_16x16x32_bf16 a[76:79], v[100:103], v[224:227], 0
    v_cvt_pk_bf16_f32 v88, v64, v65
    v_cvt_pk_bf16_f32 v89, v66, v67
    v_mfma_f32_16x16x32_bf16 a[108:111], v[100:103], v[220:223], 0
    v_cvt_pk_bf16_f32 v90, v68, v69
    v_cvt_pk_bf16_f32 v91, v70, v71
    v_mfma_f32_16x16x32_bf16 a[140:143], v[100:103], v[188:191], 0
    buffer_store_dwordx4 v[88:91], v251, s[28:31], s80 offen sc1
    v_mfma_f32_16x16x32_bf16 a[172:175], v[100:103], v[184:187], 0
    s_bfe_u32 s80, s59, 0x40004
    v_accvgpr_read_b32 v72, a32
    v_accvgpr_read_b32 v73, a33
    v_mfma_f32_16x16x32_bf16 a[204:207], v[100:103], v[180:183], 0
    s_lshl_b32 s80, s80, 10
    v_accvgpr_read_b32 v74, a34
    v_accvgpr_read_b32 v75, a35
    v_mfma_f32_16x16x32_bf16 a[8:11], v[104:107], v[176:179], a[8:11]
    s_add_u32 s80, s80, s46
    v_accvgpr_read_b32 v76, a36
    v_accvgpr_read_b32 v77, a37
    v_mfma_f32_16x16x32_bf16 a[40:43], v[104:107], v[172:175], a[40:43]
    v_accvgpr_read_b32 v78, a38
    v_accvgpr_read_b32 v79, a39
    v_mfma_f32_16x16x32_bf16 a[72:75], v[104:107], v[168:171], a[72:75]
    v_cvt_pk_bf16_f32 v92, v72, v73
    v_cvt_pk_bf16_f32 v93, v74, v75
    v_mfma_f32_16x16x32_bf16 a[104:107], v[104:107], v[164:167], a[104:107]
    s_add_u32 s50, s67, 0x60000
    v_cvt_pk_bf16_f32 v94, v76, v77
    v_cvt_pk_bf16_f32 v95, v78, v79
    v_mfma_f32_16x16x32_bf16 a[136:139], v[104:107], v[160:163], a[136:139]
    s_add_u32 m0, s71, 0x1000
    v_mfma_f32_16x16x32_bf16 a[168:171], v[104:107], v[60:63], a[168:171]
    s_waitcnt lgkmcnt(0)
    buffer_load_dwordx4 v250, s[24:27], s50 offen lds
    v_mfma_f32_16x16x32_bf16 a[200:203], v[104:107], v[56:59], a[200:203]
    s_add_u32 m0, s71, 0x1400
    v_mfma_f32_16x16x32_bf16 a[12:15], v[108:111], v[176:179], a[12:15]
    buffer_load_dwordx4 v248, s[24:27], s50 offen lds
    v_mfma_f32_16x16x32_bf16 a[44:47], v[108:111], v[172:175], a[44:47]
    s_add_u32 s50, s67, 0x68000
    v_mfma_f32_16x16x32_bf16 a[76:79], v[108:111], v[168:171], a[76:79]
    s_add_u32 m0, s71, 0x1800
    v_mfma_f32_16x16x32_bf16 a[108:111], v[108:111], v[164:167], a[108:111]
    buffer_load_dwordx4 v250, s[24:27], s50 offen lds
    v_mfma_f32_16x16x32_bf16 a[140:143], v[108:111], v[160:163], a[140:143]
    s_add_u32 m0, s71, 0x1c00
    v_mfma_f32_16x16x32_bf16 a[172:175], v[108:111], v[60:63], a[172:175]
    buffer_load_dwordx4 v248, s[24:27], s50 offen lds
    v_mfma_f32_16x16x32_bf16 a[204:207], v[108:111], v[56:59], a[204:207]
    buffer_store_dwordx4 v[92:95], v251, s[28:31], s80 offen sc1
    v_mfma_f32_16x16x32_bf16 a[8:11], v[112:115], v[52:55], a[8:11]
    s_waitcnt vmcnt(21)
    ds_read_b64_tr_b16 v[96:97], v252 offset:8192
    v_accvgpr_read_b32 v64, a64
    v_mfma_f32_16x16x32_bf16 a[40:43], v[112:115], v[48:51], a[40:43]
    s_bfe_u32 s80, s59, 0x40008
    ds_read_b64_tr_b16 v[98:99], v252 offset:9216
    v_accvgpr_read_b32 v65, a65
    v_mfma_f32_16x16x32_bf16 a[72:75], v[112:115], v[44:47], a[72:75]
    s_lshl_b32 s80, s80, 10
    ds_read_b64_tr_b16 v[100:101], v253 offset:8192
    v_accvgpr_read_b32 v66, a66
    v_mfma_f32_16x16x32_bf16 a[104:107], v[112:115], v[40:43], a[104:107]
    s_add_u32 s80, s80, s46
    ds_read_b64_tr_b16 v[102:103], v253 offset:9216
    v_accvgpr_read_b32 v67, a67
    v_mfma_f32_16x16x32_bf16 a[136:139], v[112:115], v[36:39], a[136:139]
    ds_read_b64_tr_b16 v[104:105], v252 offset:10240
    v_accvgpr_read_b32 v68, a68
    v_mfma_f32_16x16x32_bf16 a[168:171], v[112:115], v[32:35], a[168:171]
    ds_read_b64_tr_b16 v[106:107], v252 offset:11264
    v_accvgpr_read_b32 v69, a69
    v_mfma_f32_16x16x32_bf16 a[200:203], v[112:115], v[28:31], a[200:203]
    ds_read_b64_tr_b16 v[108:109], v253 offset:10240
    v_accvgpr_read_b32 v70, a70
    v_mfma_f32_16x16x32_bf16 a[12:15], v[116:119], v[52:55], a[12:15]
    ds_read_b64_tr_b16 v[110:111], v253 offset:11264
    v_accvgpr_read_b32 v71, a71
    v_mfma_f32_16x16x32_bf16 a[44:47], v[116:119], v[48:51], a[44:47]
    v_cvt_pk_bf16_f32 v80, v64, v65
    v_cvt_pk_bf16_f32 v81, v66, v67
    v_mfma_f32_16x16x32_bf16 a[76:79], v[116:119], v[44:47], a[76:79]
    v_cvt_pk_bf16_f32 v82, v68, v69
    v_cvt_pk_bf16_f32 v83, v70, v71
    v_mfma_f32_16x16x32_bf16 a[108:111], v[116:119], v[40:43], a[108:111]
    buffer_store_dwordx4 v[80:83], v251, s[28:31], s80 offen sc1
    v_mfma_f32_16x16x32_bf16 a[140:143], v[116:119], v[36:39], a[140:143]
    s_bfe_u32 s80, s59, 0x4000c
    v_accvgpr_read_b32 v72, a96
    v_accvgpr_read_b32 v73, a97
    v_mfma_f32_16x16x32_bf16 a[172:175], v[116:119], v[32:35], a[172:175]
    s_lshl_b32 s80, s80, 10
    v_accvgpr_read_b32 v74, a98
    v_accvgpr_read_b32 v75, a99
    v_mfma_f32_16x16x32_bf16 a[204:207], v[116:119], v[28:31], a[204:207]
    s_add_u32 s80, s80, s46
    v_accvgpr_read_b32 v76, a100
    v_accvgpr_read_b32 v77, a101
    v_mfma_f32_16x16x32_bf16 a[8:11], v[120:123], v[24:27], a[8:11]
    s_lshl_b32 s42, s65, 4
    ds_read_b128 v[128:131], v251 offset:28672
    v_accvgpr_read_b32 v78, a102
    v_mfma_f32_16x16x32_bf16 a[40:43], v[120:123], v[20:23], a[40:43]
    s_lshl3_add_u32 s42, s70, s42
    v_accvgpr_read_b32 v79, a103
    v_cvt_pk_bf16_f32 v84, v72, v73
    v_mfma_f32_16x16x32_bf16 a[72:75], v[120:123], v[16:19], a[72:75]
    s_waitcnt vmcnt(16)
    buffer_store_dwordx2 v[240:241], off, s[20:23], s42 offset:16 sc1
    v_mfma_f32_16x16x32_bf16 a[104:107], v[120:123], v[12:15], a[104:107]
    s_add_u32 s50, s67, 0x70000
    ds_read_b128 v[132:135], v251 offset:29696
    v_cvt_pk_bf16_f32 v85, v74, v75
    v_mfma_f32_16x16x32_bf16 a[136:139], v[120:123], v[8:11], a[136:139]
    s_add_u32 m0, s71, 0x2000
    ds_read_b128 v[136:139], v251 offset:30720
    v_cvt_pk_bf16_f32 v86, v76, v77
    v_mfma_f32_16x16x32_bf16 a[168:171], v[120:123], v[4:7], a[168:171]
    s_waitcnt lgkmcnt(3)
    buffer_load_dwordx4 v250, s[24:27], s50 offen lds
    v_mfma_f32_16x16x32_bf16 a[200:203], v[120:123], v[0:3], a[200:203]
    s_add_u32 m0, s71, 0x2400
    ds_read_b128 v[140:143], v251 offset:31744
    v_cvt_pk_bf16_f32 v87, v78, v79
    v_mfma_f32_16x16x32_bf16 a[12:15], v[124:127], v[24:27], a[12:15]
    buffer_load_dwordx4 v248, s[24:27], s50 offen lds
    v_mfma_f32_16x16x32_bf16 a[44:47], v[124:127], v[20:23], a[44:47]
    s_add_u32 s50, s67, 0x78000
    ds_read_b128 v[144:147], v251 offset:32768
    v_accvgpr_read_b32 v64, a128
    v_mfma_f32_16x16x32_bf16 a[76:79], v[124:127], v[16:19], a[76:79]
    s_add_u32 m0, s71, 0x2800
    v_accvgpr_read_b32 v65, a129
    v_accvgpr_read_b32 v66, a130
    v_mfma_f32_16x16x32_bf16 a[108:111], v[124:127], v[12:15], a[108:111]
    buffer_load_dwordx4 v250, s[24:27], s50 offen lds
    v_mfma_f32_16x16x32_bf16 a[140:143], v[124:127], v[8:11], a[140:143]
    s_add_u32 m0, s71, 0x2c00
    ds_read_b128 v[148:151], v251 offset:33792
    v_accvgpr_read_b32 v67, a131
    v_mfma_f32_16x16x32_bf16 a[172:175], v[124:127], v[4:7], a[172:175]
    buffer_store_dwordx4 v[84:87], v251, s[28:31], s80 offen sc1
    ds_read_b128 v[152:155], v251 offset:34816
    s_bfe_u32 s80, s59, 0x40010
    s_lshl_b32 s80, s80, 10
    s_add_u32 s80, s80, s46
    v_accvgpr_read_b32 v68, a132
    v_accvgpr_read_b32 v69, a133
    v_accvgpr_read_b32 v70, a134
    v_accvgpr_read_b32 v71, a135
    v_cvt_pk_bf16_f32 v88, v64, v65
    v_cvt_pk_bf16_f32 v89, v66, v67
    v_cvt_pk_bf16_f32 v90, v68, v69
    v_cvt_pk_bf16_f32 v91, v70, v71
    v_mfma_f32_16x16x32_bf16 a[204:207], v[124:127], v[0:3], a[204:207]
    s_waitcnt lgkmcnt(4)
    buffer_load_dwordx4 v248, s[24:27], s50 offen lds
    buffer_store_dwordx4 v[88:91], v251, s[28:31], s80 offen sc1
    v_mfma_f32_16x16x32_bf16 a[8:11], v[96:99], v[128:131], a[8:11]
    s_bfe_u32 s80, s59, 0x40014
    ds_read_b128 v[192:195], v251 offset:35840
    ds_read_b64_tr_b16 v[112:113], v244 offset:0
    v_mfma_f32_16x16x32_bf16 a[40:43], v[96:99], v[132:135], a[40:43]
    s_lshl_b32 s80, s80, 10
    ds_read_b64_tr_b16 v[114:115], v244 offset:1024
    v_accvgpr_read_b32 v72, a160
    v_mfma_f32_16x16x32_bf16 a[72:75], v[96:99], v[136:139], a[72:75]
    s_waitcnt lgkmcnt(6)
    ds_read_b128 v[196:199], v251 offset:36864
    v_accvgpr_read_b32 v73, a161
    v_mfma_f32_16x16x32_bf16 a[104:107], v[96:99], v[140:143], a[104:107]
    s_waitcnt lgkmcnt(6)
    v_accvgpr_read_b32 v74, a162
    v_accvgpr_read_b32 v75, a163
    v_mfma_f32_16x16x32_bf16 a[136:139], v[96:99], v[144:147], a[136:139]
    s_waitcnt lgkmcnt(5)
    ds_read_b128 v[200:203], v251 offset:37888
    v_accvgpr_read_b32 v76, a164
    v_mfma_f32_16x16x32_bf16 a[168:171], v[96:99], v[148:151], a[168:171]
    s_waitcnt lgkmcnt(5)
    v_accvgpr_read_b32 v77, a165
    v_accvgpr_read_b32 v78, a166
    v_mfma_f32_16x16x32_bf16 a[200:203], v[96:99], v[152:155], a[200:203]
    s_add_u32 s80, s80, s46
    ds_read_b128 v[204:207], v251 offset:38912
    v_accvgpr_read_b32 v79, a167
    v_mfma_f32_16x16x32_bf16 a[12:15], v[100:103], v[128:131], a[12:15]
    v_cvt_pk_bf16_f32 v92, v72, v73
    v_cvt_pk_bf16_f32 v93, v74, v75
    v_mfma_f32_16x16x32_bf16 a[44:47], v[100:103], v[132:135], a[44:47]
    ds_read_b128 v[208:211], v251 offset:39936
    v_cvt_pk_bf16_f32 v94, v76, v77
    v_mfma_f32_16x16x32_bf16 a[76:79], v[100:103], v[136:139], a[76:79]
    v_cvt_pk_bf16_f32 v95, v78, v79
    v_accvgpr_read_b32 v64, a192
    v_mfma_f32_16x16x32_bf16 a[108:111], v[100:103], v[140:143], a[108:111]
    ds_read_b128 v[212:215], v251 offset:40960
    v_accvgpr_read_b32 v65, a193
    v_mfma_f32_16x16x32_bf16 a[140:143], v[100:103], v[144:147], a[140:143]
    buffer_store_dwordx4 v[92:95], v251, s[28:31], s80 offen sc1
    v_mfma_f32_16x16x32_bf16 a[172:175], v[100:103], v[148:151], a[172:175]
    s_bfe_u32 s80, s59, 0x40018
    ds_read_b128 v[216:219], v251 offset:41984
    v_accvgpr_read_b32 v66, a194
    v_mfma_f32_16x16x32_bf16 a[204:207], v[100:103], v[152:155], a[204:207]
    s_waitcnt lgkmcnt(4)
    v_accvgpr_read_b32 v67, a195
    v_accvgpr_read_b32 v68, a196
    v_mfma_f32_16x16x32_bf16 a[8:11], v[104:107], v[192:195], a[8:11]
    s_lshl_b32 s80, s80, 10
    ds_read_b128 v[128:131], v251 offset:43008
    v_accvgpr_read_b32 v69, a197
    v_mfma_f32_16x16x32_bf16 a[40:43], v[104:107], v[196:199], a[40:43]
    s_add_u32 s80, s80, s46
    v_accvgpr_read_b32 v70, a198
    v_accvgpr_read_b32 v71, a199
    v_mfma_f32_16x16x32_bf16 a[72:75], v[104:107], v[200:203], a[72:75]
    s_waitcnt lgkmcnt(4)
    ds_read_b128 v[132:135], v251 offset:44032
    v_cvt_pk_bf16_f32 v80, v64, v65
    v_mfma_f32_16x16x32_bf16 a[104:107], v[104:107], v[204:207], a[104:107]
    s_waitcnt lgkmcnt(4)
    v_cvt_pk_bf16_f32 v81, v66, v67
    v_cvt_pk_bf16_f32 v82, v68, v69
    v_mfma_f32_16x16x32_bf16 a[136:139], v[104:107], v[208:211], a[136:139]
    s_waitcnt lgkmcnt(3)
    ds_read_b128 v[136:139], v251 offset:45056
    v_cvt_pk_bf16_f32 v83, v70, v71
    v_mfma_f32_16x16x32_bf16 a[168:171], v[104:107], v[212:215], a[168:171]
    s_waitcnt lgkmcnt(3)
    ds_read_b64_tr_b16 v[116:117], v245 offset:0
    ds_read_b64_tr_b16 v[118:119], v245 offset:1024
    v_mfma_f32_16x16x32_bf16 a[200:203], v[104:107], v[216:219], a[200:203]
    s_mov_b32 s44, 0x3
    ds_read_b128 v[140:143], v251 offset:46080
    ds_read_b64_tr_b16 v[120:121], v244 offset:2048
    v_mfma_f32_16x16x32_bf16 a[12:15], v[108:111], v[192:195], a[12:15]
    buffer_store_dwordx4 v[80:83], v251, s[28:31], s80 offen sc1
    v_mfma_f32_16x16x32_bf16 a[44:47], v[108:111], v[196:199], a[44:47]
    s_nop 0
    ds_read_b128 v[144:147], v251 offset:47104
    ds_read_b64_tr_b16 v[122:123], v244 offset:3072
    v_mfma_f32_16x16x32_bf16 a[76:79], v[108:111], v[200:203], a[76:79]
    s_nop 0
    ds_read_b64_tr_b16 v[124:125], v245 offset:2048
    ds_read_b64_tr_b16 v[126:127], v245 offset:3072
    v_mfma_f32_16x16x32_bf16 a[108:111], v[108:111], v[204:207], a[108:111]
    ds_read_b128 v[148:151], v251 offset:48128
    v_mfma_f32_16x16x32_bf16 a[140:143], v[108:111], v[208:211], a[140:143]
    v_mfma_f32_16x16x32_bf16 a[172:175], v[108:111], v[212:215], a[172:175]
    ds_read_b128 v[152:155], v251 offset:49152
    v_mfma_f32_16x16x32_bf16 a[204:207], v[108:111], v[216:219], a[204:207]
    s_waitcnt lgkmcnt(10)
    v_mfma_f32_16x16x32_bf16 a[8:11], v[112:115], v[128:131], a[8:11]
    s_waitcnt vmcnt(16)
    ds_read_b128 v[192:195], v251 offset:50176
    v_cmp_eq_u64 vcc, v[242:243], v[240:241]
    v_mfma_f32_16x16x32_bf16 a[40:43], v[112:115], v[132:135], a[40:43]
    s_nop 0
    ds_read_b64_tr_b16 v[96:97], v244 offset:4096
    ds_read_b64_tr_b16 v[98:99], v244 offset:5120
    v_mfma_f32_16x16x32_bf16 a[72:75], v[112:115], v[136:139], a[72:75]
    s_waitcnt lgkmcnt(9)
    ds_read_b128 v[196:199], v251 offset:51200
    ds_read_b64_tr_b16 v[100:101], v245 offset:4096
    v_mfma_f32_16x16x32_bf16 a[104:107], v[112:115], v[140:143], a[104:107]
    s_waitcnt lgkmcnt(9)
    ds_read_b64_tr_b16 v[102:103], v245 offset:5120
    v_mfma_f32_16x16x32_bf16 a[136:139], v[112:115], v[144:147], a[136:139]
    s_waitcnt lgkmcnt(7)
    ds_read_b128 v[200:203], v251 offset:52224
    s_and_b32 s45, vcc_lo, s44
    v_mfma_f32_16x16x32_bf16 a[168:171], v[112:115], v[148:151], a[168:171]
    s_waitcnt lgkmcnt(7)
    ds_read_b64_tr_b16 v[104:105], v244 offset:6144
    ds_read_b64_tr_b16 v[106:107], v244 offset:7168
    v_mfma_f32_16x16x32_bf16 a[200:203], v[112:115], v[152:155], a[200:203]
    s_or_b32 s48, s48, s45
    ds_read_b128 v[204:207], v251 offset:53248
    ds_read_b64_tr_b16 v[108:109], v245 offset:6144
    v_mfma_f32_16x16x32_bf16 a[12:15], v[116:119], v[128:131], a[12:15]
    ds_read_b64_tr_b16 v[110:111], v245 offset:7168
    v_mfma_f32_16x16x32_bf16 a[44:47], v[116:119], v[132:135], a[44:47]
    ds_read_b128 v[208:211], v251 offset:54272
    v_mfma_f32_16x16x32_bf16 a[76:79], v[116:119], v[136:139], a[76:79]
    v_mfma_f32_16x16x32_bf16 a[108:111], v[116:119], v[140:143], a[108:111]
    s_bitcmp1_b32 s45, 0
    s_cselect_b32 s40, 0, s49
    v_mfma_f32_16x16x32_bf16 a[140:143], v[116:119], v[144:147], a[140:143]
    ds_read_b128 v[212:215], v251 offset:55296
    v_mfma_f32_16x16x32_bf16 a[172:175], v[116:119], v[148:151], a[172:175]
    ds_read_b128 v[216:219], v251 offset:56320
    v_mfma_f32_16x16x32_bf16 a[204:207], v[116:119], v[152:155], a[204:207]
    s_waitcnt lgkmcnt(8)
    v_mfma_f32_16x16x32_bf16 a[8:11], v[120:123], v[192:195], a[8:11]
    buffer_load_dwordx4 v[0:3], v247, s[8:11], s40 offen sc1
    v_mfma_f32_16x16x32_bf16 a[40:43], v[120:123], v[196:199], a[40:43]
    ds_read_b128 v[128:131], v254 offset:0
    v_mfma_f32_16x16x32_bf16 a[72:75], v[120:123], v[200:203], a[72:75]
    s_waitcnt lgkmcnt(4)
    ds_read_b128 v[132:135], v254 offset:1024
    v_mfma_f32_16x16x32_bf16 a[104:107], v[120:123], v[204:207], a[104:107]
    s_waitcnt lgkmcnt(4)
    v_mfma_f32_16x16x32_bf16 a[136:139], v[120:123], v[208:211], a[136:139]
    s_waitcnt lgkmcnt(3)
    ds_read_b128 v[136:139], v254 offset:2048
    v_mfma_f32_16x16x32_bf16 a[168:171], v[120:123], v[212:215], a[168:171]
    s_waitcnt lgkmcnt(3)
    v_mfma_f32_16x16x32_bf16 a[200:203], v[120:123], v[216:219], a[200:203]
    ds_read_b128 v[140:143], v254 offset:3072
    v_mfma_f32_16x16x32_bf16 a[12:15], v[124:127], v[192:195], a[12:15]
    v_mfma_f32_16x16x32_bf16 a[44:47], v[124:127], v[196:199], a[44:47]
    ds_read_b128 v[144:147], v254 offset:4096
    v_mfma_f32_16x16x32_bf16 a[76:79], v[124:127], v[200:203], a[76:79]
    buffer_load_dwordx4 v[4:7], v251, s[8:11], s40 offen offset:1024 sc1
    v_mfma_f32_16x16x32_bf16 a[108:111], v[124:127], v[204:207], a[108:111]
    ds_read_b128 v[148:151], v254 offset:5120
    v_mfma_f32_16x16x32_bf16 a[140:143], v[124:127], v[208:211], a[140:143]
    v_mfma_f32_16x16x32_bf16 a[172:175], v[124:127], v[212:215], a[172:175]
    ds_read_b128 v[152:155], v254 offset:6144
    v_mfma_f32_16x16x32_bf16 a[204:207], v[124:127], v[216:219], a[204:207]
    s_waitcnt lgkmcnt(4)
    v_mfma_f32_16x16x32_bf16 a[8:11], v[96:99], v[128:131], a[8:11]
    s_nop 0
    ds_read_b128 v[192:195], v254 offset:7168
    ds_read_b64_tr_b16 v[112:113], v252 offset:0
    v_mfma_f32_16x16x32_bf16 a[40:43], v[96:99], v[132:135], a[40:43]
    ds_read_b64_tr_b16 v[114:115], v252 offset:1024
    v_mfma_f32_16x16x32_bf16 a[72:75], v[96:99], v[136:139], a[72:75]
    s_waitcnt lgkmcnt(6)
    buffer_load_dwordx4 v[8:11], v251, s[8:11], s40 offen offset:2048 sc1
    v_mfma_f32_16x16x32_bf16 a[104:107], v[96:99], v[140:143], a[104:107]
    s_waitcnt lgkmcnt(5)
    ds_read_b128 v[196:199], v254 offset:8192
    ds_read_b64_tr_b16 v[116:117], v253 offset:0
    v_mfma_f32_16x16x32_bf16 a[136:139], v[96:99], v[144:147], a[136:139]
    s_waitcnt lgkmcnt(6)
    ds_read_b128 v[200:203], v254 offset:9216
    ds_read_b64_tr_b16 v[118:119], v253 offset:1024
    v_mfma_f32_16x16x32_bf16 a[168:171], v[96:99], v[148:151], a[168:171]
    s_waitcnt lgkmcnt(7)
    ds_read_b64_tr_b16 v[120:121], v252 offset:2048
    ds_read_b64_tr_b16 v[122:123], v252 offset:3072
    v_mfma_f32_16x16x32_bf16 a[200:203], v[96:99], v[152:155], a[200:203]
    s_nop 0
    ds_read_b128 v[204:207], v254 offset:10240
    ds_read_b64_tr_b16 v[124:125], v253 offset:2048
    v_mfma_f32_16x16x32_bf16 a[12:15], v[100:103], v[128:131], a[12:15]
    ds_read_b64_tr_b16 v[126:127], v253 offset:3072
    v_mfma_f32_16x16x32_bf16 a[44:47], v[100:103], v[132:135], a[44:47]
    ds_read_b128 v[208:211], v254 offset:11264
    v_mfma_f32_16x16x32_bf16 a[76:79], v[100:103], v[136:139], a[76:79]
    v_mfma_f32_16x16x32_bf16 a[108:111], v[100:103], v[140:143], a[108:111]
    ds_read_b128 v[212:215], v254 offset:12288
    v_mfma_f32_16x16x32_bf16 a[140:143], v[100:103], v[144:147], a[140:143]
    buffer_load_dwordx4 v[12:15], v251, s[8:11], s40 offen offset:3072 sc1
    v_mfma_f32_16x16x32_bf16 a[172:175], v[100:103], v[148:151], a[172:175]
    ds_read_b128 v[216:219], v254 offset:13312
    v_mfma_f32_16x16x32_bf16 a[204:207], v[100:103], v[152:155], a[204:207]
    s_waitcnt lgkmcnt(8)
    v_mfma_f32_16x16x32_bf16 a[8:11], v[104:107], v[192:195], a[8:11]
    s_bitcmp1_b32 s45, 1
    s_cselect_b32 s40, 0x7000, s49
    v_mfma_f32_16x16x32_bf16 a[40:43], v[104:107], v[196:199], a[40:43]
    ds_read_b128 v[128:131], v254 offset:14336
    v_mfma_f32_16x16x32_bf16 a[72:75], v[104:107], v[200:203], a[72:75]
    s_waitcnt lgkmcnt(4)
    ds_read_b128 v[132:135], v254 offset:15360
    v_mfma_f32_16x16x32_bf16 a[104:107], v[104:107], v[204:207], a[104:107]
    s_waitcnt lgkmcnt(4)
    v_mfma_f32_16x16x32_bf16 a[136:139], v[104:107], v[208:211], a[136:139]
    s_waitcnt lgkmcnt(3)
    buffer_load_dwordx4 v[16:19], v247, s[8:11], s40 offen sc1
    v_mfma_f32_16x16x32_bf16 a[168:171], v[104:107], v[212:215], a[168:171]
    s_waitcnt lgkmcnt(2)
    ds_read_b128 v[136:139], v254 offset:16384
    v_mfma_f32_16x16x32_bf16 a[200:203], v[104:107], v[216:219], a[200:203]
    ds_read_b128 v[140:143], v254 offset:17408
    v_mfma_f32_16x16x32_bf16 a[12:15], v[108:111], v[192:195], a[12:15]
    v_mfma_f32_16x16x32_bf16 a[44:47], v[108:111], v[196:199], a[44:47]
    ds_read_b128 v[144:147], v254 offset:18432
    v_mfma_f32_16x16x32_bf16 a[76:79], v[108:111], v[200:203], a[76:79]
    v_mfma_f32_16x16x32_bf16 a[108:111], v[108:111], v[204:207], a[108:111]
    ds_read_b128 v[148:151], v254 offset:19456
    v_mfma_f32_16x16x32_bf16 a[140:143], v[108:111], v[208:211], a[140:143]
    v_mfma_f32_16x16x32_bf16 a[172:175], v[108:111], v[212:215], a[172:175]
    ds_read_b128 v[152:155], v254 offset:20480
    v_mfma_f32_16x16x32_bf16 a[204:207], v[108:111], v[216:219], a[204:207]
    s_waitcnt lgkmcnt(5)
    buffer_load_dwordx4 v[20:23], v251, s[8:11], s40 offen offset:1024 sc1
    v_mfma_f32_16x16x32_bf16 a[8:11], v[112:115], v[128:131], a[8:11]
    s_waitcnt vmcnt(17)
    ds_read_b64_tr_b16 v[96:97], v252 offset:4096
    v_mfma_f32_16x16x32_bf16 a[40:43], v[112:115], v[132:135], a[40:43]
    s_waitcnt lgkmcnt(4)
    ds_read_b64_tr_b16 v[98:99], v252 offset:5120
    v_mfma_f32_16x16x32_bf16 a[72:75], v[112:115], v[136:139], a[72:75]
    ds_read_b64_tr_b16 v[100:101], v253 offset:4096
    v_mfma_f32_16x16x32_bf16 a[104:107], v[112:115], v[140:143], a[104:107]
    s_waitcnt lgkmcnt(5)
    ds_read_b64_tr_b16 v[102:103], v253 offset:5120
    v_mfma_f32_16x16x32_bf16 a[136:139], v[112:115], v[144:147], a[136:139]
    s_waitcnt lgkmcnt(5)
    ds_read_b64_tr_b16 v[104:105], v252 offset:6144
    v_mfma_f32_16x16x32_bf16 a[168:171], v[112:115], v[148:151], a[168:171]
    s_waitcnt lgkmcnt(5)
    ds_read_b64_tr_b16 v[106:107], v252 offset:7168
    v_mfma_f32_16x16x32_bf16 a[200:203], v[112:115], v[152:155], a[200:203]
    buffer_load_dwordx4 v[24:27], v251, s[8:11], s40 offen offset:2048 sc1
    v_mfma_f32_16x16x32_bf16 a[12:15], v[116:119], v[128:131], a[12:15]
    s_nop 0
    ds_read_b64_tr_b16 v[108:109], v253 offset:6144
    ds_read_b64_tr_b16 v[110:111], v253 offset:7168
    v_mfma_f32_16x16x32_bf16 a[44:47], v[116:119], v[132:135], a[44:47]
    v_mfma_f32_16x16x32_bf16 a[76:79], v[116:119], v[136:139], a[76:79]
    v_mfma_f32_16x16x32_bf16 a[108:111], v[116:119], v[140:143], a[108:111]
    v_mfma_f32_16x16x32_bf16 a[140:143], v[116:119], v[144:147], a[140:143]
    v_mfma_f32_16x16x32_bf16 a[172:175], v[116:119], v[148:151], a[172:175]
    v_mfma_f32_16x16x32_bf16 a[204:207], v[116:119], v[152:155], a[204:207]
    v_mfma_f32_16x16x32_bf16 a[8:11], v[120:123], a[16:19], a[8:11]
    buffer_load_dwordx4 v[28:31], v251, s[8:11], s40 offen offset:3072 sc1
    v_mfma_f32_16x16x32_bf16 a[40:43], v[120:123], a[48:51], a[40:43]
    s_lshl_b32 s42, s70, 7
    v_mfma_f32_16x16x32_bf16 a[72:75], v[120:123], a[80:83], a[72:75]
    s_lshl4_add_u32 s42, s66, s42
    v_mfma_f32_16x16x32_bf16 a[104:107], v[120:123], a[112:115], a[104:107]
    s_waitcnt vmcnt(8)
    buffer_store_dwordx2 v[240:241], off, s[20:23], s42 offset:128 sc1
    v_mfma_f32_16x16x32_bf16 a[136:139], v[120:123], a[144:147], a[136:139]
    v_mfma_f32_16x16x32_bf16 a[168:171], v[120:123], a[176:179], a[168:171]
    v_mfma_f32_16x16x32_bf16 a[200:203], v[120:123], a[208:211], a[200:203]
    v_mfma_f32_16x16x32_bf16 a[12:15], v[124:127], a[16:19], a[12:15]
    v_mfma_f32_16x16x32_bf16 a[44:47], v[124:127], a[48:51], a[44:47]
    v_mfma_f32_16x16x32_bf16 a[76:79], v[124:127], a[80:83], a[76:79]
    v_mfma_f32_16x16x32_bf16 a[108:111], v[124:127], a[112:115], a[108:111]
    v_mfma_f32_16x16x32_bf16 a[140:143], v[124:127], a[144:147], a[140:143]
    v_mfma_f32_16x16x32_bf16 a[172:175], v[124:127], a[176:179], a[172:175]
    v_mfma_f32_16x16x32_bf16 a[204:207], v[124:127], a[208:211], a[204:207]
    s_waitcnt lgkmcnt(0)
    v_mfma_f32_16x16x32_bf16 a[8:11], v[96:99], a[20:23], a[8:11]
    ds_read_b64_tr_b16 v[112:113], v252 offset:8192
    v_mfma_f32_16x16x32_bf16 a[40:43], v[96:99], a[52:55], a[40:43]
    ds_read_b64_tr_b16 v[114:115], v252 offset:9216
    v_mfma_f32_16x16x32_bf16 a[72:75], v[96:99], a[84:87], a[72:75]
    ds_read_b64_tr_b16 v[116:117], v253 offset:8192
    v_mfma_f32_16x16x32_bf16 a[104:107], v[96:99], a[116:119], a[104:107]
    ds_read_b64_tr_b16 v[118:119], v253 offset:9216
    v_mfma_f32_16x16x32_bf16 a[136:139], v[96:99], a[148:151], a[136:139]
    ds_read_b64_tr_b16 v[120:121], v252 offset:10240
    v_mfma_f32_16x16x32_bf16 a[168:171], v[96:99], a[180:183], a[168:171]
    ds_read_b64_tr_b16 v[122:123], v252 offset:11264
    v_mfma_f32_16x16x32_bf16 a[200:203], v[96:99], a[212:215], a[200:203]
    ds_read_b64_tr_b16 v[124:125], v253 offset:10240
    v_mfma_f32_16x16x32_bf16 a[12:15], v[100:103], a[20:23], a[12:15]
    ds_read_b64_tr_b16 v[126:127], v253 offset:11264
    v_mfma_f32_16x16x32_bf16 a[44:47], v[100:103], a[52:55], a[44:47]
    v_mfma_f32_16x16x32_bf16 a[76:79], v[100:103], a[84:87], a[76:79]
    v_mfma_f32_16x16x32_bf16 a[108:111], v[100:103], a[116:119], a[108:111]
    v_mfma_f32_16x16x32_bf16 a[140:143], v[100:103], a[148:151], a[140:143]
    v_mfma_f32_16x16x32_bf16 a[172:175], v[100:103], a[180:183], a[172:175]
    v_mfma_f32_16x16x32_bf16 a[204:207], v[100:103], a[212:215], a[204:207]
    v_mfma_f32_16x16x32_bf16 a[8:11], v[104:107], a[24:27], a[8:11]
    v_mfma_f32_16x16x32_bf16 a[40:43], v[104:107], a[56:59], a[40:43]
    v_mfma_f32_16x16x32_bf16 a[72:75], v[104:107], a[88:91], a[72:75]
    v_mfma_f32_16x16x32_bf16 a[104:107], v[104:107], a[120:123], a[104:107]
    v_mfma_f32_16x16x32_bf16 a[136:139], v[104:107], a[152:155], a[136:139]
    v_mfma_f32_16x16x32_bf16 a[168:171], v[104:107], a[184:187], a[168:171]
    v_mfma_f32_16x16x32_bf16 a[200:203], v[104:107], a[216:219], a[200:203]
    v_mfma_f32_16x16x32_bf16 a[12:15], v[108:111], a[24:27], a[12:15]
    v_mfma_f32_16x16x32_bf16 a[44:47], v[108:111], a[56:59], a[44:47]
    v_mfma_f32_16x16x32_bf16 a[76:79], v[108:111], a[88:91], a[76:79]
    v_mfma_f32_16x16x32_bf16 a[108:111], v[108:111], a[120:123], a[108:111]
    v_mfma_f32_16x16x32_bf16 a[140:143], v[108:111], a[152:155], a[140:143]
    v_mfma_f32_16x16x32_bf16 a[172:175], v[108:111], a[184:187], a[172:175]
    v_mfma_f32_16x16x32_bf16 a[204:207], v[108:111], a[216:219], a[204:207]
    s_waitcnt lgkmcnt(0)
    v_mfma_f32_16x16x32_bf16 a[8:11], v[112:115], a[28:31], a[8:11]
    v_mfma_f32_16x16x32_bf16 a[40:43], v[112:115], a[60:63], a[40:43]
    v_mfma_f32_16x16x32_bf16 a[72:75], v[112:115], a[92:95], a[72:75]
    v_mfma_f32_16x16x32_bf16 a[104:107], v[112:115], a[124:127], a[104:107]
    v_mfma_f32_16x16x32_bf16 a[136:139], v[112:115], a[156:159], a[136:139]
    v_mfma_f32_16x16x32_bf16 a[168:171], v[112:115], a[188:191], a[168:171]
    v_mfma_f32_16x16x32_bf16 a[200:203], v[112:115], a[220:223], a[200:203]
    v_mfma_f32_16x16x32_bf16 a[12:15], v[116:119], a[28:31], a[12:15]
    v_mfma_f32_16x16x32_bf16 a[44:47], v[116:119], a[60:63], a[44:47]
    v_mfma_f32_16x16x32_bf16 a[76:79], v[116:119], a[92:95], a[76:79]
    v_mfma_f32_16x16x32_bf16 a[108:111], v[116:119], a[124:127], a[108:111]
    v_mfma_f32_16x16x32_bf16 a[140:143], v[116:119], a[156:159], a[140:143]
    v_mfma_f32_16x16x32_bf16 a[172:175], v[116:119], a[188:191], a[172:175]
    v_mfma_f32_16x16x32_bf16 a[204:207], v[116:119], a[220:223], a[204:207]
    v_mfma_f32_16x16x32_bf16 a[8:11], v[120:123], a[224:227], a[8:11]
    v_mfma_f32_16x16x32_bf16 a[40:43], v[120:123], a[228:231], a[40:43]
    v_mfma_f32_16x16x32_bf16 a[72:75], v[120:123], a[232:235], a[72:75]
    v_mfma_f32_16x16x32_bf16 a[104:107], v[120:123], a[236:239], a[104:107]
    v_mfma_f32_16x16x32_bf16 a[136:139], v[120:123], a[240:243], a[136:139]
    v_mfma_f32_16x16x32_bf16 a[168:171], v[120:123], a[244:247], a[168:171]
    v_mfma_f32_16x16x32_bf16 a[200:203], v[120:123], a[248:251], a[200:203]
    v_mfma_f32_16x16x32_bf16 a[12:15], v[124:127], a[224:227], a[12:15]
    v_mfma_f32_16x16x32_bf16 a[44:47], v[124:127], a[228:231], a[44:47]
    v_mfma_f32_16x16x32_bf16 a[76:79], v[124:127], a[232:235], a[76:79]
    v_mfma_f32_16x16x32_bf16 a[108:111], v[124:127], a[236:239], a[108:111]
    v_mfma_f32_16x16x32_bf16 a[140:143], v[124:127], a[240:243], a[140:143]
    v_mfma_f32_16x16x32_bf16 a[172:175], v[124:127], a[244:247], a[172:175]
    v_mfma_f32_16x16x32_bf16 a[204:207], v[124:127], a[248:251], a[204:207]
    s_mul_i32 s46, s67, 896
    s_add_u32 s46, s46, 0x2a000
    s_bfe_u32 s80, s59, 0x40000
    s_lshl_b32 s80, s80, 10
    s_add_u32 s80, s80, s46
    v_accvgpr_read_b32 v72, a8
    v_accvgpr_read_b32 v73, a9
    v_accvgpr_read_b32 v74, a10
    v_accvgpr_read_b32 v75, a11
    v_accvgpr_read_b32 v76, a12
    v_accvgpr_read_b32 v77, a13
    v_accvgpr_read_b32 v78, a14
    v_accvgpr_read_b32 v79, a15
    v_cvt_pk_bf16_f32 v84, v72, v73
    v_cvt_pk_bf16_f32 v85, v74, v75
    v_cvt_pk_bf16_f32 v86, v76, v77
    v_cvt_pk_bf16_f32 v87, v78, v79
    buffer_store_dwordx4 v[84:87], v251, s[28:31], s80 offen sc1
    s_bfe_u32 s80, s59, 0x40004
    s_lshl_b32 s80, s80, 10
    s_add_u32 s80, s80, s46
    v_accvgpr_read_b32 v64, a40
    v_accvgpr_read_b32 v65, a41
    v_accvgpr_read_b32 v66, a42
    v_accvgpr_read_b32 v67, a43
    v_accvgpr_read_b32 v68, a44
    v_accvgpr_read_b32 v69, a45
    v_accvgpr_read_b32 v70, a46
    v_accvgpr_read_b32 v71, a47
    v_cvt_pk_bf16_f32 v88, v64, v65
    v_cvt_pk_bf16_f32 v89, v66, v67
    v_cvt_pk_bf16_f32 v90, v68, v69
    v_cvt_pk_bf16_f32 v91, v70, v71
    buffer_store_dwordx4 v[88:91], v251, s[28:31], s80 offen sc1
    s_bfe_u32 s80, s59, 0x40008
    s_lshl_b32 s80, s80, 10
    s_add_u32 s80, s80, s46
    v_accvgpr_read_b32 v72, a72
    v_accvgpr_read_b32 v73, a73
    v_accvgpr_read_b32 v74, a74
    v_accvgpr_read_b32 v75, a75
    v_accvgpr_read_b32 v76, a76
    v_accvgpr_read_b32 v77, a77
    v_accvgpr_read_b32 v78, a78
    v_accvgpr_read_b32 v79, a79
    v_cvt_pk_bf16_f32 v92, v72, v73
    v_cvt_pk_bf16_f32 v93, v74, v75
    v_cvt_pk_bf16_f32 v94, v76, v77
    v_cvt_pk_bf16_f32 v95, v78, v79
    buffer_store_dwordx4 v[92:95], v251, s[28:31], s80 offen sc1
    s_bfe_u32 s80, s59, 0x4000c
    s_lshl_b32 s80, s80, 10
    s_add_u32 s80, s80, s46
    v_accvgpr_read_b32 v64, a104
    v_accvgpr_read_b32 v65, a105
    v_accvgpr_read_b32 v66, a106
    v_accvgpr_read_b32 v67, a107
    v_accvgpr_read_b32 v68, a108
    v_accvgpr_read_b32 v69, a109
    v_accvgpr_read_b32 v70, a110
    v_accvgpr_read_b32 v71, a111
    v_cvt_pk_bf16_f32 v80, v64, v65
    v_cvt_pk_bf16_f32 v81, v66, v67
    v_cvt_pk_bf16_f32 v82, v68, v69
    v_cvt_pk_bf16_f32 v83, v70, v71
    buffer_store_dwordx4 v[80:83], v246, s[28:31], s80 offen sc1
    buffer_load_dwordx2 v[242:243], v249, s[20:23], s43 offen sc1
    s_lshl_b32 s42, s70, 7
    s_lshl4_add_u32 s42, s67, s42
    s_waitcnt vmcnt(1)
    buffer_store_dwordx2 v[240:241], off, s[20:23], s42 offset:384 sc1
    s_or_b32 s52, s48, s75
    s_andn2_b32 s44, 0xff, s52
    s_mov_b32 s72, s75
    s_mov_b32 s74, 0x20000
L_red:
    s_xor_b32 s52, s44, 0xff
    s_add_u32 s53, s52, 1
    s_xor_b32 s53, s53, s52
    s_lshr_b32 s53, s53, 1
    s_andn2_b32 s73, s53, s72
    s_or_b32 s72, s72, s53
    s_waitcnt vmcnt(0) lgkmcnt(0)
    v_cmp_eq_u64 vcc, v[242:243], v[240:241]
    s_nop 4
    s_and_b32 s45, vcc_lo, s44
    s_bitcmp1_b32 s45, 0
    s_cbranch_scc0 L_nl0
    s_mov_b32 s40, 0
    buffer_load_dwordx4 v[0:3], v247, s[8:11], s40 offen sc1
    buffer_load_dwordx4 v[4:7], v251, s[8:11], s40 offen offset:1024 sc1
    buffer_load_dwordx4 v[8:11], v251, s[8:11], s40 offen offset:2048 sc1
    buffer_load_dwordx4 v[12:15], v251, s[8:11], s40 offen offset:3072 sc1
L_nl0:
    s_bitcmp1_b32 s45, 1
    s_cbranch_scc0 L_nl1
    s_mov_b32 s40, 0x7000
    buffer_load_dwordx4 v[16:19], v247, s[8:11], s40 offen sc1
    buffer_load_dwordx4 v[20:23], v251, s[8:11], s40 offen offset:1024 sc1
    buffer_load_dwordx4 v[24:27], v251, s[8:11], s40 offen offset:2048 sc1
    buffer_load_dwordx4 v[28:31], v251, s[8:11], s40 offen offset:3072 sc1
L_nl1:
    s_bitcmp1_b32 s45, 2
    s_cbranch_scc0 L_nl2
    s_mov_b32 s40, 0xe000
    buffer_load_dwordx4 v[32:35], v247, s[8:11], s40 offen sc1
    buffer_load_dwordx4 v[36:39], v251, s[8:11], s40 offen offset:1024 sc1
    buffer_load_dwordx4 v[40:43], v251, s[8:11], s40 offen offset:2048 sc1
    buffer_load_dwordx4 v[44:47], v251, s[8:11], s40 offen offset:3072 sc1
L_nl2:
    s_bitcmp1_b32 s45, 3
    s_cbranch_scc0 L_nl3
    s_mov_b32 s40, 0x15000
    buffer_load_dwordx4 v[48:51], v247, s[8:11], s40 offen sc1
    buffer_load_dwordx4 v[52:55], v251, s[8:11], s40 offen offset:1024 sc1
    buffer_load_dwordx4 v[56:59], v251, s[8:11], s40 offen offset:2048 sc1
    buffer_load_dwordx4 v[60:63], v251, s[8:11], s40 offen offset:3072 sc1
L_nl3:
    s_bitcmp1_b32 s45, 4
    s_cbranch_scc0 L_nl4
    s_mov_b32 s40, 0x1c000
    buffer_load_dwordx4 v[160:163], v247, s[8:11], s40 offen sc1
    buffer_load_dwordx4 v[164:167], v251, s[8:11], s40 offen offset:1024 sc1
    buffer_load_dwordx4 v[168:171], v251, s[8:11], s40 offen offset:2048 sc1
    buffer_load_dwordx4 v[172:175], v251, s[8:11], s40 offen offset:3072 sc1
L_nl4:
    s_bitcmp1_b32 s45, 5
    s_cbranch_scc0 L_nl5
    s_mov_b32 s40, 0x23000
    buffer_load_dwordx4 v[176:179], v247, s[8:11], s40 offen sc1
    buffer_load_dwordx4 v[180:183], v251, s[8:11], s40 offen offset:1024 sc1
    buffer_load_dwordx4 v[184:187], v251, s[8:11], s40 offen offset:2048 sc1
    buffer_load_dwordx4 v[188:191], v251, s[8:11], s40 offen offset:3072 sc1
L_nl5:
    s_bitcmp1_b32 s45, 6
    s_cbranch_scc0 L_nl6
    s_mov_b32 s40, 0x2a000
    buffer_load_dwordx4 v[220:223], v247, s[8:11], s40 offen sc1
    buffer_load_dwordx4 v[224:227], v251, s[8:11], s40 offen offset:1024 sc1
    buffer_load_dwordx4 v[228:231], v251, s[8:11], s40 offen offset:2048 sc1
    buffer_load_dwordx4 v[156:159], v251, s[8:11], s40 offen offset:3072 sc1
L_nl6:
    s_bitcmp1_b32 s45, 7
    s_cbranch_scc0 L_nl7
    s_mov_b32 s40, 0x31000
    s_waitcnt vmcnt(3)
    buffer_load_dwordx4 v[220:223], v247, s[8:11], s40 offen sc1
    s_waitcnt vmcnt(3)
    buffer_load_dwordx4 v[224:227], v251, s[8:11], s40 offen offset:1024 sc1
    s_waitcnt vmcnt(3)
    buffer_load_dwordx4 v[228:231], v251, s[8:11], s40 offen offset:2048 sc1
    s_waitcnt vmcnt(3)
    buffer_load_dwordx4 v[156:159], v251, s[8:11], s40 offen offset:3072 sc1
L_nl7:
    s_cmp_eq_u32 s44, s45
    s_cbranch_scc1 L_nof
    buffer_load_dwordx2 v[242:243], v249, s[20:23], s43 offen sc1
L_nof:
    s_bitcmp1_b32 s73, 0
    s_cbranch_scc0 L_na0
    v_mfma_f32_16x16x32_bf16 a[104:107], v[234:237], v[0:3], a[104:107]
    v_mfma_f32_16x16x32_bf16 a[108:111], v[232:235], v[0:3], a[108:111]
    v_mfma_f32_16x16x32_bf16 a[136:139], v[234:237], v[4:7], a[136:139]
    v_mfma_f32_16x16x32_bf16 a[140:143], v[232:235], v[4:7], a[140:143]
    v_mfma_f32_16x16x32_bf16 a[168:171], v[234:237], v[8:11], a[168:171]
    v_mfma_f32_16x16x32_bf16 a[172:175], v[232:235], v[8:11], a[172:175]
    v_mfma_f32_16x16x32_bf16 a[200:203], v[234:237], v[12:15], a[200:203]
    v_mfma_f32_16x16x32_bf16 a[204:207], v[232:235], v[12:15], a[204:207]
L_na0:
    s_bitcmp1_b32 s73, 1
    s_cbranch_scc0 L_na1
    v_mfma_f32_16x16x32_bf16 a[104:107], v[234:237], v[16:19], a[104:107]
    v_mfma_f32_16x16x32_bf16 a[108:111], v[232:235], v[16:19], a[108:111]
    v_mfma_f32_16x16x32_bf16 a[136:139], v[234:237], v[20:23], a[136:139]
    v_mfma_f32_16x16x32_bf16 a[140:143], v[232:235], v[20:23], a[140:143]
    v_mfma_f32_16x16x32_bf16 a[168:171], v[234:237], v[24:27], a[168:171]
    v_mfma_f32_16x16x32_bf16 a[172:175], v[232:235], v[24:27], a[172:175]
    v_mfma_f32_16x16x32_bf16 a[200:203], v[234:237], v[28:31], a[200:203]
    v_mfma_f32_16x16x32_bf16 a[204:207], v[232:235], v[28:31], a[204:207]
L_na1:
    s_bitcmp1_b32 s73, 2
    s_cbranch_scc0 L_na2
    v_mfma_f32_16x16x32_bf16 a[104:107], v[234:237], v[32:35], a[104:107]
    v_mfma_f32_16x16x32_bf16 a[108:111], v[232:235], v[32:35], a[108:111]
    v_mfma_f32_16x16x32_bf16 a[136:139], v[234:237], v[36:39], a[136:139]
    v_mfma_f32_16x16x32_bf16 a[140:143], v[232:235], v[36:39], a[140:143]
    v_mfma_f32_16x16x32_bf16 a[168:171], v[234:237], v[40:43], a[168:171]
    v_mfma_f32_16x16x32_bf16 a[172:175], v[232:235], v[40:43], a[172:175]
    v_mfma_f32_16x16x32_bf16 a[200:203], v[234:237], v[44:47], a[200:203]
    v_mfma_f32_16x16x32_bf16 a[204:207], v[232:235], v[44:47], a[204:207]
L_na2:
    s_bitcmp1_b32 s73, 3
    s_cbranch_scc0 L_na3
    v_mfma_f32_16x16x32_bf16 a[104:107], v[234:237], v[48:51], a[104:107]
    v_mfma_f32_16x16x32_bf16 a[108:111], v[232:235], v[48:51], a[108:111]
    v_mfma_f32_16x16x32_bf16 a[136:139], v[234:237], v[52:55], a[136:139]
    v_mfma_f32_16x16x32_bf16 a[140:143], v[232:235], v[52:55], a[140:143]
    v_mfma_f32_16x16x32_bf16 a[168:171], v[234:237], v[56:59], a[168:171]
    v_mfma_f32_16x16x32_bf16 a[172:175], v[232:235], v[56:59], a[172:175]
    v_mfma_f32_16x16x32_bf16 a[200:203], v[234:237], v[60:63], a[200:203]
    v_mfma_f32_16x16x32_bf16 a[204:207], v[232:235], v[60:63], a[204:207]
L_na3:
    s_bitcmp1_b32 s73, 4
    s_cbranch_scc0 L_na4
    v_mfma_f32_16x16x32_bf16 a[104:107], v[234:237], v[160:163], a[104:107]
    v_mfma_f32_16x16x32_bf16 a[108:111], v[232:235], v[160:163], a[108:111]
    v_mfma_f32_16x16x32_bf16 a[136:139], v[234:237], v[164:167], a[136:139]
    v_mfma_f32_16x16x32_bf16 a[140:143], v[232:235], v[164:167], a[140:143]
    v_mfma_f32_16x16x32_bf16 a[168:171], v[234:237], v[168:171], a[168:171]
    v_mfma_f32_16x16x32_bf16 a[172:175], v[232:235], v[168:171], a[172:175]
    v_mfma_f32_16x16x32_bf16 a[200:203], v[234:237], v[172:175], a[200:203]
    v_mfma_f32_16x16x32_bf16 a[204:207], v[232:235], v[172:175], a[204:207]
L_na4:
    s_bitcmp1_b32 s73, 5
    s_cbranch_scc0 L_na5
    v_mfma_f32_16x16x32_bf16 a[104:107], v[234:237], v[176:179], a[104:107]
    v_mfma_f32_16x16x32_bf16 a[108:111], v[232:235], v[176:179], a[108:111]
    v_mfma_f32_16x16x32_bf16 a[136:139], v[234:237], v[180:183], a[136:139]
    v_mfma_f32_16x16x32_bf16 a[140:143], v[232:235], v[180:183], a[140:143]
    v_mfma_f32_16x16x32_bf16 a[168:171], v[234:237], v[184:187], a[168:171]
    v_mfma_f32_16x16x32_bf16 a[172:175], v[232:235], v[184:187], a[172:175]
    v_mfma_f32_16x16x32_bf16 a[200:203], v[234:237], v[188:191], a[200:203]
    v_mfma_f32_16x16x32_bf16 a[204:207], v[232:235], v[188:191], a[204:207]
L_na5:
    s_bitcmp1_b32 s73, 6
    s_cbranch_scc0 L_na6
    v_mfma_f32_16x16x32_bf16 a[104:107], v[234:237], v[220:223], a[104:107]
    v_mfma_f32_16x16x32_bf16 a[108:111], v[232:235], v[220:223], a[108:111]
    v_mfma_f32_16x16x32_bf16 a[136:139], v[234:237], v[224:227], a[136:139]
    v_mfma_f32_16x16x32_bf16 a[140:143], v[232:235], v[224:227], a[140:143]
    v_mfma_f32_16x16x32_bf16 a[168:171], v[234:237], v[228:231], a[168:171]
    v_mfma_f32_16x16x32_bf16 a[172:175], v[232:235], v[228:231], a[172:175]
    v_mfma_f32_16x16x32_bf16 a[200:203], v[234:237], v[156:159], a[200:203]
    v_mfma_f32_16x16x32_bf16 a[204:207], v[232:235], v[156:159], a[204:207]
L_na6:
    s_bitcmp1_b32 s73, 7
    s_cbranch_scc0 L_na7
    v_mfma_f32_16x16x32_bf16 a[104:107], v[234:237], v[220:223], a[104:107]
    v_mfma_f32_16x16x32_bf16 a[108:111], v[232:235], v[220:223], a[108:111]
    v_mfma_f32_16x16x32_bf16 a[136:139], v[234:237], v[224:227], a[136:139]
    v_mfma_f32_16x16x32_bf16 a[140:143], v[232:235], v[224:227], a[140:143]
    v_mfma_f32_16x16x32_bf16 a[168:171], v[234:237], v[228:231], a[168:171]
    v_mfma_f32_16x16x32_bf16 a[172:175], v[232:235], v[228:231], a[172:175]
    v_mfma_f32_16x16x32_bf16 a[200:203], v[234:237], v[156:159], a[200:203]
    v_mfma_f32_16x16x32_bf16 a[204:207], v[232:235], v[156:159], a[204:207]
L_na7:
    s_cmp_eq_u32 s44, 0
    s_cbranch_scc1 L_fin
    s_andn2_b32 s44, s44, s45
    s_sub_u32 s74, s74, 1
    s_cmp_lg_u32 s74, 0
    s_cbranch_scc1 L_red
L_fin:
    s_nop 15
    v_accvgpr_read_b32 v112, a104
    v_accvgpr_read_b32 v113, a105
    v_accvgpr_read_b32 v114, a106
    v_accvgpr_read_b32 v115, a107
    v_accvgpr_read_b32 v116, a108
    v_accvgpr_read_b32 v117, a109
    v_accvgpr_read_b32 v118, a110
    v_accvgpr_read_b32 v119, a111
    v_cvt_pk_bf16_f32 v64, v112, v113
    v_cvt_pk_bf16_f32 v65, v114, v115
    v_cvt_pk_bf16_f32 v66, v116, v117
    v_cvt_pk_bf16_f32 v67, v118, v119
    s_nop 0
    v_permlane16_swap_b32 v64, v66
    v_permlane16_swap_b32 v65, v67
    buffer_store_dwordx4 v[64:67], v255, s[16:19], s47 offen
    s_mov_b32 s41, 0x8000
    v_accvgpr_read_b32 v120, a136
    v_accvgpr_read_b32 v121, a137
    v_accvgpr_read_b32 v122, a138
    v_accvgpr_read_b32 v123, a139
    v_accvgpr_read_b32 v124, a140
    v_accvgpr_read_b32 v125, a141
    v_accvgpr_read_b32 v126, a142
    v_accvgpr_read_b32 v127, a143
    v_cvt_pk_bf16_f32 v68, v120, v121
    v_cvt_pk_bf16_f32 v69, v122, v123
    v_cvt_pk_bf16_f32 v70, v124, v125
    v_cvt_pk_bf16_f32 v71, v126, v127
    s_nop 0
    v_permlane16_swap_b32 v68, v70
    v_permlane16_swap_b32 v69, v71
    buffer_store_dwordx4 v[68:71], v255, s[16:19], s41 offen
    s_mov_b32 s41, 0x10000
    v_accvgpr_read_b32 v128, a168
    v_accvgpr_read_b32 v129, a169
    v_accvgpr_read_b32 v130, a170
    v_accvgpr_read_b32 v131, a171
    v_accvgpr_read_b32 v132, a172
    v_accvgpr_read_b32 v133, a173
    v_accvgpr_read_b32 v134, a174
    v_accvgpr_read_b32 v135, a175
    v_cvt_pk_bf16_f32 v72, v128, v129
    v_cvt_pk_bf16_f32 v73, v130, v131
    v_cvt_pk_bf16_f32 v74, v132, v133
    v_cvt_pk_bf16_f32 v75, v134, v135
    s_nop 0
    v_permlane16_swap_b32 v72, v74
    v_permlane16_swap_b32 v73, v75
    buffer_store_dwordx4 v[72:75], v255, s[16:19], s41 offen
    s_mov_b32 s41, 0x18000
    v_accvgpr_read_b32 v136, a200
    v_accvgpr_read_b32 v137, a201
    v_accvgpr_read_b32 v138, a202
    v_accvgpr_read_b32 v139, a203
    v_accvgpr_read_b32 v140, a204
    v_accvgpr_read_b32 v141, a205
    v_accvgpr_read_b32 v142, a206
    v_accvgpr_read_b32 v143, a207
    v_cvt_pk_bf16_f32 v76, v136, v137
    v_cvt_pk_bf16_f32 v77, v138, v139
    v_cvt_pk_bf16_f32 v78, v140, v141
    v_cvt_pk_bf16_f32 v79, v142, v143
    s_nop 0
    v_permlane16_swap_b32 v76, v78
    v_permlane16_swap_b32 v77, v79
    buffer_store_dwordx4 v[76:79], v255, s[16:19], s41 offen
L_end:
    s_endpgm
L_npoll:
    s_mov_b32 s52, 0x20000
L_npl:
    buffer_load_dwordx2 v[240:241], off, s[76:79], 0 sc0 sc1
    s_sub_u32 s52, s52, 1
    s_waitcnt vmcnt(0)
    s_cmp_eq_u32 s52, 0
    s_cbranch_scc1 L_nok
    v_cmp_eq_u32 vcc, 0, v240
    s_nop 4
    s_cbranch_vccnz L_npl
    s_branch L_nok
L_slow:
    s_waitcnt vmcnt(0) lgkmcnt(0)
    s_mov_b32 s18, 0x20000
    s_mov_b32 s22, 0x20000
    s_mul_i32 s52, s32, 28672
    s_add_u32 s52, s52, 0
    s_add_u32 s53, s52, 8320
    s_sub_u32 s54, s52, s46
    s_sub_u32 s55, s53, s47
    s_mov_b32 s46, s52
    s_mov_b32 s47, s53
    v_add_u32 v240, s54, v240
    v_add_u32 v241, s55, v241
    v_add_u32 v242, s55, v242
    v_add_u32 v243, s55, v243
    v_add_u32 v244, s55, v244
    s_lshl_b32 s52, s32, 12
    s_sub_u32 s8, s8, s52
    s_subb_u32 s9, s9, 0
    s_mov_b32 s10, 0x1c000
    v_lshrrev_b32 v224, 4, v251
    v_and_b32 v225, 15, v224
    v_lshrrev_b32 v226, 4, v224
    v_lshlrev_b32 v226, 6, v226
    v_lshl_add_u32 v255, v225, 10, v226
    v_accvgpr_write_b32 a0, 0
    v_accvgpr_write_b32 a1, 0
    v_accvgpr_write_b32 a2, 0
    v_accvgpr_write_b32 a3, 0
    v_accvgpr_write_b32 a4, 0
    v_accvgpr_write_b32 a5, 0
    v_accvgpr_write_b32 a6, 0
    v_accvgpr_write_b32 a7, 0
    v_accvgpr_write_b32 a8, 0
    v_accvgpr_write_b32 a9, 0
    v_accvgpr_write_b32 a10, 0
    v_accvgpr_write_b32 a11, 0
    v_accvgpr_write_b32 a12, 0
    v_accvgpr_write_b32 a13, 0
    v_accvgpr_write_b32 a14, 0
    v_accvgpr_write_b32 a15, 0
    v_accvgpr_write_b32 a16, 0
    v_accvgpr_write_b32 a17, 0
    v_accvgpr_write_b32 a18, 0
    v_accvgpr_write_b32 a19, 0
    v_accvgpr_write_b32 a20, 0
    v_accvgpr_write_b32 a21, 0
    v_accvgpr_write_b32 a22, 0
    v_accvgpr_write_b32 a23, 0
    v_accvgpr_write_b32 a24, 0
    v_accvgpr_write_b32 a25, 0
    v_accvgpr_write_b32 a26, 0
    v_accvgpr_write_b32 a27, 0
    v_accvgpr_write_b32 a28, 0
    v_accvgpr_write_b32 a29, 0
    v_accvgpr_write_b32 a30, 0
    v_accvgpr_write_b32 a31, 0
    v_accvgpr_write_b32 a32, 0
    v_accvgpr_write_b32 a33, 0
    v_accvgpr_write_b32 a34, 0
    v_accvgpr_write_b32 a35, 0
    v_accvgpr_write_b32 a36, 0
    v_accvgpr_write_b32 a37, 0
    v_accvgpr_write_b32 a38, 0
    v_accvgpr_write_b32 a39, 0
    v_accvgpr_write_b32 a40, 0
    v_accvgpr_write_b32 a41, 0
    v_accvgpr_write_b32 a42, 0
    v_accvgpr_write_b32 a43, 0
    v_accvgpr_write_b32 a44, 0
    v_accvgpr_write_b32 a45, 0
    v_accvgpr_write_b32 a46, 0
    v_accvgpr_write_b32 a47, 0
    v_accvgpr_write_b32 a48, 0
    v_accvgpr_write_b32 a49, 0
    v_accvgpr_write_b32 a50, 0
    v_accvgpr_write_b32 a51, 0
    v_accvgpr_write_b32 a52, 0
    v_accvgpr_write_b32 a53, 0
    v_accvgpr_write_b32 a54, 0
    v_accvgpr_write_b32 a55, 0
    v_accvgpr_write_b32 a56, 0
    v_accvgpr_write_b32 a57, 0
    v_accvgpr_write_b32 a58, 0
    v_accvgpr_write_b32 a59, 0
    v_accvgpr_write_b32 a60, 0
    v_accvgpr_write_b32 a61, 0
    v_accvgpr_write_b32 a62, 0
    v_accvgpr_write_b32 a63, 0
    v_accvgpr_write_b32 a64, 0
    v_accvgpr_write_b32 a65, 0
    v_accvgpr_write_b32 a66, 0
    v_accvgpr_write_b32 a67, 0
    v_accvgpr_write_b32 a68, 0
    v_accvgpr_write_b32 a69, 0
    v_accvgpr_write_b32 a70, 0
    v_accvgpr_write_b32 a71, 0
    v_accvgpr_write_b32 a72, 0
    v_accvgpr_write_b32 a73, 0
    v_accvgpr_write_b32 a74, 0
    v_accvgpr_write_b32 a75, 0
    v_accvgpr_write_b32 a76, 0
    v_accvgpr_write_b32 a77, 0
    v_accvgpr_write_b32 a78, 0
    v_accvgpr_write_b32 a79, 0
    v_accvgpr_write_b32 a80, 0
    v_accvgpr_write_b32 a81, 0
    v_accvgpr_write_b32 a82, 0
    v_accvgpr_write_b32 a83, 0
    v_accvgpr_write_b32 a84, 0
    v_accvgpr_write_b32 a85, 0
    v_accvgpr_write_b32 a86, 0
    v_accvgpr_write_b32 a87, 0
    v_accvgpr_write_b32 a88, 0
    v_accvgpr_write_b32 a89, 0
    v_accvgpr_write_b32 a90, 0
    v_accvgpr_write_b32 a91, 0
    v_accvgpr_write_b32 a92, 0
    v_accvgpr_write_b32 a93, 0
    v_accvgpr_write_b32 a94, 0
    v_accvgpr_write_b32 a95, 0
    v_accvgpr_write_b32 a96, 0
    v_accvgpr_write_b32 a97, 0
    v_accvgpr_write_b32 a98, 0
    v_accvgpr_write_b32 a99, 0
    v_accvgpr_write_b32 a100, 0
    v_accvgpr_write_b32 a101, 0
    v_accvgpr_write_b32 a102, 0
    v_accvgpr_write_b32 a103, 0
    v_accvgpr_write_b32 a104, 0
    v_accvgpr_write_b32 a105, 0
    v_accvgpr_write_b32 a106, 0
    v_accvgpr_write_b32 a107, 0
    v_accvgpr_write_b32 a108, 0
    v_accvgpr_write_b32 a109, 0
    v_accvgpr_write_b32 a110, 0
    v_accvgpr_write_b32 a111, 0
    v_accvgpr_write_b32 a112, 0
    v_accvgpr_write_b32 a113, 0
    v_accvgpr_write_b32 a114, 0
    v_accvgpr_write_b32 a115, 0
    v_accvgpr_write_b32 a116, 0
    v_accvgpr_write_b32 a117, 0
    v_accvgpr_write_b32 a118, 0
    v_accvgpr_write_b32 a119, 0
    v_accvgpr_write_b32 a120, 0
    v_accvgpr_write_b32 a121, 0
    v_accvgpr_write_b32 a122, 0
    v_accvgpr_write_b32 a123, 0
    v_accvgpr_write_b32 a124, 0
    v_accvgpr_write_b32 a125, 0
    v_accvgpr_write_b32 a126, 0
    v_accvgpr_write_b32 a127, 0
    v_accvgpr_write_b32 a128, 0
    v_accvgpr_write_b32 a129, 0
    v_accvgpr_write_b32 a130, 0
    v_accvgpr_write_b32 a131, 0
    v_accvgpr_write_b32 a132, 0
    v_accvgpr_write_b32 a133, 0
    v_accvgpr_write_b32 a134, 0
    v_accvgpr_write_b32 a135, 0
    v_accvgpr_write_b32 a136, 0
    v_accvgpr_write_b32 a137, 0
    v_accvgpr_write_b32 a138, 0
    v_accvgpr_write_b32 a139, 0
    v_accvgpr_write_b32 a140, 0
    v_accvgpr_write_b32 a141, 0
    v_accvgpr_write_b32 a142, 0
    v_accvgpr_write_b32 a143, 0
    v_accvgpr_write_b32 a144, 0
    v_accvgpr_write_b32 a145, 0
    v_accvgpr_write_b32 a146, 0
    v_accvgpr_write_b32 a147, 0
    v_accvgpr_write_b32 a148, 0
    v_accvgpr_write_b32 a149, 0
    v_accvgpr_write_b32 a150, 0
    v_accvgpr_write_b32 a151, 0
    v_accvgpr_write_b32 a152, 0
    v_accvgpr_write_b32 a153, 0
    v_accvgpr_write_b32 a154, 0
    v_accvgpr_write_b32 a155, 0
    v_accvgpr_write_b32 a156, 0
    v_accvgpr_write_b32 a157, 0
    v_accvgpr_write_b32 a158, 0
    v_accvgpr_write_b32 a159, 0
    v_accvgpr_write_b32 a160, 0
    v_accvgpr_write_b32 a161, 0
    v_accvgpr_write_b32 a162, 0
    v_accvgpr_write_b32 a163, 0
    v_accvgpr_write_b32 a164, 0
    v_accvgpr_write_b32 a165, 0
    v_accvgpr_write_b32 a166, 0
    v_accvgpr_write_b32 a167, 0
    v_accvgpr_write_b32 a168, 0
    v_accvgpr_write_b32 a169, 0
    v_accvgpr_write_b32 a170, 0
    v_accvgpr_write_b32 a171, 0
    v_accvgpr_write_b32 a172, 0
    v_accvgpr_write_b32 a173, 0
    v_accvgpr_write_b32 a174, 0
    v_accvgpr_write_b32 a175, 0
    v_accvgpr_write_b32 a176, 0
    v_accvgpr_write_b32 a177, 0
    v_accvgpr_write_b32 a178, 0
    v_accvgpr_write_b32 a179, 0
    v_accvgpr_write_b32 a180, 0
    v_accvgpr_write_b32 a181, 0
    v_accvgpr_write_b32 a182, 0
    v_accvgpr_write_b32 a183, 0
    v_accvgpr_write_b32 a184, 0
    v_accvgpr_write_b32 a185, 0
    v_accvgpr_write_b32 a186, 0
    v_accvgpr_write_b32 a187, 0
    v_accvgpr_write_b32 a188, 0
    v_accvgpr_write_b32 a189, 0
    v_accvgpr_write_b32 a190, 0
    v_accvgpr_write_b32 a191, 0
    v_accvgpr_write_b32 a192, 0
    v_accvgpr_write_b32 a193, 0
    v_accvgpr_write_b32 a194, 0
    v_accvgpr_write_b32 a195, 0
    v_accvgpr_write_b32 a196, 0
    v_accvgpr_write_b32 a197, 0
    v_accvgpr_write_b32 a198, 0
    v_accvgpr_write_b32 a199, 0
    v_accvgpr_write_b32 a200, 0
    v_accvgpr_write_b32 a201, 0
    v_accvgpr_write_b32 a202, 0
    v_accvgpr_write_b32 a203, 0
    v_accvgpr_write_b32 a204, 0
    v_accvgpr_write_b32 a205, 0
    v_accvgpr_write_b32 a206, 0
    v_accvgpr_write_b32 a207, 0
    v_accvgpr_write_b32 a208, 0
    v_accvgpr_write_b32 a209, 0
    v_accvgpr_write_b32 a210, 0
    v_accvgpr_write_b32 a211, 0
    v_accvgpr_write_b32 a212, 0
    v_accvgpr_write_b32 a213, 0
    v_accvgpr_write_b32 a214, 0
    v_accvgpr_write_b32 a215, 0
    v_accvgpr_write_b32 a216, 0
    v_accvgpr_write_b32 a217, 0
    v_accvgpr_write_b32 a218, 0
    v_accvgpr_write_b32 a219, 0
    v_accvgpr_write_b32 a220, 0
    v_accvgpr_write_b32 a221, 0
    v_accvgpr_write_b32 a222, 0
    v_accvgpr_write_b32 a223, 0
    s_mov_b32 s39, 0
L_sq:
    s_lshr_b32 s52, s39, 2
    s_and_b32 s53, s39, 3
    s_lshl_b32 s54, s52, 8
    s_lshl_b32 s55, s53, 4
    s_add_u32 s50, s54, s55
    s_lshl_b32 s54, s52, 20
    s_lshl_b32 s55, s53, 16
    s_add_u32 s40, s54, s55
    s_bfe_u32 s41, s59, 0x40000
    s_lshl_b32 s41, s41, 14
    s_add_u32 s41, s41, s50
    buffer_load_dwordx4 v[204:207], v255, s[8:11], s41 offen
    s_bfe_u32 s41, s59, 0x40004
    s_lshl_b32 s41, s41, 14
    s_add_u32 s41, s41, s50
    buffer_load_dwordx4 v[208:211], v255, s[8:11], s41 offen
    s_bfe_u32 s41, s59, 0x40008
    s_lshl_b32 s41, s41, 14
    s_add_u32 s41, s41, s50
    buffer_load_dwordx4 v[212:215], v255, s[8:11], s41 offen
    s_bfe_u32 s41, s59, 0x4000c
    s_lshl_b32 s41, s41, 14
    s_add_u32 s41, s41, s50
    buffer_load_dwordx4 v[216:219], v255, s[8:11], s41 offen
    s_bfe_u32 s41, s59, 0x40010
    s_lshl_b32 s41, s41, 14
    s_add_u32 s41, s41, s50
    buffer_load_dwordx4 v[220:223], v255, s[8:11], s41 offen
    s_bfe_u32 s41, s59, 0x40014
    s_lshl_b32 s41, s41, 14
    s_add_u32 s41, s41, s50
    buffer_load_dwordx4 v[224:227], v255, s[8:11], s41 offen
    s_bfe_u32 s41, s59, 0x40018
    s_lshl_b32 s41, s41, 14
    s_add_u32 s41, s41, s50
    buffer_load_dwordx4 v[228:231], v255, s[8:11], s41 offen
    buffer_load_dwordx4 v[0:3], v249, s[12:15], s40 offen
    s_add_u32 s40, s40, 8192
    buffer_load_dwordx4 v[4:7], v249, s[12:15], s40 offen
    s_add_u32 s40, s40, 8192
    buffer_load_dwordx4 v[8:11], v249, s[12:15], s40 offen
    s_add_u32 s40, s40, 8192
    buffer_load_dwordx4 v[12:15], v249, s[12:15], s40 offen
    s_add_u32 s40, s40, 8192
    buffer_load_dwordx4 v[16:19], v249, s[12:15], s40 offen
    s_add_u32 s40, s40, 8192
    buffer_load_dwordx4 v[20:23], v249, s[12:15], s40 offen
    s_add_u32 s40, s40, 8192
    buffer_load_dwordx4 v[24:27], v249, s[12:15], s40 offen
    s_add_u32 s40, s40, 8192
    buffer_load_dwordx4 v[28:31], v249, s[12:15], s40 offen
    s_add_u32 s40, s40, 8192
    s_waitcnt vmcnt(6)
    v_perm_b32 v192, v4, v0, s37
    s_waitcnt vmcnt(4)
    v_perm_b32 v193, v12, v8, s37
    s_waitcnt vmcnt(2)
    v_perm_b32 v194, v20, v16, s37
    s_waitcnt vmcnt(0)
    v_perm_b32 v195, v28, v24, s37
    s_nop 1
    v_mfma_f32_16x16x32_bf16 a[0:3], v[192:195], v[204:207], a[0:3]
    v_mfma_f32_16x16x32_bf16 a[32:35], v[192:195], v[208:211], a[32:35]
    v_mfma_f32_16x16x32_bf16 a[64:67], v[192:195], v[212:215], a[64:67]
    v_mfma_f32_16x16x32_bf16 a[96:99], v[192:195], v[216:219], a[96:99]
    v_mfma_f32_16x16x32_bf16 a[128:131], v[192:195], v[220:223], a[128:131]
    v_mfma_f32_16x16x32_bf16 a[160:163], v[192:195], v[224:227], a[160:163]
    v_mfma_f32_16x16x32_bf16 a[192:195], v[192:195], v[228:231], a[192:195]
    v_perm_b32 v196, v4, v0, s38
    v_perm_b32 v197, v12, v8, s38
    v_perm_b32 v198, v20, v16, s38
    v_perm_b32 v199, v28, v24, s38
    s_nop 1
    v_mfma_f32_16x16x32_bf16 a[4:7], v[196:199], v[204:207], a[4:7]
    v_mfma_f32_16x16x32_bf16 a[36:39], v[196:199], v[208:211], a[36:39]
    v_mfma_f32_16x16x32_bf16 a[68:71], v[196:199], v[212:215], a[68:71]
    v_mfma_f32_16x16x32_bf16 a[100:103], v[196:199], v[216:219], a[100:103]
    v_mfma_f32_16x16x32_bf16 a[132:135], v[196:199], v[220:223], a[132:135]
    v_mfma_f32_16x16x32_bf16 a[164:167], v[196:199], v[224:227], a[164:167]
    v_mfma_f32_16x16x32_bf16 a[196:199], v[196:199], v[228:231], a[196:199]
    v_perm_b32 v200, v5, v1, s37
    v_perm_b32 v201, v13, v9, s37
    v_perm_b32 v202, v21, v17, s37
    v_perm_b32 v203, v29, v25, s37
    s_nop 1
    v_mfma_f32_16x16x32_bf16 a[8:11], v[200:203], v[204:207], a[8:11]
    v_mfma_f32_16x16x32_bf16 a[40:43], v[200:203], v[208:211], a[40:43]
    v_mfma_f32_16x16x32_bf16 a[72:75], v[200:203], v[212:215], a[72:75]
    v_mfma_f32_16x16x32_bf16 a[104:107], v[200:203], v[216:219], a[104:107]
    v_mfma_f32_16x16x32_bf16 a[136:139], v[200:203], v[220:223], a[136:139]
    v_mfma_f32_16x16x32_bf16 a[168:171], v[200:203], v[224:227], a[168:171]
    v_mfma_f32_16x16x32_bf16 a[200:203], v[200:203], v[228:231], a[200:203]
    v_perm_b32 v192, v5, v1, s38
    v_perm_b32 v193, v13, v9, s38
    v_perm_b32 v194, v21, v17, s38
    v_perm_b32 v195, v29, v25, s38
    s_nop 1
    v_mfma_f32_16x16x32_bf16 a[12:15], v[192:195], v[204:207], a[12:15]
    v_mfma_f32_16x16x32_bf16 a[44:47], v[192:195], v[208:211], a[44:47]
    v_mfma_f32_16x16x32_bf16 a[76:79], v[192:195], v[212:215], a[76:79]
    v_mfma_f32_16x16x32_bf16 a[108:111], v[192:195], v[216:219], a[108:111]
    v_mfma_f32_16x16x32_bf16 a[140:143], v[192:195], v[220:223], a[140:143]
    v_mfma_f32_16x16x32_bf16 a[172:175], v[192:195], v[224:227], a[172:175]
    v_mfma_f32_16x16x32_bf16 a[204:207], v[192:195], v[228:231], a[204:207]
    v_perm_b32 v196, v6, v2, s37
    v_perm_b32 v197, v14, v10, s37
    v_perm_b32 v198, v22, v18, s37
    v_perm_b32 v199, v30, v26, s37
    s_nop 1
    v_mfma_f32_16x16x32_bf16 a[16:19], v[196:199], v[204:207], a[16:19]
    v_mfma_f32_16x16x32_bf16 a[48:51], v[196:199], v[208:211], a[48:51]
    v_mfma_f32_16x16x32_bf16 a[80:83], v[196:199], v[212:215], a[80:83]
    v_mfma_f32_16x16x32_bf16 a[112:115], v[196:199], v[216:219], a[112:115]
    v_mfma_f32_16x16x32_bf16 a[144:147], v[196:199], v[220:223], a[144:147]
    v_mfma_f32_16x16x32_bf16 a[176:179], v[196:199], v[224:227], a[176:179]
    v_mfma_f32_16x16x32_bf16 a[208:211], v[196:199], v[228:231], a[208:211]
    v_perm_b32 v200, v6, v2, s38
    v_perm_b32 v201, v14, v10, s38
    v_perm_b32 v202, v22, v18, s38
    v_perm_b32 v203, v30, v26, s38
    s_nop 1
    v_mfma_f32_16x16x32_bf16 a[20:23], v[200:203], v[204:207], a[20:23]
    v_mfma_f32_16x16x32_bf16 a[52:55], v[200:203], v[208:211], a[52:55]
    v_mfma_f32_16x16x32_bf16 a[84:87], v[200:203], v[212:215], a[84:87]
    v_mfma_f32_16x16x32_bf16 a[116:119], v[200:203], v[216:219], a[116:119]
    v_mfma_f32_16x16x32_bf16 a[148:151], v[200:203], v[220:223], a[148:151]
    v_mfma_f32_16x16x32_bf16 a[180:183], v[200:203], v[224:227], a[180:183]
    v_mfma_f32_16x16x32_bf16 a[212:215], v[200:203], v[228:231], a[212:215]
    v_perm_b32 v192, v7, v3, s37
    v_perm_b32 v193, v15, v11, s37
    v_perm_b32 v194, v23, v19, s37
    v_perm_b32 v195, v31, v27, s37
    s_nop 1
    v_mfma_f32_16x16x32_bf16 a[24:27], v[192:195], v[204:207], a[24:27]
    v_mfma_f32_16x16x32_bf16 a[56:59], v[192:195], v[208:211], a[56:59]
    v_mfma_f32_16x16x32_bf16 a[88:91], v[192:195], v[212:215], a[88:91]
    v_mfma_f32_16x16x32_bf16 a[120:123], v[192:195], v[216:219], a[120:123]
    v_mfma_f32_16x16x32_bf16 a[152:155], v[192:195], v[220:223], a[152:155]
    v_mfma_f32_16x16x32_bf16 a[184:187], v[192:195], v[224:227], a[184:187]
    v_mfma_f32_16x16x32_bf16 a[216:219], v[192:195], v[228:231], a[216:219]
    v_perm_b32 v196, v7, v3, s38
    v_perm_b32 v197, v15, v11, s38
    v_perm_b32 v198, v23, v19, s38
    v_perm_b32 v199, v31, v27, s38
    s_nop 1
    v_mfma_f32_16x16x32_bf16 a[28:31], v[196:199], v[204:207], a[28:31]
    v_mfma_f32_16x16x32_bf16 a[60:63], v[196:199], v[208:211], a[60:63]
    v_mfma_f32_16x16x32_bf16 a[92:95], v[196:199], v[212:215], a[92:95]
    v_mfma_f32_16x16x32_bf16 a[124:127], v[196:199], v[216:219], a[124:127]
    v_mfma_f32_16x16x32_bf16 a[156:159], v[196:199], v[220:223], a[156:159]
    v_mfma_f32_16x16x32_bf16 a[188:191], v[196:199], v[224:227], a[188:191]
    v_mfma_f32_16x16x32_bf16 a[220:223], v[196:199], v[228:231], a[220:223]
    s_add_u32 s39, s39, 1
    s_cmp_lt_u32 s39, 16
    s_cbranch_scc1 L_sq
    v_accvgpr_read_b32 v228, a0
    v_accvgpr_read_b32 v229, a4
    v_accvgpr_read_b32 v230, a8
    v_accvgpr_read_b32 v231, a12
    v_accvgpr_read_b32 v232, a16
    v_accvgpr_read_b32 v233, a20
    v_accvgpr_read_b32 v234, a24
    v_accvgpr_read_b32 v235, a28
    v_mul_f32 v228, s49, v228
    v_mul_f32 v229, s49, v229
    v_mul_f32 v230, s49, v230
    v_mul_f32 v231, s49, v231
    v_mul_f32 v232, s49, v232
    v_mul_f32 v233, s49, v233
    v_mul_f32 v234, s49, v234
    v_mul_f32 v235, s49, v235
    v_cvt_pk_bf16_f32 v64, v228, v229
    v_cvt_pk_bf16_f32 v65, v230, v231
    v_cvt_pk_bf16_f32 v66, v232, v233
    v_cvt_pk_bf16_f32 v67, v234, v235
    v_accvgpr_read_b32 v228, a1
    v_accvgpr_read_b32 v229, a5
    v_accvgpr_read_b32 v230, a9
    v_accvgpr_read_b32 v231, a13
    v_accvgpr_read_b32 v232, a17
    v_accvgpr_read_b32 v233, a21
    v_accvgpr_read_b32 v234, a25
    v_accvgpr_read_b32 v235, a29
    v_mul_f32 v228, s49, v228
    v_mul_f32 v229, s49, v229
    v_mul_f32 v230, s49, v230
    v_mul_f32 v231, s49, v231
    v_mul_f32 v232, s49, v232
    v_mul_f32 v233, s49, v233
    v_mul_f32 v234, s49, v234
    v_mul_f32 v235, s49, v235
    v_cvt_pk_bf16_f32 v68, v228, v229
    v_cvt_pk_bf16_f32 v69, v230, v231
    v_cvt_pk_bf16_f32 v70, v232, v233
    v_cvt_pk_bf16_f32 v71, v234, v235
    v_accvgpr_read_b32 v228, a2
    v_accvgpr_read_b32 v229, a6
    v_accvgpr_read_b32 v230, a10
    v_accvgpr_read_b32 v231, a14
    v_accvgpr_read_b32 v232, a18
    v_accvgpr_read_b32 v233, a22
    v_accvgpr_read_b32 v234, a26
    v_accvgpr_read_b32 v235, a30
    v_mul_f32 v228, s49, v228
    v_mul_f32 v229, s49, v229
    v_mul_f32 v230, s49, v230
    v_mul_f32 v231, s49, v231
    v_mul_f32 v232, s49, v232
    v_mul_f32 v233, s49, v233
    v_mul_f32 v234, s49, v234
    v_mul_f32 v235, s49, v235
    v_cvt_pk_bf16_f32 v72, v228, v229
    v_cvt_pk_bf16_f32 v73, v230, v231
    v_cvt_pk_bf16_f32 v74, v232, v233
    v_cvt_pk_bf16_f32 v75, v234, v235
    v_accvgpr_read_b32 v228, a3
    v_accvgpr_read_b32 v229, a7
    v_accvgpr_read_b32 v230, a11
    v_accvgpr_read_b32 v231, a15
    v_accvgpr_read_b32 v232, a19
    v_accvgpr_read_b32 v233, a23
    v_accvgpr_read_b32 v234, a27
    v_accvgpr_read_b32 v235, a31
    v_mul_f32 v228, s49, v228
    v_mul_f32 v229, s49, v229
    v_mul_f32 v230, s49, v230
    v_mul_f32 v231, s49, v231
    v_mul_f32 v232, s49, v232
    v_mul_f32 v233, s49, v233
    v_mul_f32 v234, s49, v234
    v_mul_f32 v235, s49, v235
    v_cvt_pk_bf16_f32 v76, v228, v229
    v_cvt_pk_bf16_f32 v77, v230, v231
    v_cvt_pk_bf16_f32 v78, v232, v233
    v_cvt_pk_bf16_f32 v79, v234, v235
    v_accvgpr_read_b32 v228, a32
    v_accvgpr_read_b32 v229, a36
    v_accvgpr_read_b32 v230, a40
    v_accvgpr_read_b32 v231, a44
    v_accvgpr_read_b32 v232, a48
    v_accvgpr_read_b32 v233, a52
    v_accvgpr_read_b32 v234, a56
    v_accvgpr_read_b32 v235, a60
    v_mul_f32 v228, s49, v228
    v_mul_f32 v229, s49, v229
    v_mul_f32 v230, s49, v230
    v_mul_f32 v231, s49, v231
    v_mul_f32 v232, s49, v232
    v_mul_f32 v233, s49, v233
    v_mul_f32 v234, s49, v234
    v_mul_f32 v235, s49, v235
    v_cvt_pk_bf16_f32 v80, v228, v229
    v_cvt_pk_bf16_f32 v81, v230, v231
    v_cvt_pk_bf16_f32 v82, v232, v233
    v_cvt_pk_bf16_f32 v83, v234, v235
    v_accvgpr_read_b32 v228, a33
    v_accvgpr_read_b32 v229, a37
    v_accvgpr_read_b32 v230, a41
    v_accvgpr_read_b32 v231, a45
    v_accvgpr_read_b32 v232, a49
    v_accvgpr_read_b32 v233, a53
    v_accvgpr_read_b32 v234, a57
    v_accvgpr_read_b32 v235, a61
    v_mul_f32 v228, s49, v228
    v_mul_f32 v229, s49, v229
    v_mul_f32 v230, s49, v230
    v_mul_f32 v231, s49, v231
    v_mul_f32 v232, s49, v232
    v_mul_f32 v233, s49, v233
    v_mul_f32 v234, s49, v234
    v_mul_f32 v235, s49, v235
    v_cvt_pk_bf16_f32 v84, v228, v229
    v_cvt_pk_bf16_f32 v85, v230, v231
    v_cvt_pk_bf16_f32 v86, v232, v233
    v_cvt_pk_bf16_f32 v87, v234, v235
    v_accvgpr_read_b32 v228, a34
    v_accvgpr_read_b32 v229, a38
    v_accvgpr_read_b32 v230, a42
    v_accvgpr_read_b32 v231, a46
    v_accvgpr_read_b32 v232, a50
    v_accvgpr_read_b32 v233, a54
    v_accvgpr_read_b32 v234, a58
    v_accvgpr_read_b32 v235, a62
    v_mul_f32 v228, s49, v228
    v_mul_f32 v229, s49, v229
    v_mul_f32 v230, s49, v230
    v_mul_f32 v231, s49, v231
    v_mul_f32 v232, s49, v232
    v_mul_f32 v233, s49, v233
    v_mul_f32 v234, s49, v234
    v_mul_f32 v235, s49, v235
    v_cvt_pk_bf16_f32 v88, v228, v229
    v_cvt_pk_bf16_f32 v89, v230, v231
    v_cvt_pk_bf16_f32 v90, v232, v233
    v_cvt_pk_bf16_f32 v91, v234, v235
    v_accvgpr_read_b32 v228, a35
    v_accvgpr_read_b32 v229, a39
    v_accvgpr_read_b32 v230, a43
    v_accvgpr_read_b32 v231, a47
    v_accvgpr_read_b32 v232, a51
    v_accvgpr_read_b32 v233, a55
    v_accvgpr_read_b32 v234, a59
    v_accvgpr_read_b32 v235, a63
    v_mul_f32 v228, s49, v228
    v_mul_f32 v229, s49, v229
    v_mul_f32 v230, s49, v230
    v_mul_f32 v231, s49, v231
    v_mul_f32 v232, s49, v232
    v_mul_f32 v233, s49, v233
    v_mul_f32 v234, s49, v234
    v_mul_f32 v235, s49, v235
    v_cvt_pk_bf16_f32 v92, v228, v229
    v_cvt_pk_bf16_f32 v93, v230, v231
    v_cvt_pk_bf16_f32 v94, v232, v233
    v_cvt_pk_bf16_f32 v95, v234, v235
    v_accvgpr_read_b32 v228, a64
    v_accvgpr_read_b32 v229, a68
    v_accvgpr_read_b32 v230, a72
    v_accvgpr_read_b32 v231, a76
    v_accvgpr_read_b32 v232, a80
    v_accvgpr_read_b32 v233, a84
    v_accvgpr_read_b32 v234, a88
    v_accvgpr_read_b32 v235, a92
    v_mul_f32 v228, s49, v228
    v_mul_f32 v229, s49, v229
    v_mul_f32 v230, s49, v230
    v_mul_f32 v231, s49, v231
    v_mul_f32 v232, s49, v232
    v_mul_f32 v233, s49, v233
    v_mul_f32 v234, s49, v234
    v_mul_f32 v235, s49, v235
    v_cvt_pk_bf16_f32 v96, v228, v229
    v_cvt_pk_bf16_f32 v97, v230, v231
    v_cvt_pk_bf16_f32 v98, v232, v233
    v_cvt_pk_bf16_f32 v99, v234, v235
    v_accvgpr_read_b32 v228, a65
    v_accvgpr_read_b32 v229, a69
    v_accvgpr_read_b32 v230, a73
    v_accvgpr_read_b32 v231, a77
    v_accvgpr_read_b32 v232, a81
    v_accvgpr_read_b32 v233, a85
    v_accvgpr_read_b32 v234, a89
    v_accvgpr_read_b32 v235, a93
    v_mul_f32 v228, s49, v228
    v_mul_f32 v229, s49, v229
    v_mul_f32 v230, s49, v230
    v_mul_f32 v231, s49, v231
    v_mul_f32 v232, s49, v232
    v_mul_f32 v233, s49, v233
    v_mul_f32 v234, s49, v234
    v_mul_f32 v235, s49, v235
    v_cvt_pk_bf16_f32 v100, v228, v229
    v_cvt_pk_bf16_f32 v101, v230, v231
    v_cvt_pk_bf16_f32 v102, v232, v233
    v_cvt_pk_bf16_f32 v103, v234, v235
    v_accvgpr_read_b32 v228, a66
    v_accvgpr_read_b32 v229, a70
    v_accvgpr_read_b32 v230, a74
    v_accvgpr_read_b32 v231, a78
    v_accvgpr_read_b32 v232, a82
    v_accvgpr_read_b32 v233, a86
    v_accvgpr_read_b32 v234, a90
    v_accvgpr_read_b32 v235, a94
    v_mul_f32 v228, s49, v228
    v_mul_f32 v229, s49, v229
    v_mul_f32 v230, s49, v230
    v_mul_f32 v231, s49, v231
    v_mul_f32 v232, s49, v232
    v_mul_f32 v233, s49, v233
    v_mul_f32 v234, s49, v234
    v_mul_f32 v235, s49, v235
    v_cvt_pk_bf16_f32 v104, v228, v229
    v_cvt_pk_bf16_f32 v105, v230, v231
    v_cvt_pk_bf16_f32 v106, v232, v233
    v_cvt_pk_bf16_f32 v107, v234, v235
    v_accvgpr_read_b32 v228, a67
    v_accvgpr_read_b32 v229, a71
    v_accvgpr_read_b32 v230, a75
    v_accvgpr_read_b32 v231, a79
    v_accvgpr_read_b32 v232, a83
    v_accvgpr_read_b32 v233, a87
    v_accvgpr_read_b32 v234, a91
    v_accvgpr_read_b32 v235, a95
    v_mul_f32 v228, s49, v228
    v_mul_f32 v229, s49, v229
    v_mul_f32 v230, s49, v230
    v_mul_f32 v231, s49, v231
    v_mul_f32 v232, s49, v232
    v_mul_f32 v233, s49, v233
    v_mul_f32 v234, s49, v234
    v_mul_f32 v235, s49, v235
    v_cvt_pk_bf16_f32 v108, v228, v229
    v_cvt_pk_bf16_f32 v109, v230, v231
    v_cvt_pk_bf16_f32 v110, v232, v233
    v_cvt_pk_bf16_f32 v111, v234, v235
    v_accvgpr_read_b32 v228, a96
    v_accvgpr_read_b32 v229, a100
    v_accvgpr_read_b32 v230, a104
    v_accvgpr_read_b32 v231, a108
    v_accvgpr_read_b32 v232, a112
    v_accvgpr_read_b32 v233, a116
    v_accvgpr_read_b32 v234, a120
    v_accvgpr_read_b32 v235, a124
    v_mul_f32 v228, s49, v228
    v_mul_f32 v229, s49, v229
    v_mul_f32 v230, s49, v230
    v_mul_f32 v231, s49, v231
    v_mul_f32 v232, s49, v232
    v_mul_f32 v233, s49, v233
    v_mul_f32 v234, s49, v234
    v_mul_f32 v235, s49, v235
    v_cvt_pk_bf16_f32 v112, v228, v229
    v_cvt_pk_bf16_f32 v113, v230, v231
    v_cvt_pk_bf16_f32 v114, v232, v233
    v_cvt_pk_bf16_f32 v115, v234, v235
    v_accvgpr_read_b32 v228, a97
    v_accvgpr_read_b32 v229, a101
    v_accvgpr_read_b32 v230, a105
    v_accvgpr_read_b32 v231, a109
    v_accvgpr_read_b32 v232, a113
    v_accvgpr_read_b32 v233, a117
    v_accvgpr_read_b32 v234, a121
    v_accvgpr_read_b32 v235, a125
    v_mul_f32 v228, s49, v228
    v_mul_f32 v229, s49, v229
    v_mul_f32 v230, s49, v230
    v_mul_f32 v231, s49, v231
    v_mul_f32 v232, s49, v232
    v_mul_f32 v233, s49, v233
    v_mul_f32 v234, s49, v234
    v_mul_f32 v235, s49, v235
    v_cvt_pk_bf16_f32 v116, v228, v229
    v_cvt_pk_bf16_f32 v117, v230, v231
    v_cvt_pk_bf16_f32 v118, v232, v233
    v_cvt_pk_bf16_f32 v119, v234, v235
    v_accvgpr_read_b32 v228, a98
    v_accvgpr_read_b32 v229, a102
    v_accvgpr_read_b32 v230, a106
    v_accvgpr_read_b32 v231, a110
    v_accvgpr_read_b32 v232, a114
    v_accvgpr_read_b32 v233, a118
    v_accvgpr_read_b32 v234, a122
    v_accvgpr_read_b32 v235, a126
    v_mul_f32 v228, s49, v228
    v_mul_f32 v229, s49, v229
    v_mul_f32 v230, s49, v230
    v_mul_f32 v231, s49, v231
    v_mul_f32 v232, s49, v232
    v_mul_f32 v233, s49, v233
    v_mul_f32 v234, s49, v234
    v_mul_f32 v235, s49, v235
    v_cvt_pk_bf16_f32 v120, v228, v229
    v_cvt_pk_bf16_f32 v121, v230, v231
    v_cvt_pk_bf16_f32 v122, v232, v233
    v_cvt_pk_bf16_f32 v123, v234, v235
    v_accvgpr_read_b32 v228, a99
    v_accvgpr_read_b32 v229, a103
    v_accvgpr_read_b32 v230, a107
    v_accvgpr_read_b32 v231, a111
    v_accvgpr_read_b32 v232, a115
    v_accvgpr_read_b32 v233, a119
    v_accvgpr_read_b32 v234, a123
    v_accvgpr_read_b32 v235, a127
    v_mul_f32 v228, s49, v228
    v_mul_f32 v229, s49, v229
    v_mul_f32 v230, s49, v230
    v_mul_f32 v231, s49, v231
    v_mul_f32 v232, s49, v232
    v_mul_f32 v233, s49, v233
    v_mul_f32 v234, s49, v234
    v_mul_f32 v235, s49, v235
    v_cvt_pk_bf16_f32 v124, v228, v229
    v_cvt_pk_bf16_f32 v125, v230, v231
    v_cvt_pk_bf16_f32 v126, v232, v233
    v_cvt_pk_bf16_f32 v127, v234, v235
    v_accvgpr_read_b32 v228, a128
    v_accvgpr_read_b32 v229, a132
    v_accvgpr_read_b32 v230, a136
    v_accvgpr_read_b32 v231, a140
    v_accvgpr_read_b32 v232, a144
    v_accvgpr_read_b32 v233, a148
    v_accvgpr_read_b32 v234, a152
    v_accvgpr_read_b32 v235, a156
    v_mul_f32 v228, s49, v228
    v_mul_f32 v229, s49, v229
    v_mul_f32 v230, s49, v230
    v_mul_f32 v231, s49, v231
    v_mul_f32 v232, s49, v232
    v_mul_f32 v233, s49, v233
    v_mul_f32 v234, s49, v234
    v_mul_f32 v235, s49, v235
    v_cvt_pk_bf16_f32 v192, v228, v229
    v_cvt_pk_bf16_f32 v193, v230, v231
    v_cvt_pk_bf16_f32 v194, v232, v233
    v_cvt_pk_bf16_f32 v195, v234, v235
    v_accvgpr_read_b32 v228, a129
    v_accvgpr_read_b32 v229, a133
    v_accvgpr_read_b32 v230, a137
    v_accvgpr_read_b32 v231, a141
    v_accvgpr_read_b32 v232, a145
    v_accvgpr_read_b32 v233, a149
    v_accvgpr_read_b32 v234, a153
    v_accvgpr_read_b32 v235, a157
    v_mul_f32 v228, s49, v228
    v_mul_f32 v229, s49, v229
    v_mul_f32 v230, s49, v230
    v_mul_f32 v231, s49, v231
    v_mul_f32 v232, s49, v232
    v_mul_f32 v233, s49, v233
    v_mul_f32 v234, s49, v234
    v_mul_f32 v235, s49, v235
    v_cvt_pk_bf16_f32 v196, v228, v229
    v_cvt_pk_bf16_f32 v197, v230, v231
    v_cvt_pk_bf16_f32 v198, v232, v233
    v_cvt_pk_bf16_f32 v199, v234, v235
    v_accvgpr_read_b32 v228, a130
    v_accvgpr_read_b32 v229, a134
    v_accvgpr_read_b32 v230, a138
    v_accvgpr_read_b32 v231, a142
    v_accvgpr_read_b32 v232, a146
    v_accvgpr_read_b32 v233, a150
    v_accvgpr_read_b32 v234, a154
    v_accvgpr_read_b32 v235, a158
    v_mul_f32 v228, s49, v228
    v_mul_f32 v229, s49, v229
    v_mul_f32 v230, s49, v230
    v_mul_f32 v231, s49, v231
    v_mul_f32 v232, s49, v232
    v_mul_f32 v233, s49, v233
    v_mul_f32 v234, s49, v234
    v_mul_f32 v235, s49, v235
    v_cvt_pk_bf16_f32 v200, v228, v229
    v_cvt_pk_bf16_f32 v201, v230, v231
    v_cvt_pk_bf16_f32 v202, v232, v233
    v_cvt_pk_bf16_f32 v203, v234, v235
    v_accvgpr_read_b32 v228, a131
    v_accvgpr_read_b32 v229, a135
    v_accvgpr_read_b32 v230, a139
    v_accvgpr_read_b32 v231, a143
    v_accvgpr_read_b32 v232, a147
    v_accvgpr_read_b32 v233, a151
    v_accvgpr_read_b32 v234, a155
    v_accvgpr_read_b32 v235, a159
    v_mul_f32 v228, s49, v228
    v_mul_f32 v229, s49, v229
    v_mul_f32 v230, s49, v230
    v_mul_f32 v231, s49, v231
    v_mul_f32 v232, s49, v232
    v_mul_f32 v233, s49, v233
    v_mul_f32 v234, s49, v234
    v_mul_f32 v235, s49, v235
    v_cvt_pk_bf16_f32 v204, v228, v229
    v_cvt_pk_bf16_f32 v205, v230, v231
    v_cvt_pk_bf16_f32 v206, v232, v233
    v_cvt_pk_bf16_f32 v207, v234, v235
    v_accvgpr_read_b32 v228, a160
    v_accvgpr_read_b32 v229, a164
    v_accvgpr_read_b32 v230, a168
    v_accvgpr_read_b32 v231, a172
    v_accvgpr_read_b32 v232, a176
    v_accvgpr_read_b32 v233, a180
    v_accvgpr_read_b32 v234, a184
    v_accvgpr_read_b32 v235, a188
    v_mul_f32 v228, s49, v228
    v_mul_f32 v229, s49, v229
    v_mul_f32 v230, s49, v230
    v_mul_f32 v231, s49, v231
    v_mul_f32 v232, s49, v232
    v_mul_f32 v233, s49, v233
    v_mul_f32 v234, s49, v234
    v_mul_f32 v235, s49, v235
    v_cvt_pk_bf16_f32 v208, v228, v229
    v_cvt_pk_bf16_f32 v209, v230, v231
    v_cvt_pk_bf16_f32 v210, v232, v233
    v_cvt_pk_bf16_f32 v211, v234, v235
    v_accvgpr_read_b32 v228, a161
    v_accvgpr_read_b32 v229, a165
    v_accvgpr_read_b32 v230, a169
    v_accvgpr_read_b32 v231, a173
    v_accvgpr_read_b32 v232, a177
    v_accvgpr_read_b32 v233, a181
    v_accvgpr_read_b32 v234, a185
    v_accvgpr_read_b32 v235, a189
    v_mul_f32 v228, s49, v228
    v_mul_f32 v229, s49, v229
    v_mul_f32 v230, s49, v230
    v_mul_f32 v231, s49, v231
    v_mul_f32 v232, s49, v232
    v_mul_f32 v233, s49, v233
    v_mul_f32 v234, s49, v234
    v_mul_f32 v235, s49, v235
    v_cvt_pk_bf16_f32 v212, v228, v229
    v_cvt_pk_bf16_f32 v213, v230, v231
    v_cvt_pk_bf16_f32 v214, v232, v233
    v_cvt_pk_bf16_f32 v215, v234, v235
    v_accvgpr_read_b32 v228, a162
    v_accvgpr_read_b32 v229, a166
    v_accvgpr_read_b32 v230, a170
    v_accvgpr_read_b32 v231, a174
    v_accvgpr_read_b32 v232, a178
    v_accvgpr_read_b32 v233, a182
    v_accvgpr_read_b32 v234, a186
    v_accvgpr_read_b32 v235, a190
    v_mul_f32 v228, s49, v228
    v_mul_f32 v229, s49, v229
    v_mul_f32 v230, s49, v230
    v_mul_f32 v231, s49, v231
    v_mul_f32 v232, s49, v232
    v_mul_f32 v233, s49, v233
    v_mul_f32 v234, s49, v234
    v_mul_f32 v235, s49, v235
    v_cvt_pk_bf16_f32 v216, v228, v229
    v_cvt_pk_bf16_f32 v217, v230, v231
    v_cvt_pk_bf16_f32 v218, v232, v233
    v_cvt_pk_bf16_f32 v219, v234, v235
    v_accvgpr_read_b32 v228, a163
    v_accvgpr_read_b32 v229, a167
    v_accvgpr_read_b32 v230, a171
    v_accvgpr_read_b32 v231, a175
    v_accvgpr_read_b32 v232, a179
    v_accvgpr_read_b32 v233, a183
    v_accvgpr_read_b32 v234, a187
    v_accvgpr_read_b32 v235, a191
    v_mul_f32 v228, s49, v228
    v_mul_f32 v229, s49, v229
    v_mul_f32 v230, s49, v230
    v_mul_f32 v231, s49, v231
    v_mul_f32 v232, s49, v232
    v_mul_f32 v233, s49, v233
    v_mul_f32 v234, s49, v234
    v_mul_f32 v235, s49, v235
    v_cvt_pk_bf16_f32 v220, v228, v229
    v_cvt_pk_bf16_f32 v221, v230, v231
    v_cvt_pk_bf16_f32 v222, v232, v233
    v_cvt_pk_bf16_f32 v223, v234, v235
    v_accvgpr_read_b32 v228, a192
    v_accvgpr_read_b32 v229, a196
    v_accvgpr_read_b32 v230, a200
    v_accvgpr_read_b32 v231, a204
    v_accvgpr_read_b32 v232, a208
    v_accvgpr_read_b32 v233, a212
    v_accvgpr_read_b32 v234, a216
    v_accvgpr_read_b32 v235, a220
    v_mul_f32 v228, s49, v228
    v_mul_f32 v229, s49, v229
    v_mul_f32 v230, s49, v230
    v_mul_f32 v231, s49, v231
    v_mul_f32 v232, s49, v232
    v_mul_f32 v233, s49, v233
    v_mul_f32 v234, s49, v234
    v_mul_f32 v235, s49, v235
    v_cvt_pk_bf16_f32 v16, v228, v229
    v_cvt_pk_bf16_f32 v17, v230, v231
    v_cvt_pk_bf16_f32 v18, v232, v233
    v_cvt_pk_bf16_f32 v19, v234, v235
    v_accvgpr_read_b32 v228, a193
    v_accvgpr_read_b32 v229, a197
    v_accvgpr_read_b32 v230, a201
    v_accvgpr_read_b32 v231, a205
    v_accvgpr_read_b32 v232, a209
    v_accvgpr_read_b32 v233, a213
    v_accvgpr_read_b32 v234, a217
    v_accvgpr_read_b32 v235, a221
    v_mul_f32 v228, s49, v228
    v_mul_f32 v229, s49, v229
    v_mul_f32 v230, s49, v230
    v_mul_f32 v231, s49, v231
    v_mul_f32 v232, s49, v232
    v_mul_f32 v233, s49, v233
    v_mul_f32 v234, s49, v234
    v_mul_f32 v235, s49, v235
    v_cvt_pk_bf16_f32 v20, v228, v229
    v_cvt_pk_bf16_f32 v21, v230, v231
    v_cvt_pk_bf16_f32 v22, v232, v233
    v_cvt_pk_bf16_f32 v23, v234, v235
    v_accvgpr_read_b32 v228, a194
    v_accvgpr_read_b32 v229, a198
    v_accvgpr_read_b32 v230, a202
    v_accvgpr_read_b32 v231, a206
    v_accvgpr_read_b32 v232, a210
    v_accvgpr_read_b32 v233, a214
    v_accvgpr_read_b32 v234, a218
    v_accvgpr_read_b32 v235, a222
    v_mul_f32 v228, s49, v228
    v_mul_f32 v229, s49, v229
    v_mul_f32 v230, s49, v230
    v_mul_f32 v231, s49, v231
    v_mul_f32 v232, s49, v232
    v_mul_f32 v233, s49, v233
    v_mul_f32 v234, s49, v234
    v_mul_f32 v235, s49, v235
    v_cvt_pk_bf16_f32 v24, v228, v229
    v_cvt_pk_bf16_f32 v25, v230, v231
    v_cvt_pk_bf16_f32 v26, v232, v233
    v_cvt_pk_bf16_f32 v27, v234, v235
    v_accvgpr_read_b32 v228, a195
    v_accvgpr_read_b32 v229, a199
    v_accvgpr_read_b32 v230, a203
    v_accvgpr_read_b32 v231, a207
    v_accvgpr_read_b32 v232, a211
    v_accvgpr_read_b32 v233, a215
    v_accvgpr_read_b32 v234, a219
    v_accvgpr_read_b32 v235, a223
    v_mul_f32 v228, s49, v228
    v_mul_f32 v229, s49, v229
    v_mul_f32 v230, s49, v230
    v_mul_f32 v231, s49, v231
    v_mul_f32 v232, s49, v232
    v_mul_f32 v233, s49, v233
    v_mul_f32 v234, s49, v234
    v_mul_f32 v235, s49, v235
    v_cvt_pk_bf16_f32 v28, v228, v229
    v_cvt_pk_bf16_f32 v29, v230, v231
    v_cvt_pk_bf16_f32 v30, v232, v233
    v_cvt_pk_bf16_f32 v31, v234, v235
    v_mov_b32 v40, 0xff800000
    v_mov_b32 v44, 0xff800000
    v_mov_b32 v48, 0xff800000
    v_mov_b32 v52, 0xff800000
    v_mov_b32 v56, 0xff800000
    v_mov_b32 v60, 0xff800000
    v_mov_b32 v224, 0xff800000
    s_mov_b32 s42, 0
    s_mov_b32 s43, 0x1000
    s_mov_b32 s39, 0
L_sm:
    s_add_u32 m0, s46, 0
    s_nop 0
    buffer_load_dwordx4 v245, s[16:19], s42 offen nt lds
    s_add_u32 m0, s46, 16
    s_nop 0
    buffer_load_dwordx4 v245, s[16:19], s42 offen offset:1024 nt lds
    s_add_u32 m0, s46, 32
    s_nop 0
    buffer_load_dwordx4 v245, s[16:19], s42 offen offset:2048 nt lds
    s_add_u32 m0, s46, 48
    s_nop 0
    buffer_load_dwordx4 v245, s[16:19], s42 offen offset:3072 nt lds
    s_add_u32 m0, s46, 0x1040
    s_nop 0
    buffer_load_dwordx4 v245, s[16:19], s43 offen nt lds
    s_add_u32 m0, s46, 0x1050
    s_nop 0
    buffer_load_dwordx4 v245, s[16:19], s43 offen offset:1024 nt lds
    s_add_u32 m0, s46, 0x1060
    s_nop 0
    buffer_load_dwordx4 v245, s[16:19], s43 offen offset:2048 nt lds
    s_add_u32 m0, s46, 0x1070
    s_nop 0
    buffer_load_dwordx4 v245, s[16:19], s43 offen offset:3072 nt lds
    s_waitcnt vmcnt(0)
    ds_read_b128 v[128:131], v240 offset:0
    ds_read_b128 v[132:135], v240 offset:16
    ds_read_b128 v[136:139], v240 offset:32
    ds_read_b128 v[140:143], v240 offset:48
    ds_read_b128 v[144:147], v240 offset:4160
    ds_read_b128 v[148:151], v240 offset:4176
    ds_read_b128 v[152:155], v240 offset:4192
    ds_read_b128 v[156:159], v240 offset:4208
    s_waitcnt lgkmcnt(7)
    v_mfma_f32_16x16x32_bf16 v[0:3], v[128:131], v[64:67], 0
    s_waitcnt lgkmcnt(6)
    v_mfma_f32_16x16x32_bf16 v[0:3], v[132:135], v[68:71], v[0:3]
    s_waitcnt lgkmcnt(5)
    v_mfma_f32_16x16x32_bf16 v[0:3], v[136:139], v[72:75], v[0:3]
    s_waitcnt lgkmcnt(4)
    v_mfma_f32_16x16x32_bf16 v[0:3], v[140:143], v[76:79], v[0:3]
    s_waitcnt lgkmcnt(3)
    v_mfma_f32_16x16x32_bf16 v[4:7], v[144:147], v[64:67], 0
    s_waitcnt lgkmcnt(2)
    v_mfma_f32_16x16x32_bf16 v[4:7], v[148:151], v[68:71], v[4:7]
    s_waitcnt lgkmcnt(1)
    v_mfma_f32_16x16x32_bf16 v[4:7], v[152:155], v[72:75], v[4:7]
    s_waitcnt lgkmcnt(0)
    v_mfma_f32_16x16x32_bf16 v[4:7], v[156:159], v[76:79], v[4:7]
    v_max3_f32 v40, v40, v0, v1
    v_max3_f32 v40, v40, v2, v3
    s_nop 6
    v_max3_f32 v40, v40, v4, v5
    v_max3_f32 v40, v40, v6, v7
    v_mfma_f32_16x16x32_bf16 v[8:11], v[128:131], v[80:83], 0
    v_mfma_f32_16x16x32_bf16 v[8:11], v[132:135], v[84:87], v[8:11]
    v_mfma_f32_16x16x32_bf16 v[8:11], v[136:139], v[88:91], v[8:11]
    v_mfma_f32_16x16x32_bf16 v[8:11], v[140:143], v[92:95], v[8:11]
    v_mfma_f32_16x16x32_bf16 v[12:15], v[144:147], v[80:83], 0
    v_mfma_f32_16x16x32_bf16 v[12:15], v[148:151], v[84:87], v[12:15]
    v_mfma_f32_16x16x32_bf16 v[12:15], v[152:155], v[88:91], v[12:15]
    v_mfma_f32_16x16x32_bf16 v[12:15], v[156:159], v[92:95], v[12:15]
    v_max3_f32 v44, v44, v8, v9
    v_max3_f32 v44, v44, v10, v11
    s_nop 6
    v_max3_f32 v44, v44, v12, v13
    v_max3_f32 v44, v44, v14, v15
    v_mfma_f32_16x16x32_bf16 v[0:3], v[128:131], v[96:99], 0
    v_mfma_f32_16x16x32_bf16 v[0:3], v[132:135], v[100:103], v[0:3]
    v_mfma_f32_16x16x32_bf16 v[0:3], v[136:139], v[104:107], v[0:3]
    v_mfma_f32_16x16x32_bf16 v[0:3], v[140:143], v[108:111], v[0:3]
    v_mfma_f32_16x16x32_bf16 v[4:7], v[144:147], v[96:99], 0
    v_mfma_f32_16x16x32_bf16 v[4:7], v[148:151], v[100:103], v[4:7]
    v_mfma_f32_16x16x32_bf16 v[4:7], v[152:155], v[104:107], v[4:7]
    v_mfma_f32_16x16x32_bf16 v[4:7], v[156:159], v[108:111], v[4:7]
    v_max3_f32 v48, v48, v0, v1
    v_max3_f32 v48, v48, v2, v3
    s_nop 6
    v_max3_f32 v48, v48, v4, v5
    v_max3_f32 v48, v48, v6, v7
    v_mfma_f32_16x16x32_bf16 v[8:11], v[128:131], v[112:115], 0
    v_mfma_f32_16x16x32_bf16 v[8:11], v[132:135], v[116:119], v[8:11]
    v_mfma_f32_16x16x32_bf16 v[8:11], v[136:139], v[120:123], v[8:11]
    v_mfma_f32_16x16x32_bf16 v[8:11], v[140:143], v[124:127], v[8:11]
    v_mfma_f32_16x16x32_bf16 v[12:15], v[144:147], v[112:115], 0
    v_mfma_f32_16x16x32_bf16 v[12:15], v[148:151], v[116:119], v[12:15]
    v_mfma_f32_16x16x32_bf16 v[12:15], v[152:155], v[120:123], v[12:15]
    v_mfma_f32_16x16x32_bf16 v[12:15], v[156:159], v[124:127], v[12:15]
    v_max3_f32 v52, v52, v8, v9
    v_max3_f32 v52, v52, v10, v11
    s_nop 6
    v_max3_f32 v52, v52, v12, v13
    v_max3_f32 v52, v52, v14, v15
    v_mfma_f32_16x16x32_bf16 v[0:3], v[128:131], v[192:195], 0
    v_mfma_f32_16x16x32_bf16 v[0:3], v[132:135], v[196:199], v[0:3]
    v_mfma_f32_16x16x32_bf16 v[0:3], v[136:139], v[200:203], v[0:3]
    v_mfma_f32_16x16x32_bf16 v[0:3], v[140:143], v[204:207], v[0:3]
    v_mfma_f32_16x16x32_bf16 v[4:7], v[144:147], v[192:195], 0
    v_mfma_f32_16x16x32_bf16 v[4:7], v[148:151], v[196:199], v[4:7]
    v_mfma_f32_16x16x32_bf16 v[4:7], v[152:155], v[200:203], v[4:7]
    v_mfma_f32_16x16x32_bf16 v[4:7], v[156:159], v[204:207], v[4:7]
    v_max3_f32 v56, v56, v0, v1
    v_max3_f32 v56, v56, v2, v3
    s_nop 6
    v_max3_f32 v56, v56, v4, v5
    v_max3_f32 v56, v56, v6, v7
    v_mfma_f32_16x16x32_bf16 v[8:11], v[128:131], v[208:211], 0
    v_mfma_f32_16x16x32_bf16 v[8:11], v[132:135], v[212:215], v[8:11]
    v_mfma_f32_16x16x32_bf16 v[8:11], v[136:139], v[216:219], v[8:11]
    v_mfma_f32_16x16x32_bf16 v[8:11], v[140:143], v[220:223], v[8:11]
    v_mfma_f32_16x16x32_bf16 v[12:15], v[144:147], v[208:211], 0
    v_mfma_f32_16x16x32_bf16 v[12:15], v[148:151], v[212:215], v[12:15]
    v_mfma_f32_16x16x32_bf16 v[12:15], v[152:155], v[216:219], v[12:15]
    v_mfma_f32_16x16x32_bf16 v[12:15], v[156:159], v[220:223], v[12:15]
    v_max3_f32 v60, v60, v8, v9
    v_max3_f32 v60, v60, v10, v11
    s_nop 6
    v_max3_f32 v60, v60, v12, v13
    v_max3_f32 v60, v60, v14, v15
    v_mfma_f32_16x16x32_bf16 v[0:3], v[128:131], v[16:19], 0
    v_mfma_f32_16x16x32_bf16 v[0:3], v[132:135], v[20:23], v[0:3]
    v_mfma_f32_16x16x32_bf16 v[0:3], v[136:139], v[24:27], v[0:3]
    v_mfma_f32_16x16x32_bf16 v[0:3], v[140:143], v[28:31], v[0:3]
    v_mfma_f32_16x16x32_bf16 v[4:7], v[144:147], v[16:19], 0
    v_mfma_f32_16x16x32_bf16 v[4:7], v[148:151], v[20:23], v[4:7]
    v_mfma_f32_16x16x32_bf16 v[4:7], v[152:155], v[24:27], v[4:7]
    v_mfma_f32_16x16x32_bf16 v[4:7], v[156:159], v[28:31], v[4:7]
    v_max3_f32 v224, v224, v0, v1
    v_max3_f32 v224, v224, v2, v3
    s_nop 6
    v_max3_f32 v224, v224, v4, v5
    v_max3_f32 v224, v224, v6, v7
    s_add_u32 s42, s42, 8192
    s_add_u32 s43, s43, 8192
    s_add_u32 s39, s39, 1
    s_cmp_lt_u32 s39, 16
    s_cbranch_scc1 L_sm
    v_mov_b32 v41, v40
    s_nop 1
    v_permlane32_swap_b32 v40, v41
    v_max_f32 v40, v40, v41
    v_mov_b32 v41, v40
    s_nop 1
    v_permlane16_swap_b32 v40, v41
    v_max_f32 v40, v40, v41
    v_sub_f32 v41, 0, v40
    v_sub_f32 v42, 0, v40
    v_sub_f32 v43, 0, v40
    v_sub_f32 v40, 0, v40
    v_mov_b32 v45, v44
    s_nop 1
    v_permlane32_swap_b32 v44, v45
    v_max_f32 v44, v44, v45
    v_mov_b32 v45, v44
    s_nop 1
    v_permlane16_swap_b32 v44, v45
    v_max_f32 v44, v44, v45
    v_sub_f32 v45, 0, v44
    v_sub_f32 v46, 0, v44
    v_sub_f32 v47, 0, v44
    v_sub_f32 v44, 0, v44
    v_mov_b32 v49, v48
    s_nop 1
    v_permlane32_swap_b32 v48, v49
    v_max_f32 v48, v48, v49
    v_mov_b32 v49, v48
    s_nop 1
    v_permlane16_swap_b32 v48, v49
    v_max_f32 v48, v48, v49
    v_sub_f32 v49, 0, v48
    v_sub_f32 v50, 0, v48
    v_sub_f32 v51, 0, v48
    v_sub_f32 v48, 0, v48
    v_mov_b32 v53, v52
    s_nop 1
    v_permlane32_swap_b32 v52, v53
    v_max_f32 v52, v52, v53
    v_mov_b32 v53, v52
    s_nop 1
    v_permlane16_swap_b32 v52, v53
    v_max_f32 v52, v52, v53
    v_sub_f32 v53, 0, v52
    v_sub_f32 v54, 0, v52
    v_sub_f32 v55, 0, v52
    v_sub_f32 v52, 0, v52
    v_mov_b32 v57, v56
    s_nop 1
    v_permlane32_swap_b32 v56, v57
    v_max_f32 v56, v56, v57
    v_mov_b32 v57, v56
    s_nop 1
    v_permlane16_swap_b32 v56, v57
    v_max_f32 v56, v56, v57
    v_sub_f32 v57, 0, v56
    v_sub_f32 v58, 0, v56
    v_sub_f32 v59, 0, v56
    v_sub_f32 v56, 0, v56
    v_mov_b32 v61, v60
    s_nop 1
    v_permlane32_swap_b32 v60, v61
    v_max_f32 v60, v60, v61
    v_mov_b32 v61, v60
    s_nop 1
    v_permlane16_swap_b32 v60, v61
    v_max_f32 v60, v60, v61
    v_sub_f32 v61, 0, v60
    v_sub_f32 v62, 0, v60
    v_sub_f32 v63, 0, v60
    v_sub_f32 v60, 0, v60
    v_mov_b32 v225, v224
    s_nop 1
    v_permlane32_swap_b32 v224, v225
    v_max_f32 v224, v224, v225
    v_mov_b32 v225, v224
    s_nop 1
    v_permlane16_swap_b32 v224, v225
    v_max_f32 v224, v224, v225
    v_sub_f32 v225, 0, v224
    v_sub_f32 v226, 0, v224
    v_sub_f32 v227, 0, v224
    v_sub_f32 v224, 0, v224
    v_accvgpr_write_b32 a0, 0
    v_accvgpr_write_b32 a1, 0
    v_accvgpr_write_b32 a2, 0
    v_accvgpr_write_b32 a3, 0
    v_accvgpr_write_b32 a4, 0
    v_accvgpr_write_b32 a5, 0
    v_accvgpr_write_b32 a6, 0
    v_accvgpr_write_b32 a7, 0
    v_accvgpr_write_b32 a8, 0
    v_accvgpr_write_b32 a9, 0
    v_accvgpr_write_b32 a10, 0
    v_accvgpr_write_b32 a11, 0
    v_accvgpr_write_b32 a12, 0
    v_accvgpr_write_b32 a13, 0
    v_accvgpr_write_b32 a14, 0
    v_accvgpr_write_b32 a15, 0
    v_accvgpr_write_b32 a16, 0
    v_accvgpr_write_b32 a17, 0
    v_accvgpr_write_b32 a18, 0
    v_accvgpr_write_b32 a19, 0
    v_accvgpr_write_b32 a20, 0
    v_accvgpr_write_b32 a21, 0
    v_accvgpr_write_b32 a22, 0
    v_accvgpr_write_b32 a23, 0
    v_accvgpr_write_b32 a24, 0
    v_accvgpr_write_b32 a25, 0
    v_accvgpr_write_b32 a26, 0
    v_accvgpr_write_b32 a27, 0
    v_accvgpr_write_b32 a28, 0
    v_accvgpr_write_b32 a29, 0
    v_accvgpr_write_b32 a30, 0
    v_accvgpr_write_b32 a31, 0
    v_accvgpr_write_b32 a32, 0
    v_accvgpr_write_b32 a33, 0
    v_accvgpr_write_b32 a34, 0
    v_accvgpr_write_b32 a35, 0
    v_accvgpr_write_b32 a36, 0
    v_accvgpr_write_b32 a37, 0
    v_accvgpr_write_b32 a38, 0
    v_accvgpr_write_b32 a39, 0
    v_accvgpr_write_b32 a40, 0
    v_accvgpr_write_b32 a41, 0
    v_accvgpr_write_b32 a42, 0
    v_accvgpr_write_b32 a43, 0
    v_accvgpr_write_b32 a44, 0
    v_accvgpr_write_b32 a45, 0
    v_accvgpr_write_b32 a46, 0
    v_accvgpr_write_b32 a47, 0
    v_accvgpr_write_b32 a48, 0
    v_accvgpr_write_b32 a49, 0
    v_accvgpr_write_b32 a50, 0
    v_accvgpr_write_b32 a51, 0
    v_accvgpr_write_b32 a52, 0
    v_accvgpr_write_b32 a53, 0
    v_accvgpr_write_b32 a54, 0
    v_accvgpr_write_b32 a55, 0
    v_accvgpr_write_b32 a56, 0
    v_accvgpr_write_b32 a57, 0
    v_accvgpr_write_b32 a58, 0
    v_accvgpr_write_b32 a59, 0
    v_accvgpr_write_b32 a60, 0
    v_accvgpr_write_b32 a61, 0
    v_accvgpr_write_b32 a62, 0
    v_accvgpr_write_b32 a63, 0
    v_accvgpr_write_b32 a64, 0
    v_accvgpr_write_b32 a65, 0
    v_accvgpr_write_b32 a66, 0
    v_accvgpr_write_b32 a67, 0
    v_accvgpr_write_b32 a68, 0
    v_accvgpr_write_b32 a69, 0
    v_accvgpr_write_b32 a70, 0
    v_accvgpr_write_b32 a71, 0
    v_accvgpr_write_b32 a72, 0
    v_accvgpr_write_b32 a73, 0
    v_accvgpr_write_b32 a74, 0
    v_accvgpr_write_b32 a75, 0
    v_accvgpr_write_b32 a76, 0
    v_accvgpr_write_b32 a77, 0
    v_accvgpr_write_b32 a78, 0
    v_accvgpr_write_b32 a79, 0
    v_accvgpr_write_b32 a80, 0
    v_accvgpr_write_b32 a81, 0
    v_accvgpr_write_b32 a82, 0
    v_accvgpr_write_b32 a83, 0
    v_accvgpr_write_b32 a84, 0
    v_accvgpr_write_b32 a85, 0
    v_accvgpr_write_b32 a86, 0
    v_accvgpr_write_b32 a87, 0
    v_accvgpr_write_b32 a88, 0
    v_accvgpr_write_b32 a89, 0
    v_accvgpr_write_b32 a90, 0
    v_accvgpr_write_b32 a91, 0
    v_accvgpr_write_b32 a92, 0
    v_accvgpr_write_b32 a93, 0
    v_accvgpr_write_b32 a94, 0
    v_accvgpr_write_b32 a95, 0
    v_accvgpr_write_b32 a96, 0
    v_accvgpr_write_b32 a97, 0
    v_accvgpr_write_b32 a98, 0
    v_accvgpr_write_b32 a99, 0
    v_accvgpr_write_b32 a100, 0
    v_accvgpr_write_b32 a101, 0
    v_accvgpr_write_b32 a102, 0
    v_accvgpr_write_b32 a103, 0
    v_accvgpr_write_b32 a104, 0
    v_accvgpr_write_b32 a105, 0
    v_accvgpr_write_b32 a106, 0
    v_accvgpr_write_b32 a107, 0
    v_accvgpr_write_b32 a108, 0
    v_accvgpr_write_b32 a109, 0
    v_accvgpr_write_b32 a110, 0
    v_accvgpr_write_b32 a111, 0
    v_accvgpr_write_b32 a112, 0
    v_accvgpr_write_b32 a113, 0
    v_accvgpr_write_b32 a114, 0
    v_accvgpr_write_b32 a115, 0
    v_accvgpr_write_b32 a116, 0
    v_accvgpr_write_b32 a117, 0
    v_accvgpr_write_b32 a118, 0
    v_accvgpr_write_b32 a119, 0
    v_accvgpr_write_b32 a120, 0
    v_accvgpr_write_b32 a121, 0
    v_accvgpr_write_b32 a122, 0
    v_accvgpr_write_b32 a123, 0
    v_accvgpr_write_b32 a124, 0
    v_accvgpr_write_b32 a125, 0
    v_accvgpr_write_b32 a126, 0
    v_accvgpr_write_b32 a127, 0
    v_accvgpr_write_b32 a128, 0
    v_accvgpr_write_b32 a129, 0
    v_accvgpr_write_b32 a130, 0
    v_accvgpr_write_b32 a131, 0
    v_accvgpr_write_b32 a132, 0
    v_accvgpr_write_b32 a133, 0
    v_accvgpr_write_b32 a134, 0
    v_accvgpr_write_b32 a135, 0
    v_accvgpr_write_b32 a136, 0
    v_accvgpr_write_b32 a137, 0
    v_accvgpr_write_b32 a138, 0
    v_accvgpr_write_b32 a139, 0
    v_accvgpr_write_b32 a140, 0
    v_accvgpr_write_b32 a141, 0
    v_accvgpr_write_b32 a142, 0
    v_accvgpr_write_b32 a143, 0
    v_accvgpr_write_b32 a144, 0
    v_accvgpr_write_b32 a145, 0
    v_accvgpr_write_b32 a146, 0
    v_accvgpr_write_b32 a147, 0
    v_accvgpr_write_b32 a148, 0
    v_accvgpr_write_b32 a149, 0
    v_accvgpr_write_b32 a150, 0
    v_accvgpr_write_b32 a151, 0
    v_accvgpr_write_b32 a152, 0
    v_accvgpr_write_b32 a153, 0
    v_accvgpr_write_b32 a154, 0
    v_accvgpr_write_b32 a155, 0
    v_accvgpr_write_b32 a156, 0
    v_accvgpr_write_b32 a157, 0
    v_accvgpr_write_b32 a158, 0
    v_accvgpr_write_b32 a159, 0
    v_accvgpr_write_b32 a160, 0
    v_accvgpr_write_b32 a161, 0
    v_accvgpr_write_b32 a162, 0
    v_accvgpr_write_b32 a163, 0
    v_accvgpr_write_b32 a164, 0
    v_accvgpr_write_b32 a165, 0
    v_accvgpr_write_b32 a166, 0
    v_accvgpr_write_b32 a167, 0
    v_accvgpr_write_b32 a168, 0
    v_accvgpr_write_b32 a169, 0
    v_accvgpr_write_b32 a170, 0
    v_accvgpr_write_b32 a171, 0
    v_accvgpr_write_b32 a172, 0
    v_accvgpr_write_b32 a173, 0
    v_accvgpr_write_b32 a174, 0
    v_accvgpr_write_b32 a175, 0
    v_accvgpr_write_b32 a176, 0
    v_accvgpr_write_b32 a177, 0
    v_accvgpr_write_b32 a178, 0
    v_accvgpr_write_b32 a179, 0
    v_accvgpr_write_b32 a180, 0
    v_accvgpr_write_b32 a181, 0
    v_accvgpr_write_b32 a182, 0
    v_accvgpr_write_b32 a183, 0
    v_accvgpr_write_b32 a184, 0
    v_accvgpr_write_b32 a185, 0
    v_accvgpr_write_b32 a186, 0
    v_accvgpr_write_b32 a187, 0
    v_accvgpr_write_b32 a188, 0
    v_accvgpr_write_b32 a189, 0
    v_accvgpr_write_b32 a190, 0
    v_accvgpr_write_b32 a191, 0
    v_accvgpr_write_b32 a192, 0
    v_accvgpr_write_b32 a193, 0
    v_accvgpr_write_b32 a194, 0
    v_accvgpr_write_b32 a195, 0
    v_accvgpr_write_b32 a196, 0
    v_accvgpr_write_b32 a197, 0
    v_accvgpr_write_b32 a198, 0
    v_accvgpr_write_b32 a199, 0
    v_accvgpr_write_b32 a200, 0
    v_accvgpr_write_b32 a201, 0
    v_accvgpr_write_b32 a202, 0
    v_accvgpr_write_b32 a203, 0
    v_accvgpr_write_b32 a204, 0
    v_accvgpr_write_b32 a205, 0
    v_accvgpr_write_b32 a206, 0
    v_accvgpr_write_b32 a207, 0
    v_accvgpr_write_b32 a208, 0
    v_accvgpr_write_b32 a209, 0
    v_accvgpr_write_b32 a210, 0
    v_accvgpr_write_b32 a211, 0
    v_accvgpr_write_b32 a212, 0
    v_accvgpr_write_b32 a213, 0
    v_accvgpr_write_b32 a214, 0
    v_accvgpr_write_b32 a215, 0
    v_accvgpr_write_b32 a216, 0
    v_accvgpr_write_b32 a217, 0
    v_accvgpr_write_b32 a218, 0
    v_accvgpr_write_b32 a219, 0
    v_accvgpr_write_b32 a220, 0
    v_accvgpr_write_b32 a221, 0
    v_accvgpr_write_b32 a222, 0
    v_accvgpr_write_b32 a223, 0
    v_accvgpr_write_b32 a224, 0
    v_accvgpr_write_b32 a225, 0
    v_accvgpr_write_b32 a226, 0
    v_accvgpr_write_b32 a227, 0
    v_accvgpr_write_b32 a228, 0
    v_accvgpr_write_b32 a229, 0
    v_accvgpr_write_b32 a230, 0
    v_accvgpr_write_b32 a231, 0
    v_accvgpr_write_b32 a232, 0
    v_accvgpr_write_b32 a233, 0
    v_accvgpr_write_b32 a234, 0
    v_accvgpr_write_b32 a235, 0
    v_accvgpr_write_b32 a236, 0
    v_accvgpr_write_b32 a237, 0
    v_accvgpr_write_b32 a238, 0
    v_accvgpr_write_b32 a239, 0
    v_accvgpr_write_b32 a240, 0
    v_accvgpr_write_b32 a241, 0
    v_accvgpr_write_b32 a242, 0
    v_accvgpr_write_b32 a243, 0
    v_accvgpr_write_b32 a244, 0
    v_accvgpr_write_b32 a245, 0
    v_accvgpr_write_b32 a246, 0
    v_accvgpr_write_b32 a247, 0
    v_accvgpr_write_b32 a248, 0
    v_accvgpr_write_b32 a249, 0
    v_accvgpr_write_b32 a250, 0
    v_accvgpr_write_b32 a251, 0
    v_mov_b32 v236, 0x3f803f80
    v_accvgpr_write_b32 a252, v236
    v_accvgpr_write_b32 a253, v236
    v_accvgpr_write_b32 a254, v236
    v_accvgpr_write_b32 a255, v236
    s_mov_b32 s42, 0
    s_mov_b32 s43, 0x1000
    s_mov_b32 s39, 0
L_sa:
    s_add_u32 m0, s46, 0
    s_nop 0
    buffer_load_dwordx4 v245, s[16:19], s42 offen nt lds
    s_add_u32 m0, s46, 16
    s_nop 0
    buffer_load_dwordx4 v245, s[16:19], s42 offen offset:1024 nt lds
    s_add_u32 m0, s46, 32
    s_nop 0
    buffer_load_dwordx4 v245, s[16:19], s42 offen offset:2048 nt lds
    s_add_u32 m0, s46, 48
    s_nop 0
    buffer_load_dwordx4 v245, s[16:19], s42 offen offset:3072 nt lds
    s_add_u32 m0, s46, 0x1040
    s_nop 0
    buffer_load_dwordx4 v245, s[16:19], s43 offen nt lds
    s_add_u32 m0, s46, 0x1050
    s_nop 0
    buffer_load_dwordx4 v245, s[16:19], s43 offen offset:1024 nt lds
    s_add_u32 m0, s46, 0x1060
    s_nop 0
    buffer_load_dwordx4 v245, s[16:19], s43 offen offset:2048 nt lds
    s_add_u32 m0, s46, 0x1070
    s_nop 0
    buffer_load_dwordx4 v245, s[16:19], s43 offen offset:3072 nt lds
    s_add_u32 m0, s47, 0
    s_nop 0
    buffer_load_dwordx4 v245, s[20:23], s42 offen nt lds
    s_add_u32 m0, s47, 32
    s_nop 0
    buffer_load_dwordx4 v245, s[20:23], s42 offen offset:1024 nt lds
    s_add_u32 m0, s47, 64
    s_nop 0
    buffer_load_dwordx4 v245, s[20:23], s42 offen offset:2048 nt lds
    s_add_u32 m0, s47, 0x60
    s_nop 0
    buffer_load_dwordx4 v245, s[20:23], s42 offen offset:3072 nt lds
    s_add_u32 m0, s47, 0x1080
    s_nop 0
    buffer_load_dwordx4 v245, s[20:23], s43 offen nt lds
    s_add_u32 m0, s47, 0x10a0
    s_nop 0
    buffer_load_dwordx4 v245, s[20:23], s43 offen offset:1024 nt lds
    s_add_u32 m0, s47, 0x10c0
    s_nop 0
    buffer_load_dwordx4 v245, s[20:23], s43 offen offset:2048 nt lds
    s_add_u32 m0, s47, 0x10e0
    s_nop 0
    buffer_load_dwordx4 v245, s[20:23], s43 offen offset:3072 nt lds
    s_waitcnt vmcnt(8)
    ds_read_b128 v[128:131], v240 offset:0
    ds_read_b128 v[132:135], v240 offset:16
    ds_read_b128 v[136:139], v240 offset:32
    ds_read_b128 v[140:143], v240 offset:48
    ds_read_b128 v[144:147], v240 offset:4160
    ds_read_b128 v[148:151], v240 offset:4176
    ds_read_b128 v[152:155], v240 offset:4192
    ds_read_b128 v[156:159], v240 offset:4208
    s_waitcnt vmcnt(0)
    ds_read_b64_tr_b16 v[160:161], v241 offset:0
    ds_read_b64_tr_b16 v[162:163], v241 offset:4224
    ds_read_b64_tr_b16 v[164:165], v241 offset:32
    ds_read_b64_tr_b16 v[166:167], v241 offset:4256
    ds_read_b64_tr_b16 v[168:169], v242 offset:0
    ds_read_b64_tr_b16 v[170:171], v242 offset:4224
    ds_read_b64_tr_b16 v[172:173], v242 offset:32
    ds_read_b64_tr_b16 v[174:175], v242 offset:4256
    ds_read_b64_tr_b16 v[176:177], v243 offset:0
    ds_read_b64_tr_b16 v[178:179], v243 offset:4224
    ds_read_b64_tr_b16 v[180:181], v243 offset:32
    ds_read_b64_tr_b16 v[182:183], v243 offset:4256
    ds_read_b64_tr_b16 v[184:185], v244 offset:0
    ds_read_b64_tr_b16 v[186:187], v244 offset:4224
    ds_read_b64_tr_b16 v[188:189], v244 offset:32
    ds_read_b64_tr_b16 v[190:191], v244 offset:4256
    s_waitcnt lgkmcnt(15)
    v_mfma_f32_16x16x32_bf16 v[0:3], v[128:131], v[64:67], v[40:43]
    s_waitcnt lgkmcnt(15)
    v_mfma_f32_16x16x32_bf16 v[0:3], v[132:135], v[68:71], v[0:3]
    s_waitcnt lgkmcnt(15)
    v_mfma_f32_16x16x32_bf16 v[0:3], v[136:139], v[72:75], v[0:3]
    s_waitcnt lgkmcnt(15)
    v_mfma_f32_16x16x32_bf16 v[0:3], v[140:143], v[76:79], v[0:3]
    s_waitcnt lgkmcnt(15)
    v_mfma_f32_16x16x32_bf16 v[4:7], v[144:147], v[64:67], v[40:43]
    s_waitcnt lgkmcnt(15)
    v_mfma_f32_16x16x32_bf16 v[4:7], v[148:151], v[68:71], v[4:7]
    s_waitcnt lgkmcnt(15)
    v_mfma_f32_16x16x32_bf16 v[4:7], v[152:155], v[72:75], v[4:7]
    s_waitcnt lgkmcnt(15)
    v_mfma_f32_16x16x32_bf16 v[4:7], v[156:159], v[76:79], v[4:7]
    s_waitcnt lgkmcnt(14)
    v_exp_f32 v0, v0
    v_exp_f32 v1, v1
    s_nop 0
    v_cvt_pk_bf16_f32 v32, v0, v1
    v_exp_f32 v2, v2
    v_exp_f32 v3, v3
    s_nop 0
    v_cvt_pk_bf16_f32 v33, v2, v3
    v_exp_f32 v4, v4
    v_exp_f32 v5, v5
    s_nop 0
    v_cvt_pk_bf16_f32 v34, v4, v5
    v_exp_f32 v6, v6
    v_exp_f32 v7, v7
    s_nop 0
    v_cvt_pk_bf16_f32 v35, v6, v7
    s_nop 1
    v_mfma_f32_16x16x32_bf16 a[0:3], v[160:163], v[32:35], a[0:3]
    s_waitcnt lgkmcnt(0)
    v_mfma_f32_16x16x32_bf16 a[4:7], v[164:167], v[32:35], a[4:7]
    v_mfma_f32_16x16x32_bf16 a[8:11], v[168:171], v[32:35], a[8:11]
    v_mfma_f32_16x16x32_bf16 a[12:15], v[172:175], v[32:35], a[12:15]
    v_mfma_f32_16x16x32_bf16 a[16:19], v[176:179], v[32:35], a[16:19]
    v_mfma_f32_16x16x32_bf16 a[20:23], v[180:183], v[32:35], a[20:23]
    v_mfma_f32_16x16x32_bf16 a[24:27], v[184:187], v[32:35], a[24:27]
    v_mfma_f32_16x16x32_bf16 a[28:31], v[188:191], v[32:35], a[28:31]
    v_mfma_f32_16x16x32_bf16 a[240:243], a[252:255], v[32:35], a[240:243]
    v_mfma_f32_16x16x32_bf16 v[8:11], v[128:131], v[80:83], v[44:47]
    v_mfma_f32_16x16x32_bf16 v[8:11], v[132:135], v[84:87], v[8:11]
    v_mfma_f32_16x16x32_bf16 v[8:11], v[136:139], v[88:91], v[8:11]
    v_mfma_f32_16x16x32_bf16 v[8:11], v[140:143], v[92:95], v[8:11]
    v_mfma_f32_16x16x32_bf16 v[12:15], v[144:147], v[80:83], v[44:47]
    v_mfma_f32_16x16x32_bf16 v[12:15], v[148:151], v[84:87], v[12:15]
    v_mfma_f32_16x16x32_bf16 v[12:15], v[152:155], v[88:91], v[12:15]
    v_mfma_f32_16x16x32_bf16 v[12:15], v[156:159], v[92:95], v[12:15]
    v_exp_f32 v8, v8
    v_exp_f32 v9, v9
    s_nop 0
    v_cvt_pk_bf16_f32 v36, v8, v9
    v_exp_f32 v10, v10
    v_exp_f32 v11, v11
    s_nop 0
    v_cvt_pk_bf16_f32 v37, v10, v11
    s_nop 0
    v_exp_f32 v12, v12
    v_exp_f32 v13, v13
    s_nop 0
    v_cvt_pk_bf16_f32 v38, v12, v13
    v_exp_f32 v14, v14
    v_exp_f32 v15, v15
    s_nop 0
    v_cvt_pk_bf16_f32 v39, v14, v15
    s_nop 1
    v_mfma_f32_16x16x32_bf16 a[32:35], v[160:163], v[36:39], a[32:35]
    v_mfma_f32_16x16x32_bf16 a[36:39], v[164:167], v[36:39], a[36:39]
    v_mfma_f32_16x16x32_bf16 a[40:43], v[168:171], v[36:39], a[40:43]
    v_mfma_f32_16x16x32_bf16 a[44:47], v[172:175], v[36:39], a[44:47]
    v_mfma_f32_16x16x32_bf16 a[48:51], v[176:179], v[36:39], a[48:51]
    v_mfma_f32_16x16x32_bf16 a[52:55], v[180:183], v[36:39], a[52:55]
    v_mfma_f32_16x16x32_bf16 a[56:59], v[184:187], v[36:39], a[56:59]
    v_mfma_f32_16x16x32_bf16 a[60:63], v[188:191], v[36:39], a[60:63]
    v_mfma_f32_16x16x32_bf16 a[244:247], a[252:255], v[36:39], a[244:247]
    v_mfma_f32_16x16x32_bf16 v[0:3], v[128:131], v[96:99], v[48:51]
    v_mfma_f32_16x16x32_bf16 v[0:3], v[132:135], v[100:103], v[0:3]
    v_mfma_f32_16x16x32_bf16 v[0:3], v[136:139], v[104:107], v[0:3]
    v_mfma_f32_16x16x32_bf16 v[0:3], v[140:143], v[108:111], v[0:3]
    v_mfma_f32_16x16x32_bf16 v[4:7], v[144:147], v[96:99], v[48:51]
    v_mfma_f32_16x16x32_bf16 v[4:7], v[148:151], v[100:103], v[4:7]
    v_mfma_f32_16x16x32_bf16 v[4:7], v[152:155], v[104:107], v[4:7]
    v_mfma_f32_16x16x32_bf16 v[4:7], v[156:159], v[108:111], v[4:7]
    v_exp_f32 v0, v0
    v_exp_f32 v1, v1
    s_nop 0
    v_cvt_pk_bf16_f32 v32, v0, v1
    v_exp_f32 v2, v2
    v_exp_f32 v3, v3
    s_nop 0
    v_cvt_pk_bf16_f32 v33, v2, v3
    s_nop 0
    v_exp_f32 v4, v4
    v_exp_f32 v5, v5
    s_nop 0
    v_cvt_pk_bf16_f32 v34, v4, v5
    v_exp_f32 v6, v6
    v_exp_f32 v7, v7
    s_nop 0
    v_cvt_pk_bf16_f32 v35, v6, v7
    s_nop 1
    v_mfma_f32_16x16x32_bf16 a[64:67], v[160:163], v[32:35], a[64:67]
    v_mfma_f32_16x16x32_bf16 a[68:71], v[164:167], v[32:35], a[68:71]
    v_mfma_f32_16x16x32_bf16 a[72:75], v[168:171], v[32:35], a[72:75]
    v_mfma_f32_16x16x32_bf16 a[76:79], v[172:175], v[32:35], a[76:79]
    v_mfma_f32_16x16x32_bf16 a[80:83], v[176:179], v[32:35], a[80:83]
    v_mfma_f32_16x16x32_bf16 a[84:87], v[180:183], v[32:35], a[84:87]
    v_mfma_f32_16x16x32_bf16 a[88:91], v[184:187], v[32:35], a[88:91]
    v_mfma_f32_16x16x32_bf16 a[92:95], v[188:191], v[32:35], a[92:95]
    v_mfma_f32_16x16x32_bf16 a[248:251], a[252:255], v[32:35], a[248:251]
    v_mfma_f32_16x16x32_bf16 v[8:11], v[128:131], v[112:115], v[52:55]
    v_mfma_f32_16x16x32_bf16 v[8:11], v[132:135], v[116:119], v[8:11]
    v_mfma_f32_16x16x32_bf16 v[8:11], v[136:139], v[120:123], v[8:11]
    v_mfma_f32_16x16x32_bf16 v[8:11], v[140:143], v[124:127], v[8:11]
    v_mfma_f32_16x16x32_bf16 v[12:15], v[144:147], v[112:115], v[52:55]
    v_mfma_f32_16x16x32_bf16 v[12:15], v[148:151], v[116:119], v[12:15]
    v_mfma_f32_16x16x32_bf16 v[12:15], v[152:155], v[120:123], v[12:15]
    v_mfma_f32_16x16x32_bf16 v[12:15], v[156:159], v[124:127], v[12:15]
    v_exp_f32 v8, v8
    v_exp_f32 v9, v9
    s_nop 0
    v_cvt_pk_bf16_f32 v36, v8, v9
    v_exp_f32 v10, v10
    v_exp_f32 v11, v11
    s_nop 0
    v_cvt_pk_bf16_f32 v37, v10, v11
    s_nop 0
    v_exp_f32 v12, v12
    v_exp_f32 v13, v13
    s_nop 0
    v_cvt_pk_bf16_f32 v38, v12, v13
    v_exp_f32 v14, v14
    v_exp_f32 v15, v15
    s_nop 0
    v_cvt_pk_bf16_f32 v39, v14, v15
    s_nop 1
    v_mfma_f32_16x16x32_bf16 a[96:99], v[160:163], v[36:39], a[96:99]
    v_mfma_f32_16x16x32_bf16 a[100:103], v[164:167], v[36:39], a[100:103]
    v_mfma_f32_16x16x32_bf16 a[104:107], v[168:171], v[36:39], a[104:107]
    v_mfma_f32_16x16x32_bf16 a[108:111], v[172:175], v[36:39], a[108:111]
    v_mfma_f32_16x16x32_bf16 a[112:115], v[176:179], v[36:39], a[112:115]
    v_mfma_f32_16x16x32_bf16 a[116:119], v[180:183], v[36:39], a[116:119]
    v_mfma_f32_16x16x32_bf16 a[120:123], v[184:187], v[36:39], a[120:123]
    v_mfma_f32_16x16x32_bf16 a[124:127], v[188:191], v[36:39], a[124:127]
    v_mfma_f32_16x16x32_bf16 a[224:227], a[252:255], v[36:39], a[224:227]
    v_mfma_f32_16x16x32_bf16 v[0:3], v[128:131], v[192:195], v[56:59]
    v_mfma_f32_16x16x32_bf16 v[0:3], v[132:135], v[196:199], v[0:3]
    v_mfma_f32_16x16x32_bf16 v[0:3], v[136:139], v[200:203], v[0:3]
    v_mfma_f32_16x16x32_bf16 v[0:3], v[140:143], v[204:207], v[0:3]
    v_mfma_f32_16x16x32_bf16 v[4:7], v[144:147], v[192:195], v[56:59]
    v_mfma_f32_16x16x32_bf16 v[4:7], v[148:151], v[196:199], v[4:7]
    v_mfma_f32_16x16x32_bf16 v[4:7], v[152:155], v[200:203], v[4:7]
    v_mfma_f32_16x16x32_bf16 v[4:7], v[156:159], v[204:207], v[4:7]
    v_exp_f32 v0, v0
    v_exp_f32 v1, v1
    s_nop 0
    v_cvt_pk_bf16_f32 v32, v0, v1
    v_exp_f32 v2, v2
    v_exp_f32 v3, v3
    s_nop 0
    v_cvt_pk_bf16_f32 v33, v2, v3
    s_nop 0
    v_exp_f32 v4, v4
    v_exp_f32 v5, v5
    s_nop 0
    v_cvt_pk_bf16_f32 v34, v4, v5
    v_exp_f32 v6, v6
    v_exp_f32 v7, v7
    s_nop 0
    v_cvt_pk_bf16_f32 v35, v6, v7
    s_nop 1
    v_mfma_f32_16x16x32_bf16 a[128:131], v[160:163], v[32:35], a[128:131]
    v_mfma_f32_16x16x32_bf16 a[132:135], v[164:167], v[32:35], a[132:135]
    v_mfma_f32_16x16x32_bf16 a[136:139], v[168:171], v[32:35], a[136:139]
    v_mfma_f32_16x16x32_bf16 a[140:143], v[172:175], v[32:35], a[140:143]
    v_mfma_f32_16x16x32_bf16 a[144:147], v[176:179], v[32:35], a[144:147]
    v_mfma_f32_16x16x32_bf16 a[148:151], v[180:183], v[32:35], a[148:151]
    v_mfma_f32_16x16x32_bf16 a[152:155], v[184:187], v[32:35], a[152:155]
    v_mfma_f32_16x16x32_bf16 a[156:159], v[188:191], v[32:35], a[156:159]
    v_mfma_f32_16x16x32_bf16 a[228:231], a[252:255], v[32:35], a[228:231]
    v_mfma_f32_16x16x32_bf16 v[8:11], v[128:131], v[208:211], v[60:63]
    v_mfma_f32_16x16x32_bf16 v[8:11], v[132:135], v[212:215], v[8:11]
    v_mfma_f32_16x16x32_bf16 v[8:11], v[136:139], v[216:219], v[8:11]
    v_mfma_f32_16x16x32_bf16 v[8:11], v[140:143], v[220:223], v[8:11]
    v_mfma_f32_16x16x32_bf16 v[12:15], v[144:147], v[208:211], v[60:63]
    v_mfma_f32_16x16x32_bf16 v[12:15], v[148:151], v[212:215], v[12:15]
    v_mfma_f32_16x16x32_bf16 v[12:15], v[152:155], v[216:219], v[12:15]
    v_mfma_f32_16x16x32_bf16 v[12:15], v[156:159], v[220:223], v[12:15]
    v_exp_f32 v8, v8
    v_exp_f32 v9, v9
    s_nop 0
    v_cvt_pk_bf16_f32 v36, v8, v9
    v_exp_f32 v10, v10
    v_exp_f32 v11, v11
    s_nop 0
    v_cvt_pk_bf16_f32 v37, v10, v11
    s_nop 0
    v_exp_f32 v12, v12
    v_exp_f32 v13, v13
    s_nop 0
    v_cvt_pk_bf16_f32 v38, v12, v13
    v_exp_f32 v14, v14
    v_exp_f32 v15, v15
    s_nop 0
    v_cvt_pk_bf16_f32 v39, v14, v15
    s_nop 1
    v_mfma_f32_16x16x32_bf16 a[160:163], v[160:163], v[36:39], a[160:163]
    v_mfma_f32_16x16x32_bf16 a[164:167], v[164:167], v[36:39], a[164:167]
    v_mfma_f32_16x16x32_bf16 a[168:171], v[168:171], v[36:39], a[168:171]
    v_mfma_f32_16x16x32_bf16 a[172:175], v[172:175], v[36:39], a[172:175]
    v_mfma_f32_16x16x32_bf16 a[176:179], v[176:179], v[36:39], a[176:179]
    v_mfma_f32_16x16x32_bf16 a[180:183], v[180:183], v[36:39], a[180:183]
    v_mfma_f32_16x16x32_bf16 a[184:187], v[184:187], v[36:39], a[184:187]
    v_mfma_f32_16x16x32_bf16 a[188:191], v[188:191], v[36:39], a[188:191]
    v_mfma_f32_16x16x32_bf16 a[232:235], a[252:255], v[36:39], a[232:235]
    v_mfma_f32_16x16x32_bf16 v[0:3], v[128:131], v[16:19], v[224:227]
    v_mfma_f32_16x16x32_bf16 v[0:3], v[132:135], v[20:23], v[0:3]
    v_mfma_f32_16x16x32_bf16 v[0:3], v[136:139], v[24:27], v[0:3]
    v_mfma_f32_16x16x32_bf16 v[0:3], v[140:143], v[28:31], v[0:3]
    v_mfma_f32_16x16x32_bf16 v[4:7], v[144:147], v[16:19], v[224:227]
    v_mfma_f32_16x16x32_bf16 v[4:7], v[148:151], v[20:23], v[4:7]
    v_mfma_f32_16x16x32_bf16 v[4:7], v[152:155], v[24:27], v[4:7]
    v_mfma_f32_16x16x32_bf16 v[4:7], v[156:159], v[28:31], v[4:7]
    v_exp_f32 v0, v0
    v_exp_f32 v1, v1
    s_nop 0
    v_cvt_pk_bf16_f32 v32, v0, v1
    v_exp_f32 v2, v2
    v_exp_f32 v3, v3
    s_nop 0
    v_cvt_pk_bf16_f32 v33, v2, v3
    s_nop 0
    v_exp_f32 v4, v4
    v_exp_f32 v5, v5
    s_nop 0
    v_cvt_pk_bf16_f32 v34, v4, v5
    v_exp_f32 v6, v6
    v_exp_f32 v7, v7
    s_nop 0
    v_cvt_pk_bf16_f32 v35, v6, v7
    s_nop 1
    v_mfma_f32_16x16x32_bf16 a[192:195], v[160:163], v[32:35], a[192:195]
    v_mfma_f32_16x16x32_bf16 a[196:199], v[164:167], v[32:35], a[196:199]
    v_mfma_f32_16x16x32_bf16 a[200:203], v[168:171], v[32:35], a[200:203]
    v_mfma_f32_16x16x32_bf16 a[204:207], v[172:175], v[32:35], a[204:207]
    v_mfma_f32_16x16x32_bf16 a[208:211], v[176:179], v[32:35], a[208:211]
    v_mfma_f32_16x16x32_bf16 a[212:215], v[180:183], v[32:35], a[212:215]
    v_mfma_f32_16x16x32_bf16 a[216:219], v[184:187], v[32:35], a[216:219]
    v_mfma_f32_16x16x32_bf16 a[220:223], v[188:191], v[32:35], a[220:223]
    v_mfma_f32_16x16x32_bf16 a[236:239], a[252:255], v[32:35], a[236:239]
    s_add_u32 s42, s42, 8192
    s_add_u32 s43, s43, 8192
    s_add_u32 s39, s39, 1
    s_cmp_lt_u32 s39, 16
    s_cbranch_scc1 L_sa
    v_accvgpr_read_b32 v232, a240
    v_cmp_nlt_f32 s[82:83], v232, s51
    s_nop 4
    s_or_b64 s[56:57], s[56:57], s[82:83]
    v_rcp_f32 v232, v232
    v_accvgpr_read_b32 v233, a244
    v_cmp_nlt_f32 s[82:83], v233, s51
    s_nop 4
    s_or_b64 s[56:57], s[56:57], s[82:83]
    v_rcp_f32 v233, v233
    v_accvgpr_read_b32 v234, a248
    v_cmp_nlt_f32 s[82:83], v234, s51
    s_nop 4
    s_or_b64 s[56:57], s[56:57], s[82:83]
    v_rcp_f32 v234, v234
    v_accvgpr_read_b32 v235, a224
    v_cmp_nlt_f32 s[82:83], v235, s51
    s_nop 4
    s_or_b64 s[56:57], s[56:57], s[82:83]
    v_rcp_f32 v235, v235
    v_accvgpr_read_b32 v236, a228
    v_cmp_nlt_f32 s[82:83], v236, s51
    s_nop 4
    s_or_b64 s[56:57], s[56:57], s[82:83]
    v_rcp_f32 v236, v236
    v_accvgpr_read_b32 v237, a232
    v_cmp_nlt_f32 s[82:83], v237, s51
    s_nop 4
    s_or_b64 s[56:57], s[56:57], s[82:83]
    v_rcp_f32 v237, v237
    v_accvgpr_read_b32 v238, a236
    v_cmp_nlt_f32 s[82:83], v238, s51
    s_nop 4
    s_or_b64 s[56:57], s[56:57], s[82:83]
    v_rcp_f32 v238, v238
    v_accvgpr_read_b32 v64, a0
    v_accvgpr_read_b32 v65, a1
    v_accvgpr_read_b32 v66, a2
    v_accvgpr_read_b32 v67, a3
    v_accvgpr_read_b32 v68, a4
    v_accvgpr_read_b32 v69, a5
    v_accvgpr_read_b32 v70, a6
    v_accvgpr_read_b32 v71, a7
    v_mul_f32 v64, v64, v232
    v_mul_f32 v65, v65, v232
    v_mul_f32 v66, v66, v232
    v_mul_f32 v67, v67, v232
    v_mul_f32 v68, v68, v232
    v_mul_f32 v69, v69, v232
    v_mul_f32 v70, v70, v232
    v_mul_f32 v71, v71, v232
    v_cvt_pk_bf16_f32 v80, v64, v65
    v_cvt_pk_bf16_f32 v81, v66, v67
    v_cvt_pk_bf16_f32 v82, v68, v69
    v_cvt_pk_bf16_f32 v83, v70, v71
    ds_write_b128 v246, v[80:83] offset:0
    v_accvgpr_read_b32 v72, a8
    v_accvgpr_read_b32 v73, a9
    v_accvgpr_read_b32 v74, a10
    v_accvgpr_read_b32 v75, a11
    v_accvgpr_read_b32 v76, a12
    v_accvgpr_read_b32 v77, a13
    v_accvgpr_read_b32 v78, a14
    v_accvgpr_read_b32 v79, a15
    v_mul_f32 v72, v72, v232
    v_mul_f32 v73, v73, v232
    v_mul_f32 v74, v74, v232
    v_mul_f32 v75, v75, v232
    v_mul_f32 v76, v76, v232
    v_mul_f32 v77, v77, v232
    v_mul_f32 v78, v78, v232
    v_mul_f32 v79, v79, v232
    v_cvt_pk_bf16_f32 v84, v72, v73
    v_cvt_pk_bf16_f32 v85, v74, v75
    v_cvt_pk_bf16_f32 v86, v76, v77
    v_cvt_pk_bf16_f32 v87, v78, v79
    ds_write_b128 v246, v[84:87] offset:7168
    v_accvgpr_read_b32 v64, a16
    v_accvgpr_read_b32 v65, a17
    v_accvgpr_read_b32 v66, a18
    v_accvgpr_read_b32 v67, a19
    v_accvgpr_read_b32 v68, a20
    v_accvgpr_read_b32 v69, a21
    v_accvgpr_read_b32 v70, a22
    v_accvgpr_read_b32 v71, a23
    v_pk_mul_f32 v[64:65], v[64:65], v[232:233] op_sel:[0,0] op_sel_hi:[1,0]
    v_pk_mul_f32 v[66:67], v[66:67], v[232:233] op_sel:[0,0] op_sel_hi:[1,0]
    v_pk_mul_f32 v[68:69], v[68:69], v[232:233] op_sel:[0,0] op_sel_hi:[1,0]
    v_pk_mul_f32 v[70:71], v[70:71], v[232:233] op_sel:[0,0] op_sel_hi:[1,0]
    v_accvgpr_read_b32 v72, a24
    v_accvgpr_read_b32 v73, a25
    v_accvgpr_read_b32 v74, a26
    v_accvgpr_read_b32 v75, a27
    v_cvt_pk_bf16_f32 v88, v64, v65
    v_cvt_pk_bf16_f32 v89, v66, v67
    v_cvt_pk_bf16_f32 v90, v68, v69
    v_cvt_pk_bf16_f32 v91, v70, v71
    v_accvgpr_read_b32 v76, a28
    v_accvgpr_read_b32 v77, a29
    v_accvgpr_read_b32 v78, a30
    v_accvgpr_read_b32 v79, a31
    ds_write_b128 v246, v[88:91] offset:14336
    v_pk_mul_f32 v[72:73], v[72:73], v[232:233] op_sel:[0,0] op_sel_hi:[1,0]
    v_pk_mul_f32 v[74:75], v[74:75], v[232:233] op_sel:[0,0] op_sel_hi:[1,0]
    v_pk_mul_f32 v[76:77], v[76:77], v[232:233] op_sel:[0,0] op_sel_hi:[1,0]
    v_pk_mul_f32 v[78:79], v[78:79], v[232:233] op_sel:[0,0] op_sel_hi:[1,0]
    v_accvgpr_read_b32 v64, a32
    v_accvgpr_read_b32 v65, a33
    v_accvgpr_read_b32 v66, a34
    v_accvgpr_read_b32 v67, a35
    v_cvt_pk_bf16_f32 v92, v72, v73
    v_cvt_pk_bf16_f32 v93, v74, v75
    v_cvt_pk_bf16_f32 v94, v76, v77
    v_cvt_pk_bf16_f32 v95, v78, v79
    v_accvgpr_read_b32 v68, a36
    v_accvgpr_read_b32 v69, a37
    v_accvgpr_read_b32 v70, a38
    v_accvgpr_read_b32 v71, a39
    ds_write_b128 v246, v[92:95] offset:21504
    v_pk_mul_f32 v[64:65], v[64:65], v[232:233] op_sel:[0,1] op_sel_hi:[1,1]
    v_pk_mul_f32 v[66:67], v[66:67], v[232:233] op_sel:[0,1] op_sel_hi:[1,1]
    v_pk_mul_f32 v[68:69], v[68:69], v[232:233] op_sel:[0,1] op_sel_hi:[1,1]
    v_pk_mul_f32 v[70:71], v[70:71], v[232:233] op_sel:[0,1] op_sel_hi:[1,1]
    v_accvgpr_read_b32 v72, a40
    v_accvgpr_read_b32 v73, a41
    v_accvgpr_read_b32 v74, a42
    v_accvgpr_read_b32 v75, a43
    v_cvt_pk_bf16_f32 v80, v64, v65
    v_cvt_pk_bf16_f32 v81, v66, v67
    v_cvt_pk_bf16_f32 v82, v68, v69
    v_cvt_pk_bf16_f32 v83, v70, v71
    v_accvgpr_read_b32 v76, a44
    v_accvgpr_read_b32 v77, a45
    v_accvgpr_read_b32 v78, a46
    v_accvgpr_read_b32 v79, a47
    ds_write_b128 v246, v[80:83] offset:1024
    v_pk_mul_f32 v[72:73], v[72:73], v[232:233] op_sel:[0,1] op_sel_hi:[1,1]
    v_pk_mul_f32 v[74:75], v[74:75], v[232:233] op_sel:[0,1] op_sel_hi:[1,1]
    v_pk_mul_f32 v[76:77], v[76:77], v[232:233] op_sel:[0,1] op_sel_hi:[1,1]
    v_pk_mul_f32 v[78:79], v[78:79], v[232:233] op_sel:[0,1] op_sel_hi:[1,1]
    v_accvgpr_read_b32 v64, a48
    v_accvgpr_read_b32 v65, a49
    v_accvgpr_read_b32 v66, a50
    v_accvgpr_read_b32 v67, a51
    v_cvt_pk_bf16_f32 v84, v72, v73
    v_cvt_pk_bf16_f32 v85, v74, v75
    v_cvt_pk_bf16_f32 v86, v76, v77
    v_cvt_pk_bf16_f32 v87, v78, v79
    v_accvgpr_read_b32 v68, a52
    v_accvgpr_read_b32 v69, a53
    v_accvgpr_read_b32 v70, a54
    v_accvgpr_read_b32 v71, a55
    ds_write_b128 v246, v[84:87] offset:8192
    v_pk_mul_f32 v[64:65], v[64:65], v[232:233] op_sel:[0,1] op_sel_hi:[1,1]
    v_pk_mul_f32 v[66:67], v[66:67], v[232:233] op_sel:[0,1] op_sel_hi:[1,1]
    v_pk_mul_f32 v[68:69], v[68:69], v[232:233] op_sel:[0,1] op_sel_hi:[1,1]
    v_pk_mul_f32 v[70:71], v[70:71], v[232:233] op_sel:[0,1] op_sel_hi:[1,1]
    v_accvgpr_read_b32 v72, a56
    v_accvgpr_read_b32 v73, a57
    v_accvgpr_read_b32 v74, a58
    v_accvgpr_read_b32 v75, a59
    v_cvt_pk_bf16_f32 v88, v64, v65
    v_cvt_pk_bf16_f32 v89, v66, v67
    v_cvt_pk_bf16_f32 v90, v68, v69
    v_cvt_pk_bf16_f32 v91, v70, v71
    v_accvgpr_read_b32 v76, a60
    v_accvgpr_read_b32 v77, a61
    v_accvgpr_read_b32 v78, a62
    v_accvgpr_read_b32 v79, a63
    ds_write_b128 v246, v[88:91] offset:15360
    v_pk_mul_f32 v[72:73], v[72:73], v[232:233] op_sel:[0,1] op_sel_hi:[1,1]
    v_pk_mul_f32 v[74:75], v[74:75], v[232:233] op_sel:[0,1] op_sel_hi:[1,1]
    v_pk_mul_f32 v[76:77], v[76:77], v[232:233] op_sel:[0,1] op_sel_hi:[1,1]
    v_pk_mul_f32 v[78:79], v[78:79], v[232:233] op_sel:[0,1] op_sel_hi:[1,1]
    v_accvgpr_read_b32 v64, a64
    v_accvgpr_read_b32 v65, a65
    v_accvgpr_read_b32 v66, a66
    v_accvgpr_read_b32 v67, a67
    v_cvt_pk_bf16_f32 v92, v72, v73
    v_cvt_pk_bf16_f32 v93, v74, v75
    v_cvt_pk_bf16_f32 v94, v76, v77
    v_cvt_pk_bf16_f32 v95, v78, v79
    v_accvgpr_read_b32 v68, a68
    v_accvgpr_read_b32 v69, a69
    v_accvgpr_read_b32 v70, a70
    v_accvgpr_read_b32 v71, a71
    ds_write_b128 v246, v[92:95] offset:22528
    v_pk_mul_f32 v[64:65], v[64:65], v[234:235] op_sel:[0,0] op_sel_hi:[1,0]
    v_pk_mul_f32 v[66:67], v[66:67], v[234:235] op_sel:[0,0] op_sel_hi:[1,0]
    v_pk_mul_f32 v[68:69], v[68:69], v[234:235] op_sel:[0,0] op_sel_hi:[1,0]
    v_pk_mul_f32 v[70:71], v[70:71], v[234:235] op_sel:[0,0] op_sel_hi:[1,0]
    v_accvgpr_read_b32 v72, a72
    v_accvgpr_read_b32 v73, a73
    v_accvgpr_read_b32 v74, a74
    v_accvgpr_read_b32 v75, a75
    v_cvt_pk_bf16_f32 v80, v64, v65
    v_cvt_pk_bf16_f32 v81, v66, v67
    v_cvt_pk_bf16_f32 v82, v68, v69
    v_cvt_pk_bf16_f32 v83, v70, v71
    v_accvgpr_read_b32 v76, a76
    v_accvgpr_read_b32 v77, a77
    v_accvgpr_read_b32 v78, a78
    v_accvgpr_read_b32 v79, a79
    ds_write_b128 v246, v[80:83] offset:2048
    v_pk_mul_f32 v[72:73], v[72:73], v[234:235] op_sel:[0,0] op_sel_hi:[1,0]
    v_pk_mul_f32 v[74:75], v[74:75], v[234:235] op_sel:[0,0] op_sel_hi:[1,0]
    v_pk_mul_f32 v[76:77], v[76:77], v[234:235] op_sel:[0,0] op_sel_hi:[1,0]
    v_pk_mul_f32 v[78:79], v[78:79], v[234:235] op_sel:[0,0] op_sel_hi:[1,0]
    v_accvgpr_read_b32 v64, a80
    v_accvgpr_read_b32 v65, a81
    v_accvgpr_read_b32 v66, a82
    v_accvgpr_read_b32 v67, a83
    v_cvt_pk_bf16_f32 v84, v72, v73
    v_cvt_pk_bf16_f32 v85, v74, v75
    v_cvt_pk_bf16_f32 v86, v76, v77
    v_cvt_pk_bf16_f32 v87, v78, v79
    v_accvgpr_read_b32 v68, a84
    v_accvgpr_read_b32 v69, a85
    v_accvgpr_read_b32 v70, a86
    v_accvgpr_read_b32 v71, a87
    ds_write_b128 v246, v[84:87] offset:9216
    v_pk_mul_f32 v[64:65], v[64:65], v[234:235] op_sel:[0,0] op_sel_hi:[1,0]
    v_pk_mul_f32 v[66:67], v[66:67], v[234:235] op_sel:[0,0] op_sel_hi:[1,0]
    v_pk_mul_f32 v[68:69], v[68:69], v[234:235] op_sel:[0,0] op_sel_hi:[1,0]
    v_pk_mul_f32 v[70:71], v[70:71], v[234:235] op_sel:[0,0] op_sel_hi:[1,0]
    v_accvgpr_read_b32 v72, a88
    v_accvgpr_read_b32 v73, a89
    v_accvgpr_read_b32 v74, a90
    v_accvgpr_read_b32 v75, a91
    v_cvt_pk_bf16_f32 v88, v64, v65
    v_cvt_pk_bf16_f32 v89, v66, v67
    v_cvt_pk_bf16_f32 v90, v68, v69
    v_cvt_pk_bf16_f32 v91, v70, v71
    v_accvgpr_read_b32 v76, a92
    v_accvgpr_read_b32 v77, a93
    v_accvgpr_read_b32 v78, a94
    v_accvgpr_read_b32 v79, a95
    ds_write_b128 v246, v[88:91] offset:16384
    v_pk_mul_f32 v[72:73], v[72:73], v[234:235] op_sel:[0,0] op_sel_hi:[1,0]
    v_pk_mul_f32 v[74:75], v[74:75], v[234:235] op_sel:[0,0] op_sel_hi:[1,0]
    v_pk_mul_f32 v[76:77], v[76:77], v[234:235] op_sel:[0,0] op_sel_hi:[1,0]
    v_pk_mul_f32 v[78:79], v[78:79], v[234:235] op_sel:[0,0] op_sel_hi:[1,0]
    v_accvgpr_read_b32 v64, a96
    v_accvgpr_read_b32 v65, a97
    v_accvgpr_read_b32 v66, a98
    v_accvgpr_read_b32 v67, a99
    v_cvt_pk_bf16_f32 v92, v72, v73
    v_cvt_pk_bf16_f32 v93, v74, v75
    v_cvt_pk_bf16_f32 v94, v76, v77
    v_cvt_pk_bf16_f32 v95, v78, v79
    v_accvgpr_read_b32 v68, a100
    v_accvgpr_read_b32 v69, a101
    v_accvgpr_read_b32 v70, a102
    v_accvgpr_read_b32 v71, a103
    ds_write_b128 v246, v[92:95] offset:23552
    v_pk_mul_f32 v[64:65], v[64:65], v[234:235] op_sel:[0,1] op_sel_hi:[1,1]
    v_pk_mul_f32 v[66:67], v[66:67], v[234:235] op_sel:[0,1] op_sel_hi:[1,1]
    v_pk_mul_f32 v[68:69], v[68:69], v[234:235] op_sel:[0,1] op_sel_hi:[1,1]
    v_pk_mul_f32 v[70:71], v[70:71], v[234:235] op_sel:[0,1] op_sel_hi:[1,1]
    v_accvgpr_read_b32 v72, a104
    v_accvgpr_read_b32 v73, a105
    v_accvgpr_read_b32 v74, a106
    v_accvgpr_read_b32 v75, a107
    v_cvt_pk_bf16_f32 v80, v64, v65
    v_cvt_pk_bf16_f32 v81, v66, v67
    v_cvt_pk_bf16_f32 v82, v68, v69
    v_cvt_pk_bf16_f32 v83, v70, v71
    v_accvgpr_read_b32 v76, a108
    v_accvgpr_read_b32 v77, a109
    v_accvgpr_read_b32 v78, a110
    v_accvgpr_read_b32 v79, a111
    ds_write_b128 v246, v[80:83] offset:3072
    v_pk_mul_f32 v[72:73], v[72:73], v[234:235] op_sel:[0,1] op_sel_hi:[1,1]
    v_pk_mul_f32 v[74:75], v[74:75], v[234:235] op_sel:[0,1] op_sel_hi:[1,1]
    v_pk_mul_f32 v[76:77], v[76:77], v[234:235] op_sel:[0,1] op_sel_hi:[1,1]
    v_pk_mul_f32 v[78:79], v[78:79], v[234:235] op_sel:[0,1] op_sel_hi:[1,1]
    v_accvgpr_read_b32 v64, a112
    v_accvgpr_read_b32 v65, a113
    v_accvgpr_read_b32 v66, a114
    v_accvgpr_read_b32 v67, a115
    v_cvt_pk_bf16_f32 v84, v72, v73
    v_cvt_pk_bf16_f32 v85, v74, v75
    v_cvt_pk_bf16_f32 v86, v76, v77
    v_cvt_pk_bf16_f32 v87, v78, v79
    v_accvgpr_read_b32 v68, a116
    v_accvgpr_read_b32 v69, a117
    v_accvgpr_read_b32 v70, a118
    v_accvgpr_read_b32 v71, a119
    ds_write_b128 v246, v[84:87] offset:10240
    v_pk_mul_f32 v[64:65], v[64:65], v[234:235] op_sel:[0,1] op_sel_hi:[1,1]
    v_pk_mul_f32 v[66:67], v[66:67], v[234:235] op_sel:[0,1] op_sel_hi:[1,1]
    v_pk_mul_f32 v[68:69], v[68:69], v[234:235] op_sel:[0,1] op_sel_hi:[1,1]
    v_pk_mul_f32 v[70:71], v[70:71], v[234:235] op_sel:[0,1] op_sel_hi:[1,1]
    v_accvgpr_read_b32 v72, a120
    v_accvgpr_read_b32 v73, a121
    v_accvgpr_read_b32 v74, a122
    v_accvgpr_read_b32 v75, a123
    v_cvt_pk_bf16_f32 v88, v64, v65
    v_cvt_pk_bf16_f32 v89, v66, v67
    v_cvt_pk_bf16_f32 v90, v68, v69
    v_cvt_pk_bf16_f32 v91, v70, v71
    v_accvgpr_read_b32 v76, a124
    v_accvgpr_read_b32 v77, a125
    v_accvgpr_read_b32 v78, a126
    v_accvgpr_read_b32 v79, a127
    ds_write_b128 v246, v[88:91] offset:17408
    v_pk_mul_f32 v[72:73], v[72:73], v[234:235] op_sel:[0,1] op_sel_hi:[1,1]
    v_pk_mul_f32 v[74:75], v[74:75], v[234:235] op_sel:[0,1] op_sel_hi:[1,1]
    v_pk_mul_f32 v[76:77], v[76:77], v[234:235] op_sel:[0,1] op_sel_hi:[1,1]
    v_pk_mul_f32 v[78:79], v[78:79], v[234:235] op_sel:[0,1] op_sel_hi:[1,1]
    v_accvgpr_read_b32 v64, a128
    v_accvgpr_read_b32 v65, a129
    v_accvgpr_read_b32 v66, a130
    v_accvgpr_read_b32 v67, a131
    v_cvt_pk_bf16_f32 v92, v72, v73
    v_cvt_pk_bf16_f32 v93, v74, v75
    v_cvt_pk_bf16_f32 v94, v76, v77
    v_cvt_pk_bf16_f32 v95, v78, v79
    v_accvgpr_read_b32 v68, a132
    v_accvgpr_read_b32 v69, a133
    v_accvgpr_read_b32 v70, a134
    v_accvgpr_read_b32 v71, a135
    ds_write_b128 v246, v[92:95] offset:24576
    v_pk_mul_f32 v[64:65], v[64:65], v[236:237] op_sel:[0,0] op_sel_hi:[1,0]
    v_pk_mul_f32 v[66:67], v[66:67], v[236:237] op_sel:[0,0] op_sel_hi:[1,0]
    v_pk_mul_f32 v[68:69], v[68:69], v[236:237] op_sel:[0,0] op_sel_hi:[1,0]
    v_pk_mul_f32 v[70:71], v[70:71], v[236:237] op_sel:[0,0] op_sel_hi:[1,0]
    v_accvgpr_read_b32 v72, a136
    v_accvgpr_read_b32 v73, a137
    v_accvgpr_read_b32 v74, a138
    v_accvgpr_read_b32 v75, a139
    v_cvt_pk_bf16_f32 v80, v64, v65
    v_cvt_pk_bf16_f32 v81, v66, v67
    v_cvt_pk_bf16_f32 v82, v68, v69
    v_cvt_pk_bf16_f32 v83, v70, v71
    v_accvgpr_read_b32 v76, a140
    v_accvgpr_read_b32 v77, a141
    v_accvgpr_read_b32 v78, a142
    v_accvgpr_read_b32 v79, a143
    ds_write_b128 v246, v[80:83] offset:4096
    v_pk_mul_f32 v[72:73], v[72:73], v[236:237] op_sel:[0,0] op_sel_hi:[1,0]
    v_pk_mul_f32 v[74:75], v[74:75], v[236:237] op_sel:[0,0] op_sel_hi:[1,0]
    v_pk_mul_f32 v[76:77], v[76:77], v[236:237] op_sel:[0,0] op_sel_hi:[1,0]
    v_pk_mul_f32 v[78:79], v[78:79], v[236:237] op_sel:[0,0] op_sel_hi:[1,0]
    v_accvgpr_read_b32 v64, a144
    v_accvgpr_read_b32 v65, a145
    v_accvgpr_read_b32 v66, a146
    v_accvgpr_read_b32 v67, a147
    v_cvt_pk_bf16_f32 v84, v72, v73
    v_cvt_pk_bf16_f32 v85, v74, v75
    v_cvt_pk_bf16_f32 v86, v76, v77
    v_cvt_pk_bf16_f32 v87, v78, v79
    v_accvgpr_read_b32 v68, a148
    v_accvgpr_read_b32 v69, a149
    v_accvgpr_read_b32 v70, a150
    v_accvgpr_read_b32 v71, a151
    ds_write_b128 v246, v[84:87] offset:11264
    v_pk_mul_f32 v[64:65], v[64:65], v[236:237] op_sel:[0,0] op_sel_hi:[1,0]
    v_pk_mul_f32 v[66:67], v[66:67], v[236:237] op_sel:[0,0] op_sel_hi:[1,0]
    v_pk_mul_f32 v[68:69], v[68:69], v[236:237] op_sel:[0,0] op_sel_hi:[1,0]
    v_pk_mul_f32 v[70:71], v[70:71], v[236:237] op_sel:[0,0] op_sel_hi:[1,0]
    v_accvgpr_read_b32 v72, a152
    v_accvgpr_read_b32 v73, a153
    v_accvgpr_read_b32 v74, a154
    v_accvgpr_read_b32 v75, a155
    v_cvt_pk_bf16_f32 v88, v64, v65
    v_cvt_pk_bf16_f32 v89, v66, v67
    v_cvt_pk_bf16_f32 v90, v68, v69
    v_cvt_pk_bf16_f32 v91, v70, v71
    v_accvgpr_read_b32 v76, a156
    v_accvgpr_read_b32 v77, a157
    v_accvgpr_read_b32 v78, a158
    v_accvgpr_read_b32 v79, a159
    ds_write_b128 v246, v[88:91] offset:18432
    v_pk_mul_f32 v[72:73], v[72:73], v[236:237] op_sel:[0,0] op_sel_hi:[1,0]
    v_pk_mul_f32 v[74:75], v[74:75], v[236:237] op_sel:[0,0] op_sel_hi:[1,0]
    v_pk_mul_f32 v[76:77], v[76:77], v[236:237] op_sel:[0,0] op_sel_hi:[1,0]
    v_pk_mul_f32 v[78:79], v[78:79], v[236:237] op_sel:[0,0] op_sel_hi:[1,0]
    v_accvgpr_read_b32 v64, a160
    v_accvgpr_read_b32 v65, a161
    v_accvgpr_read_b32 v66, a162
    v_accvgpr_read_b32 v67, a163
    v_cvt_pk_bf16_f32 v92, v72, v73
    v_cvt_pk_bf16_f32 v93, v74, v75
    v_cvt_pk_bf16_f32 v94, v76, v77
    v_cvt_pk_bf16_f32 v95, v78, v79
    v_accvgpr_read_b32 v68, a164
    v_accvgpr_read_b32 v69, a165
    v_accvgpr_read_b32 v70, a166
    v_accvgpr_read_b32 v71, a167
    ds_write_b128 v246, v[92:95] offset:25600
    v_pk_mul_f32 v[64:65], v[64:65], v[236:237] op_sel:[0,1] op_sel_hi:[1,1]
    v_pk_mul_f32 v[66:67], v[66:67], v[236:237] op_sel:[0,1] op_sel_hi:[1,1]
    v_pk_mul_f32 v[68:69], v[68:69], v[236:237] op_sel:[0,1] op_sel_hi:[1,1]
    v_pk_mul_f32 v[70:71], v[70:71], v[236:237] op_sel:[0,1] op_sel_hi:[1,1]
    v_accvgpr_read_b32 v72, a168
    v_accvgpr_read_b32 v73, a169
    v_accvgpr_read_b32 v74, a170
    v_accvgpr_read_b32 v75, a171
    v_cvt_pk_bf16_f32 v80, v64, v65
    v_cvt_pk_bf16_f32 v81, v66, v67
    v_cvt_pk_bf16_f32 v82, v68, v69
    v_cvt_pk_bf16_f32 v83, v70, v71
    v_accvgpr_read_b32 v76, a172
    v_accvgpr_read_b32 v77, a173
    v_accvgpr_read_b32 v78, a174
    v_accvgpr_read_b32 v79, a175
    ds_write_b128 v246, v[80:83] offset:5120
    v_pk_mul_f32 v[72:73], v[72:73], v[236:237] op_sel:[0,1] op_sel_hi:[1,1]
    v_pk_mul_f32 v[74:75], v[74:75], v[236:237] op_sel:[0,1] op_sel_hi:[1,1]
    v_pk_mul_f32 v[76:77], v[76:77], v[236:237] op_sel:[0,1] op_sel_hi:[1,1]
    v_pk_mul_f32 v[78:79], v[78:79], v[236:237] op_sel:[0,1] op_sel_hi:[1,1]
    v_accvgpr_read_b32 v64, a176
    v_accvgpr_read_b32 v65, a177
    v_accvgpr_read_b32 v66, a178
    v_accvgpr_read_b32 v67, a179
    v_cvt_pk_bf16_f32 v84, v72, v73
    v_cvt_pk_bf16_f32 v85, v74, v75
    v_cvt_pk_bf16_f32 v86, v76, v77
    v_cvt_pk_bf16_f32 v87, v78, v79
    v_accvgpr_read_b32 v68, a180
    v_accvgpr_read_b32 v69, a181
    v_accvgpr_read_b32 v70, a182
    v_accvgpr_read_b32 v71, a183
    ds_write_b128 v246, v[84:87] offset:12288
    v_pk_mul_f32 v[64:65], v[64:65], v[236:237] op_sel:[0,1] op_sel_hi:[1,1]
    v_pk_mul_f32 v[66:67], v[66:67], v[236:237] op_sel:[0,1] op_sel_hi:[1,1]
    v_pk_mul_f32 v[68:69], v[68:69], v[236:237] op_sel:[0,1] op_sel_hi:[1,1]
    v_pk_mul_f32 v[70:71], v[70:71], v[236:237] op_sel:[0,1] op_sel_hi:[1,1]
    v_accvgpr_read_b32 v72, a184
    v_accvgpr_read_b32 v73, a185
    v_accvgpr_read_b32 v74, a186
    v_accvgpr_read_b32 v75, a187
    v_cvt_pk_bf16_f32 v88, v64, v65
    v_cvt_pk_bf16_f32 v89, v66, v67
    v_cvt_pk_bf16_f32 v90, v68, v69
    v_cvt_pk_bf16_f32 v91, v70, v71
    v_accvgpr_read_b32 v76, a188
    v_accvgpr_read_b32 v77, a189
    v_accvgpr_read_b32 v78, a190
    v_accvgpr_read_b32 v79, a191
    ds_write_b128 v246, v[88:91] offset:19456
    v_pk_mul_f32 v[72:73], v[72:73], v[236:237] op_sel:[0,1] op_sel_hi:[1,1]
    v_pk_mul_f32 v[74:75], v[74:75], v[236:237] op_sel:[0,1] op_sel_hi:[1,1]
    v_pk_mul_f32 v[76:77], v[76:77], v[236:237] op_sel:[0,1] op_sel_hi:[1,1]
    v_pk_mul_f32 v[78:79], v[78:79], v[236:237] op_sel:[0,1] op_sel_hi:[1,1]
    v_accvgpr_read_b32 v64, a192
    v_accvgpr_read_b32 v65, a193
    v_accvgpr_read_b32 v66, a194
    v_accvgpr_read_b32 v67, a195
    v_cvt_pk_bf16_f32 v92, v72, v73
    v_cvt_pk_bf16_f32 v93, v74, v75
    v_cvt_pk_bf16_f32 v94, v76, v77
    v_cvt_pk_bf16_f32 v95, v78, v79
    v_accvgpr_read_b32 v68, a196
    v_accvgpr_read_b32 v69, a197
    v_accvgpr_read_b32 v70, a198
    v_accvgpr_read_b32 v71, a199
    ds_write_b128 v246, v[92:95] offset:26624
    v_pk_mul_f32 v[64:65], v[64:65], v[238:239] op_sel:[0,0] op_sel_hi:[1,0]
    v_pk_mul_f32 v[66:67], v[66:67], v[238:239] op_sel:[0,0] op_sel_hi:[1,0]
    v_pk_mul_f32 v[68:69], v[68:69], v[238:239] op_sel:[0,0] op_sel_hi:[1,0]
    v_pk_mul_f32 v[70:71], v[70:71], v[238:239] op_sel:[0,0] op_sel_hi:[1,0]
    v_accvgpr_read_b32 v72, a200
    v_accvgpr_read_b32 v73, a201
    v_accvgpr_read_b32 v74, a202
    v_accvgpr_read_b32 v75, a203
    v_cvt_pk_bf16_f32 v80, v64, v65
    v_cvt_pk_bf16_f32 v81, v66, v67
    v_cvt_pk_bf16_f32 v82, v68, v69
    v_cvt_pk_bf16_f32 v83, v70, v71
    v_accvgpr_read_b32 v76, a204
    v_accvgpr_read_b32 v77, a205
    v_accvgpr_read_b32 v78, a206
    v_accvgpr_read_b32 v79, a207
    ds_write_b128 v246, v[80:83] offset:6144
    v_pk_mul_f32 v[72:73], v[72:73], v[238:239] op_sel:[0,0] op_sel_hi:[1,0]
    v_pk_mul_f32 v[74:75], v[74:75], v[238:239] op_sel:[0,0] op_sel_hi:[1,0]
    v_pk_mul_f32 v[76:77], v[76:77], v[238:239] op_sel:[0,0] op_sel_hi:[1,0]
    v_pk_mul_f32 v[78:79], v[78:79], v[238:239] op_sel:[0,0] op_sel_hi:[1,0]
    v_accvgpr_read_b32 v64, a208
    v_accvgpr_read_b32 v65, a209
    v_accvgpr_read_b32 v66, a210
    v_accvgpr_read_b32 v67, a211
    v_cvt_pk_bf16_f32 v84, v72, v73
    v_cvt_pk_bf16_f32 v85, v74, v75
    v_cvt_pk_bf16_f32 v86, v76, v77
    v_cvt_pk_bf16_f32 v87, v78, v79
    v_accvgpr_read_b32 v68, a212
    v_accvgpr_read_b32 v69, a213
    v_accvgpr_read_b32 v70, a214
    v_accvgpr_read_b32 v71, a215
    ds_write_b128 v246, v[84:87] offset:13312
    v_pk_mul_f32 v[64:65], v[64:65], v[238:239] op_sel:[0,0] op_sel_hi:[1,0]
    v_pk_mul_f32 v[66:67], v[66:67], v[238:239] op_sel:[0,0] op_sel_hi:[1,0]
    v_pk_mul_f32 v[68:69], v[68:69], v[238:239] op_sel:[0,0] op_sel_hi:[1,0]
    v_pk_mul_f32 v[70:71], v[70:71], v[238:239] op_sel:[0,0] op_sel_hi:[1,0]
    v_accvgpr_read_b32 v72, a216
    v_accvgpr_read_b32 v73, a217
    v_accvgpr_read_b32 v74, a218
    v_accvgpr_read_b32 v75, a219
    v_cvt_pk_bf16_f32 v88, v64, v65
    v_cvt_pk_bf16_f32 v89, v66, v67
    v_cvt_pk_bf16_f32 v90, v68, v69
    v_cvt_pk_bf16_f32 v91, v70, v71
    v_accvgpr_read_b32 v76, a220
    v_accvgpr_read_b32 v77, a221
    v_accvgpr_read_b32 v78, a222
    v_accvgpr_read_b32 v79, a223
    ds_write_b128 v246, v[88:91] offset:20480
    v_pk_mul_f32 v[72:73], v[72:73], v[238:239] op_sel:[0,0] op_sel_hi:[1,0]
    v_pk_mul_f32 v[74:75], v[74:75], v[238:239] op_sel:[0,0] op_sel_hi:[1,0]
    v_pk_mul_f32 v[76:77], v[76:77], v[238:239] op_sel:[0,0] op_sel_hi:[1,0]
    v_pk_mul_f32 v[78:79], v[78:79], v[238:239] op_sel:[0,0] op_sel_hi:[1,0]
    v_cvt_pk_bf16_f32 v92, v72, v73
    v_cvt_pk_bf16_f32 v93, v74, v75
    v_cvt_pk_bf16_f32 v94, v76, v77
    v_cvt_pk_bf16_f32 v95, v78, v79
    ds_write_b128 v246, v[92:95] offset:27648
    ds_read_b64_tr_b16 v[96:97], v252 offset:0
    ds_read_b64_tr_b16 v[98:99], v252 offset:1024
    ds_read_b64_tr_b16 v[100:101], v253 offset:0
    ds_read_b64_tr_b16 v[102:103], v253 offset:1024
    ds_read_b64_tr_b16 v[104:105], v252 offset:2048
    ds_read_b64_tr_b16 v[106:107], v252 offset:3072
    ds_read_b64_tr_b16 v[108:109], v253 offset:2048
    ds_read_b64_tr_b16 v[110:111], v253 offset:3072
    buffer_load_dwordx2 v[42:43], off, s[76:79], 0 sc0 sc1
    s_waitcnt vmcnt(0) lgkmcnt(0)
    s_nop 15
    s_branch L_join
.section .rodata,"a"
.p2align 6
.amdhsa_kernel concat_heads__mha_block_cached__gqa_block_cached__near_ridge_kernel
  .amdhsa_next_free_vgpr 512
  .amdhsa_next_free_sgpr 102
  .amdhsa_accum_offset 256
  .amdhsa_group_segment_fixed_size 0
  .amdhsa_kernarg_size 104
  .amdhsa_user_sgpr_count 2
  .amdhsa_user_sgpr_kernarg_segment_ptr 1
  .amdhsa_system_sgpr_workgroup_id_x 1
.end_amdhsa_kernel
```
